```python
import torch

def _softmax(x, axis=-1):
    return torch.softmax(x, dim=axis)

def _gelu(x):
    return torch.nn.functional.gelu(x, approximate='tanh')

def _silu(x):
    return torch.nn.functional.silu(x)

def _sigmoid(x):
    return torch.sigmoid(x)

def _layernorm(x, axis=-1, eps=1e-05):
    m = x.mean(dim=axis, keepdim=True)
    v = x.var(dim=axis, keepdim=True, unbiased=False)
    return (x - m) / torch.sqrt(v + eps)

def _scatter_add(tgt, idx, src, axis=0):
    return tgt.clone().index_add_(axis, idx, src)

def _segment_sum(src, seg, n):
    out = torch.zeros((n,) + src.shape[1:], dtype=src.dtype)
    return out.index_add_(0, seg, src)

def _pad(x, pw):
    flat = tuple((v for pair in reversed(pw) for v in pair))
    return torch.nn.functional.pad(x, flat)
kernel_name = 'adaLN_cond__sliding_local_dilated__mixer_s_mlp__prompt'

def setup_inputs():

    _w = lambda a: (lambda t: t.to(torch.bfloat16) if t.is_floating_point() else t)(torch.as_tensor(a))

    def _A_setup():
        B, S, D = (1, 2048, 512)
        return {'x': _w((lambda *s: torch.randn(*s, dtype=torch.bfloat16) * 0.05)(B, S, D)), 'wqkv': _w((lambda *s: torch.randn(*s, dtype=torch.bfloat16) * 0.05)(D, 3 * D)), 'wo': _w((lambda *s: torch.randn(*s, dtype=torch.bfloat16) * 0.05)(D, D))}
    _A_in = _A_setup()

    def _B_setup():
        B, S, D, F = (1, 2048, 512, 1376)
        return {'x': _w((lambda *s: torch.randn(*s, dtype=torch.bfloat16) * 0.05)(B, S, D)), 'w1': _w((lambda *s: torch.randn(*s, dtype=torch.bfloat16) * 3.2)(D, D) * D ** (-0.5)), 'w2': _w((lambda *s: torch.randn(*s, dtype=torch.bfloat16) * 3.2)(D, D) * D ** (-0.5)), 'w3': _w((lambda *s: torch.randn(*s, dtype=torch.bfloat16) * 3.2)(D, F) * D ** (-0.5)), 'w4': _w((lambda *s: torch.randn(*s, dtype=torch.bfloat16) * 3.2)(F, D) * F ** (-0.5))}
    _B_in = _B_setup()
    return {'A_x': _A_in['x'], 'A_wqkv': _A_in['wqkv'], 'A_wo': _A_in['wo'], 'B_x': _B_in['x'], 'B_w1': _B_in['w1'], 'B_w2': _B_in['w2'], 'B_w3': _B_in['w3'], 'B_w4': _B_in['w4'], 'c': _w((lambda *s: torch.randn(*s, dtype=torch.bfloat16) * 0.1)(1, 512) * 8.0), 'w_mod': _w((lambda *s: torch.randn(*s, dtype=torch.bfloat16) * 0.1)(512, 6 * 512) * 512 ** (-0.5) * 8.0)}

def reference(A_x, A_wqkv, A_wo, B_x, B_w1, B_w2, B_w3, B_w4, c, w_mod):

    def _A_ref(x, wqkv, wo):
        B, S, D = x.shape
        H = 32
        Dh = D // H
        W, dil = (8, 2)
        qkv = (lambda x, *d: x.permute(*d))((x @ wqkv).reshape(B, S, 3, H, Dh), 2, 0, 3, 1, 4)
        q, k, v = (qkv[0], qkv[1], qkv[2])
        scale = Dh ** (-0.5)
        pos = torch.arange(S)
        off = torch.arange(W) * dil
        idx = pos[:, None] - off[None, :]
        mask = idx >= 0
        idx_c = torch.where(mask, idx, 0).reshape(-1)
        kg = k[:, :, idx_c, :].reshape(B, H, S, W, Dh)
        vg = v[:, :, idx_c, :].reshape(B, H, S, W, Dh)
        logits = torch.einsum('bhsd,bhswd->bhsw', q, kg) * scale
        logits = torch.where(mask[None, None, :, :], logits, -1000000000.0)
        attn = _softmax(logits, axis=-1)
        o = torch.einsum('bhsw,bhswd->bhsd', attn, vg)
        return (lambda x, *d: x.permute(*d))(o, 0, 2, 1, 3).reshape(B, S, D) @ wo

    def _B_ref(x, w1, w2, w3, w4):
        B, S, D = x.shape
        h = _gelu(_layernorm(x, axis=-1) @ w1)
        c = D // 4
        g0 = _pad(h[:, :, 0 * c:1 * c], ((0, 0), (1, 0), (0, 0)))[:, :S, :]
        g1 = _pad(h[:, :, 1 * c:2 * c], ((0, 0), (0, 1), (0, 0)))[:, 1:, :]
        g2 = _pad(h[:, :, 2 * c:3 * c], ((0, 0), (2, 0), (0, 0)))[:, :S, :]
        g3 = _pad(h[:, :, 3 * c:], ((0, 0), (0, 2), (0, 0)))[:, 2:, :]
        hs = torch.concatenate([g0, g1, g2, g3], axis=-1) @ w2
        x1 = x + hs
        h2 = _gelu(_layernorm(x1, axis=-1) @ w3) @ w4
        return x1 + h2
    x = A_x
    mod = (_silu(c) @ w_mod).reshape(c.shape[0], 6, 1, -1)
    sa, ca, ga, sb, cb, gb = (mod[:, 0].clone(), mod[:, 1].clone(), mod[:, 2].clone(), mod[:, 3].clone(), mod[:, 4].clone(), mod[:, 5].clone())
    h = _layernorm(x, axis=-1) * (1 + ca) + sa
    x = x + ga * _A_ref(h, A_wqkv, A_wo)
    h = _layernorm(x, axis=-1) * (1 + cb) + sb
    x = x + gb * _B_ref(h, B_w1, B_w2, B_w3, B_w4)
    return x
```

```asm
; @launch grid=(256,1,1) block=(256,1,1) lds=163840
.amdgcn_target "amdgcn-amd-amdhsa--gfx950"
.text
.globl adaLN_cond__sliding_local_dilated__mixer_s_mlp__prompt_kernel
.p2align 8
.type adaLN_cond__sliding_local_dilated__mixer_s_mlp__prompt_kernel,@function
adaLN_cond__sliding_local_dilated__mixer_s_mlp__prompt_kernel:
s_load_dwordx2 s[32:33], s[0:1], 72
s_load_dwordx2 s[36:37], s[0:1], 64
s_load_dwordx2 s[44:45], s[0:1], 96
s_load_dwordx2 s[4:5], s[0:1], 0
s_cmp_ge_u32 s2, 256
s_cbranch_scc1 L_end
s_getpc_b64 s[76:77]
s_mov_b32 s79, 0x20000
s_mov_b32 s78, 49152
s_lshr_b32 s59, s2, 3
s_lshl_b32 s60, s59, 7
v_lshlrev_b32 v5, 12, v0
buffer_load_dword v251, v5, s[76:79], s60 offen
v_lshrrev_b32 v5, 6, v0
v_and_b32 v1, 63, v0
v_readfirstlane_b32 s52, v5
s_and_b32 s48, s2, 7
s_lshr_b32 s49, s2, 6
s_and_b32 s50, s59, 7
s_mov_b32 s34, 3145728
s_movk_i32 s38, 1024
s_mov_b32 s46, 20971520
s_mov_b32 s6, 2097152
s_mov_b32 s35, s79
s_mov_b32 s39, s79
s_mov_b32 s47, s79
s_mov_b32 s7, s79
s_lshl_b32 s57, s50, 6
s_lshl_b32 s58, s48, 7
s_add_u32 s72, s58, s57
s_lshl_b32 s58, s58, 1
s_addk_i32 s58, 1152
s_cmp_lt_u32 s50, 2
s_cselect_b32 s72, s72, s58
v_lshrrev_b32 v6, 3, v1
v_and_b32 v5, 2, v6
v_and_b32 v7, 7, v1
v_xor_b32 v5, v5, v7
v_mul_u32_u24 v6, 6144, v6
v_lshl_add_u32 v5, v5, 4, v6
v_xor_b32 v6, 64, v5
s_lshl2_add_u32 s82, s49, s52
s_mul_i32 s82, s82, 196608
s_lshl1_add_u32 s80, s72, s82
s_lshl_b32 s90, s52, 12
v_and_b32 v7, 127, v0
v_lshlrev_b32 v7, 1, v7
s_lshl_b32 s81, s49, 8
s_sub_u32 s63, s50, 2
s_cmp_lt_u32 s63, 5
s_cselect_b64 s[68:69], -1, 0
s_cselect_b64 s[70:71], 0, -1
v_mov_b32 v10, 0
s_waitcnt lgkmcnt(0)
buffer_load_dword v9, v10, s[44:47], 0 offen sc1
s_cbranch_scc1 L_ld0B
buffer_load_ushort v8, v7, s[36:39], s81 offen
s_add_u32 m0, s90, 0
s_nop 0
buffer_load_dwordx4 v5, s[32:35], s80 offen offset:0 nt lds
s_add_u32 s80, s80, 48128
buffer_load_dwordx4 v6, s[32:35], s80 offen offset:1024 nt lds
s_add_u32 s80, s80, 48128
buffer_load_dwordx4 v5, s[32:35], s80 offen offset:2048 nt lds
s_add_u32 s80, s80, 48128
buffer_load_dwordx4 v6, s[32:35], s80 offen offset:3072 nt lds
s_branch L_ld0
L_ld0B:
s_lshl2_add_u32 s74, s48, s49
s_lshl2_add_u32 s74, s74, s63
s_sub_u32 s74, s74, 1
s_lshl_b32 s74, s74, 14
v_lshlrev_b32 v2, 4, v1
s_add_u32 s74, s74, s90
s_max_i32 s74, s74, 0
buffer_load_dwordx4 v[68:71], v2, s[4:7], s74 offen offset:0 nt
buffer_load_dwordx4 v[76:79], v2, s[4:7], s74 offen offset:1024 nt
buffer_load_dwordx4 v[84:87], v2, s[4:7], s74 offen offset:2048 nt
buffer_load_dwordx4 v[92:95], v2, s[4:7], s74 offen offset:3072 nt
buffer_load_dword v251, v10, s[44:47], 0 offen
L_ld0:
s_load_dwordx2 s[8:9], s[0:1], 8
s_load_dwordx2 s[12:13], s[0:1], 16
s_load_dwordx2 s[16:17], s[0:1], 32
s_load_dwordx2 s[20:21], s[0:1], 40
s_load_dwordx2 s[24:25], s[0:1], 48
s_load_dwordx2 s[28:29], s[0:1], 56
s_load_dwordx2 s[40:41], s[0:1], 80
s_lshl2_add_u32 s51, s48, s49
v_lshlrev_b32 v2, 4, v1
s_lshl2_add_u32 s74, s51, s63
s_sub_u32 s74, s74, 1
s_lshl_b32 s74, s74, 14
s_add_u32 s74, s74, s90
s_max_i32 s74, s74, 0
s_min_u32 s57, s57, 192
s_add_u32 s73, s58, s57
s_sub_u32 s73, s73, 128
s_lshl1_add_u32 s82, s73, s82
s_mov_b32 s10, 1572864
s_mov_b32 s11, s79
s_mov_b32 s14, 524288
s_mov_b32 s15, s79
s_mov_b32 s18, 524288
s_mov_b32 s19, s79
s_mov_b32 s22, 524288
s_mov_b32 s23, s79
s_mov_b32 s26, 1409024
s_mov_b32 s27, s79
s_mov_b32 s30, 1409024
s_mov_b32 s31, s79
s_mov_b32 s42, 2097152
s_mov_b32 s43, s79
v_lshrrev_b32 v3, 4, v1
v_and_b32 v4, 15, v1
s_lshl2_add_u32 s59, s59, s52
v_lshrrev_b32 v63, 2, v1
s_lshl_b32 s57, s59, 11
v_lshl_add_u32 v63, v63, 7, s57
v_lshlrev_b32 v255, 7, v1
s_lshl_b32 s59, s59, 12
v_lshl_add_u32 v235, v3, 10, s59
s_waitcnt lgkmcnt(0)
s_lshl3_add_u32 s0, s48, s50
s_lshl2_add_u32 s0, s0, s52
s_lshr_b32 s1, s0, 1
s_mul_i32 s1, s1, 66560
s_add_u32 s1, s1, 2097152
s_getreg_b32 s55, hwreg(HW_REG_XCC_ID)
s_and_b32 s55, s55, 15
s_mov_b32 s56, 200000
s_mov_b32 s94, 0xffff0000
s_mov_b32 s91, 0x3b000000
s_lshl_b32 s53, s51, 2
s_add_u32 s53, s53, s52
s_mul_i32 s88, s52, 3072
s_lshl_b32 s89, s52, 15
s_lshl_b32 s62, s50, 11
s_lshl_b32 s86, s52, 10
s_lshl_b32 s87, s50, 16
s_add_u32 s87, s87, s89
s_mul_i32 s57, s53, 66560
v_add_u32 v12, s57, v2
s_mul_i32 s61, s51, 266240
v_lshlrev_b32 v11, 3, v1
v_add_u32 v11, s61, v11
s_add_u32 s95, s61, s62
s_lshl_b32 s57, s52, 9
s_add_u32 s95, s95, s57
s_lshl_b32 s57, s50, 5
s_add_u32 s61, s61, s57
s_lshl_b32 s57, s52, 3
s_add_u32 s61, s61, s57
s_lshl_b32 s100, 0x11111111, s52
s_mov_b32 s101, 0
s_lshl_b32 s57, 0x00110011, s52
s_lshr_b32 s57, s57, 1
s_cmp_eq_u32 s52, 0
s_cselect_b32 s57, 0, s57
s_lshl_b32 s58, 0x22002200, s52
s_cmp_eq_u32 s52, 3
s_cselect_b32 s58, 0, s58
s_or_b32 s98, s57, s58
s_or_b32 s98, s98, s100
s_mov_b32 s99, 0
v_and_b32 v232, 1, v3
v_lshlrev_b32 v232, 1, v232
v_and_b32 v233, 7, v1
v_xor_b32 v232, v232, v233
s_and_b32 s57, s52, 1
s_lshl_b32 s57, s57, 2
v_xor_b32 v234, s57, v232
v_lshrrev_b32 v231, 3, v1
v_mul_u32_u24 v60, 3072, v231
v_lshl_add_u32 v60, v234, 4, v60
s_lshl_b32 s57, s88, 3
s_lshl_b32 s58, s50, 7
s_add_u32 s57, s57, s58
v_add_u32 v60, s57, v60
v_lshl_add_u32 v231, v231, 10, s58
v_lshl_add_u32 v52, v232, 4, v231
v_xor_b32 v53, 64, v52
v_add_u32 v54, 14336, v52
v_add_u32 v55, 21504, v53
v_add_u32 v53, 7168, v53
v_lshlrev_b32 v234, 1, v3
v_xor_b32 v234, v234, v233
v_lshl_add_u32 v48, v234, 4, v231
v_add_u32 v49, 7168, v48
v_add_u32 v50, 14336, v48
v_add_u32 v51, 21504, v48
v_lshl_add_u32 v61, v233, 4, v231
v_bfe_u32 v232, v1, 2, 2
v_and_b32 v233, 3, v1
v_lshlrev_b32 v233, 3, v233
v_lshl_add_u32 v233, v232, 7, v233
v_lshrrev_b32 v232, 1, v232
v_and_b32 v234, 1, v3
v_lshl_or_b32 v232, v234, 1, v232
v_lshl_add_u32 v233, v232, 5, v233
s_lshl_b32 s57, s52, 5
v_xor_b32 v234, s57, v233
v_lshl_add_u32 v62, v3, 10, v234
v_mul_u32_u24 v231, 3072, v3
v_add_u32 v234, v234, v231
v_add_u32 v16, 84480, v234
v_add_u32 v17, 121344, v234
v_add_u32 v19, 33792, v234
v_lshl_add_u32 v234, v3, 10, v233
v_lshl_add_u32 v231, v3, 9, v233
v_mov_b32 v56, v234
v_add_u32 v56, 84480, v56
v_xor_b32 v57, 32, v234
v_add_u32 v57, 84480, v57
v_xor_b32 v58, 64, v234
v_add_u32 v58, 84480, v58
v_xor_b32 v59, 96, v234
v_add_u32 v59, 84480, v59
v_mov_b32 v236, v231
v_add_u32 v240, 61440, v236
v_add_u32 v244, 122880, v236
v_xor_b32 v237, 32, v231
v_add_u32 v241, 61440, v237
v_add_u32 v245, 122880, v237
v_xor_b32 v238, 64, v231
v_add_u32 v242, 61440, v238
v_add_u32 v246, 122880, v238
v_xor_b32 v239, 96, v231
v_add_u32 v243, 61440, v239
v_add_u32 v247, 122880, v239
v_mul_u32_u24 v232, 1056, v4
v_lshl_add_u32 v20, v3, 4, v232
v_add_u32 v21, 50688, v20
v_lshlrev_b32 v14, 4, v3
v_add_u32 v14, 162304, v14
v_lshlrev_b32 v232, 7, v4
v_lshl_add_u32 v232, v3, 3, v232
s_lshl_b32 s57, s52, 11
s_add_u32 s57, s57, 150016
v_add_u32 v254, s57, v232
v_and_b32 v232, 1, v3
v_mul_u32_u24 v232, 66560, v232
v_lshrrev_b32 v233, 1, v3
v_lshl_add_u32 v232, v233, 8, v232
v_lshl_add_u32 v252, v4, 4, v232
v_and_b32 v232, 1, v4
v_lshlrev_b32 v232, 4, v232
v_lshl_add_u32 v253, v3, 5, v232
s_mul_i32 s57, s63, 66560
s_mul_i32 s58, s51, 266240
s_add_u32 s58, s58, s90
s_add_u32 s57, s57, s58
s_add_u32 s57, s57, 2074624
s_mul_i32 s75, s53, 66560
s_add_u32 s75, s75, 2137088
s_cmp_eq_u32 s63, 0
s_cselect_b32 s75, s75, s57
s_lshl_b32 s57, s48, 7
v_add_u32 v22, s57, v2
v_and_b32 v22, 0x3ff, v22
v_add_u32 v18, s58, v22
s_mul_i32 s57, s53, 66560
v_add_u32 v22, s57, v22
buffer_load_dword v251, v235, s[8:11], 0 offen offset:384
s_mov_b32 s60, 524288
buffer_load_dword v251, v235, s[8:11], s60 offen offset:384
s_mov_b32 s60, 1048576
buffer_load_dword v251, v235, s[8:11], s60 offen offset:384
s_add_u32 m0, s88, 84480
s_mul_i32 s3, s48, 196608
buffer_load_dwordx4 v60, s[8:11], s3 offen offset:0 lds
buffer_load_dwordx4 v60, s[8:11], s3 offen offset:1024 lds
buffer_load_dwordx4 v60, s[8:11], s3 offen offset:2048 lds
s_waitcnt vmcnt(11)
v_readfirstlane_b32 s54, v9
s_lshl_b32 s57, s51, 8
s_and_b32 s58, s0, 31
s_lshl_b32 s58, s58, 3
s_add_u32 s57, s57, s58
s_add_u32 s57, s57, 4096
s_mul_i32 s54, s54, 0x9E3779B1
s_add_u32 s54, s54, 0x7F4A7C15
v_mov_b32 v9, s54
v_mov_b32 v232, s55
v_mov_b32 v233, s54
s_bfe_u32 s76, s54, 524288
s_bfe_u32 s77, s54, 524296
s_bfe_u32 s78, s54, 524304
s_bfe_u32 s79, s54, 524312
s_mov_b64 exec, 1
buffer_store_dwordx2 v[232:233], v10, s[44:47], s57 offen sc1
s_mov_b64 exec, -1
s_cmp_lt_u32 s63, 5
s_cbranch_scc1 L_pathB
s_waitcnt vmcnt(11)
v_lshlrev_b32 v8, 16, v8
v_mul_f32 v224, 0xbfb8aa3b, v8
v_exp_f32 v224, v224
v_lshlrev_b32 v229, 4, v3
v_add_f32 v224, 1.0, v224
v_rcp_f32 v224, v224
v_mov_b32 v228, 0xffffff00
v_mul_f32 v224, v224, v8
v_cvt_pk_bf16_f32 v224, v224, v224
ds_write_b16 v7, v224 offset:32768
s_mul_i32 s57, s49, 12288
s_lshl_b32 s58, s72, 2
s_add_u32 s57, s57, s58
s_lshl_b32 s58, s52, 6
s_add_u32 s57, s57, s58
s_add_u32 s57, s57, 16384
s_waitcnt vmcnt(7)
s_waitcnt lgkmcnt(0)
s_barrier
ds_read_b128 a[196:199], v229 offset:32768
ds_read_b64_tr_b16 a[192:193], v62 offset:0
ds_read_b64_tr_b16 a[194:195], v62 offset:512
ds_read_b128 a[204:207], v229 offset:32832
ds_read_b64_tr_b16 a[200:201], v62 offset:4096
ds_read_b64_tr_b16 a[202:203], v62 offset:4608
ds_read_b128 a[212:215], v229 offset:32896
ds_read_b64_tr_b16 a[208:209], v62 offset:8192
ds_read_b64_tr_b16 a[210:211], v62 offset:8704
ds_read_b128 a[220:223], v229 offset:32960
ds_read_b64_tr_b16 a[216:217], v62 offset:12288
ds_read_b64_tr_b16 a[218:219], v62 offset:12800
s_waitcnt lgkmcnt(9)
v_mfma_f32_16x16x32_bf16 v[224:227], a[192:195], a[196:199], 0
s_waitcnt lgkmcnt(6)
v_mfma_f32_16x16x32_bf16 v[224:227], a[200:203], a[204:207], v[224:227]
s_waitcnt lgkmcnt(3)
v_mfma_f32_16x16x32_bf16 v[224:227], a[208:211], a[212:215], v[224:227]
s_waitcnt lgkmcnt(0)
v_mfma_f32_16x16x32_bf16 v[224:227], a[216:219], a[220:223], v[224:227]
s_mov_b32 exec_lo, 0x00010001
s_mov_b32 exec_hi, 0x00010001
s_nop 5
v_and_or_b32 v224, v224, v228, s76
v_and_or_b32 v225, v225, v228, s77
v_and_or_b32 v226, v226, v228, s78
v_and_or_b32 v227, v227, v228, s79
buffer_store_dwordx4 v[224:227], v229, s[44:47], s57 offen sc1
s_mov_b64 exec, -1
s_mov_b32 s60, 2162944
s_mov_b32 exec_hi, 0
buffer_load_dword v251, v11, s[44:47], s60 offen
s_mov_b32 exec_hi, -1
s_add_u32 m0, s90, 16384
s_nop 0
buffer_load_dwordx4 v5, s[32:35], s82 offen offset:0 nt lds
s_add_u32 s82, s82, 48128
buffer_load_dwordx4 v6, s[32:35], s82 offen offset:1024 nt lds
s_add_u32 s82, s82, 48128
buffer_load_dwordx4 v5, s[32:35], s82 offen offset:2048 nt lds
s_add_u32 s82, s82, 48128
buffer_load_dwordx4 v6, s[32:35], s82 offen offset:3072 nt lds
s_min_u32 s60, s50, 2
s_mul_i32 s92, s51, 3
s_add_u32 s60, s60, s92
s_lshl_b32 s60, s60, 2
s_add_u32 s60, s60, s52
s_mul_i32 s60, s60, 1408
s_mov_b64 exec, 2047
buffer_load_dword v251, v255, s[12:15], s60 offen
s_mov_b64 exec, -1
s_min_u32 s60, s50, 2
s_mul_i32 s92, s51, 3
s_add_u32 s60, s60, s92
s_lshl_b32 s60, s60, 2
s_add_u32 s60, s60, s52
s_mul_i32 s60, s60, 1408
s_mov_b64 exec, 2047
buffer_load_dword v251, v255, s[16:19], s60 offen
s_mov_b64 exec, -1
s_min_u32 s75, s50, 2
s_mul_i32 s60, s51, 3
s_add_u32 s75, s75, s60
s_lshl_b32 s75, s75, 2
s_add_u32 s75, s75, s52
s_lshl_b32 s60, s75, 11
s_cmp_lt_u32 s75, 256
s_cselect_b64 exec, -1, 0
buffer_load_dwordx4 v[164:167], v2, s[20:23], s60 offen
buffer_load_dwordx4 v[172:175], v2, s[20:23], s60 offen offset:1024
s_mov_b64 exec, -1
s_add_u32 m0, s88, 96768
s_add_u32 s3, s3, 98304
buffer_load_dwordx4 v60, s[8:11], s3 offen offset:0 lds
buffer_load_dwordx4 v60, s[8:11], s3 offen offset:1024 lds
buffer_load_dwordx4 v60, s[8:11], s3 offen offset:2048 lds
s_add_u32 m0, s88, 109056
s_add_u32 s3, s3, 98304
s_cmp_eq_u32 s3, 1572864
s_cselect_b32 s3, 0, s3
buffer_load_dwordx4 v60, s[8:11], s3 offen offset:0 lds
buffer_load_dwordx4 v60, s[8:11], s3 offen offset:1024 lds
buffer_load_dwordx4 v60, s[8:11], s3 offen offset:2048 lds
s_lshr_b32 s57, s50, 1
s_lshl_b32 s58, s57, 10
s_bitcmp1_b32 s50, 0
s_cselect_b32 s37, 8, 0
s_cselect_b32 s38, 8, 0
s_lshl_b32 s36, s50, 10
s_add_u32 s36, s36, 2113536
s_add_u32 s37, s37, s58
s_add_u32 s37, s37, 2138112
s_lshl_b32 s57, s57, 8
s_add_u32 s38, s38, s57
s_add_u32 s38, s38, 2161664
s_mov_b32 s34, 0xc000c000
s_bitcmp1_b32 s50, 1
s_cselect_b32 s57, 0, 3
s_cselect_b32 s58, -1, 2
s_cmov_b32 s34, 0x00030003
s_lshl_b32 s39, s51, 1
s_add_u32 s39, s39, s58
s_cmp_lg_u32 s52, s57
s_cselect_b32 s39, 64, s39
s_min_u32 s59, s39, 64
s_lshl_b32 s39, s59, 11
s_lshr_b32 s58, s50, 2
s_lshl_b32 s58, s58, 10
s_add_u32 s39, s39, s58
s_and_b32 s58, s50, 1
s_lshl_b32 s58, s58, 9
s_add_u32 s39, s39, s58
s_add_u32 s39, s39, 131072
s_cmp_eq_u32 s59, 64
s_cselect_b32 s34, 0, s34
s_and_b32 s57, s52, 1
s_lshr_b32 s58, s52, 1
s_cmp_eq_u32 s57, s58
s_cselect_b32 s63, 1, 0
s_cmp_eq_u32 s53, 0
s_cselect_b32 s63, 2, s63
s_cmp_eq_u32 s53, 127
s_cselect_b32 s63, 2, s63
s_lshl_b32 s32, s51, 1
s_add_u32 s32, s32, s57
s_lshl_b32 s32, s32, 11
s_add_u32 s32, s32, 131072
s_mov_b32 s64, 0
s_mov_b32 s66, 0
s_cmp_eq_u32 s52, 0
s_cmov_b32 s64, 0x00010001
s_cmov_b32 s66, 0x00030003
s_cmp_eq_u32 s52, 3
s_cmov_b32 s64, 0x80008000
s_cmov_b32 s66, 0xc000c000
s_mov_b32 s65, s64
s_mov_b32 s67, s66
s_not_b64 s[68:69], s[64:65]
s_not_b64 s[70:71], s[66:67]
s_lshl_b32 s33, s53, 14
s_lshl_b32 s58, s50, 7
s_add_u32 s33, s33, s58
s_lshr_b32 s57, s50, 1
s_mul_i32 s57, s57, 704
s_bitcmp1_b32 s50, 0
s_cselect_b32 s92, 384, 0
s_mov_b32 s93, 256
s_cmov_b32 s93, -96
s_cmp_eq_u32 s50, 7
s_cselect_b32 s92, 320, s92
s_add_u32 s92, s92, s57
s_cmp_ge_u32 s50, 6
s_cselect_b32 s93, 2147483648, s93
s_mul_i32 s57, s52, 22016
s_add_u32 s92, s92, s57
v_lshlrev_b32 v5, 1, v3
v_and_b32 v6, 7, v1
v_xor_b32 v5, v5, v6
v_lshrrev_b32 v6, 3, v1
v_mul_u32_u24 v6, 2752, v6
v_lshl_add_u32 v6, v5, 4, v6
v_add_u32 v44, s92, v6
v_mov_b32 v7, 256
v_mov_b32 v8, s93
v_cmp_le_u32 vcc, 4, v5
s_nop 1
v_cndmask_b32 v7, v7, v8, vcc
v_bfrev_b32 v8, 1
v_cmp_le_u32 vcc, 6, v5
s_nop 1
v_cndmask_b32 v7, v7, v8, vcc
v_add_u32 v45, v44, v7
s_mul_i32 s57, s50, 5
s_add_u32 s57, s57, s52
v_lshl_add_u32 v5, v1, 2, s57
v_subrev_u32 v6, 40, v5
v_min_u32 v5, v5, v6
v_add_u32 v6, 5, v5
v_mul_u32_u24 v6, 205, v6
v_lshrrev_b32 v6, 11, v6
v_min_u32 v6, 3, v6
v_add_lshl_u32 v13, v5, v6, 15
s_mul_i32 s57, s52, 360448
s_add_u32 s57, s57, 163840
v_writelane_b32 v13, s57, 10
s_add_u32 m0, s88, 121344
s_add_u32 s3, s3, 98304
buffer_load_dwordx4 v60, s[8:11], s3 offen offset:0 lds
buffer_load_dwordx4 v60, s[8:11], s3 offen offset:1024 lds
buffer_load_dwordx4 v60, s[8:11], s3 offen offset:2048 lds
s_mul_i32 s57, s49, 12288
s_lshl_b32 s58, s73, 2
s_add_u32 s57, s57, s58
s_lshl_b32 s58, s52, 6
s_add_u32 s57, s57, s58
s_add_u32 s57, s57, 16384
s_waitcnt vmcnt(13)
s_barrier
ds_read_b64_tr_b16 a[192:193], v62 offset:16384
ds_read_b64_tr_b16 a[194:195], v62 offset:16896
ds_read_b64_tr_b16 a[200:201], v62 offset:20480
ds_read_b64_tr_b16 a[202:203], v62 offset:20992
ds_read_b64_tr_b16 a[208:209], v62 offset:24576
ds_read_b64_tr_b16 a[210:211], v62 offset:25088
ds_read_b64_tr_b16 a[216:217], v62 offset:28672
ds_read_b64_tr_b16 a[218:219], v62 offset:29184
s_waitcnt lgkmcnt(6)
v_mfma_f32_16x16x32_bf16 v[224:227], a[192:195], a[196:199], 0
s_waitcnt lgkmcnt(4)
v_mfma_f32_16x16x32_bf16 v[224:227], a[200:203], a[204:207], v[224:227]
s_waitcnt lgkmcnt(2)
v_mfma_f32_16x16x32_bf16 v[224:227], a[208:211], a[212:215], v[224:227]
s_waitcnt lgkmcnt(0)
v_mfma_f32_16x16x32_bf16 v[224:227], a[216:219], a[220:223], v[224:227]
s_mov_b32 exec_lo, 0x00010001
s_mov_b32 exec_hi, 0x00010001
s_nop 5
v_and_or_b32 v224, v224, v228, s76
v_and_or_b32 v225, v225, v228, s77
v_and_or_b32 v226, v226, v228, s78
v_and_or_b32 v227, v227, v228, s79
buffer_store_dwordx4 v[224:227], v229, s[44:47], s57 offen sc1
s_mov_b64 exec, -1
s_waitcnt vmcnt(10)
v_lshlrev_b32 v160, 16, v164
v_and_b32 v161, s94, v164
v_lshlrev_b32 v162, 16, v165
v_and_b32 v163, s94, v165
v_lshlrev_b32 v164, 16, v166
v_and_b32 v165, s94, v166
v_lshlrev_b32 v166, 16, v167
v_and_b32 v167, s94, v167
v_pk_add_f32 v[160:161], v[160:161], v[162:163]
v_pk_add_f32 v[164:165], v[164:165], v[166:167]
v_pk_add_f32 v[160:161], v[160:161], v[164:165]
v_lshlrev_b32 v168, 16, v172
v_and_b32 v169, s94, v172
v_lshlrev_b32 v170, 16, v173
v_and_b32 v171, s94, v173
v_lshlrev_b32 v172, 16, v174
v_and_b32 v173, s94, v174
v_lshlrev_b32 v174, 16, v175
v_and_b32 v175, s94, v175
v_pk_add_f32 v[168:169], v[168:169], v[170:171]
v_pk_add_f32 v[172:173], v[172:173], v[174:175]
v_pk_add_f32 v[168:169], v[168:169], v[172:173]
v_add_f32 v160, v160, v161
v_add_f32 v162, v168, v169
s_lshl_b32 s60, s75, 4
v_add_f32_dpp v160, v160, v160 row_ror:8 row_mask:0xf bank_mask:0xf
v_add_f32_dpp v162, v162, v162 row_ror:8 row_mask:0xf bank_mask:0xf
s_nop 0
v_add_f32_dpp v160, v160, v160 row_ror:4 row_mask:0xf bank_mask:0xf
v_add_f32_dpp v162, v162, v162 row_ror:4 row_mask:0xf bank_mask:0xf
s_nop 0
v_add_f32_dpp v160, v160, v160 row_ror:2 row_mask:0xf bank_mask:0xf
v_add_f32_dpp v162, v162, v162 row_ror:2 row_mask:0xf bank_mask:0xf
s_nop 0
v_add_f32_dpp v160, v160, v160 row_ror:1 row_mask:0xf bank_mask:0xf
v_add_f32_dpp v162, v162, v162 row_ror:1 row_mask:0xf bank_mask:0xf
v_mov_b32 v161, v160
v_mov_b32 v163, v162
s_nop 0
v_permlane32_swap_b32 v160, v161
v_permlane32_swap_b32 v162, v163
v_add_f32 v160, v160, v161
v_add_f32 v162, v162, v163
v_mov_b32 v161, v160
v_mov_b32 v163, v162
s_nop 0
v_permlane16_swap_b32 v160, v161
v_permlane16_swap_b32 v162, v163
v_add_f32 v160, v160, v161
v_add_f32 v162, v162, v163
s_add_u32 s60, s60, 65536
v_mul_f32 v160, s91, v160
v_mul_f32 v162, s91, v162
v_mov_b32 v161, v9
v_mov_b32 v163, v9
s_cmp_lt_u32 s75, 256
s_cselect_b64 exec, 1, 0
buffer_store_dwordx4 v[160:163], v10, s[44:47], s60 offen sc1
s_mov_b64 exec, -1
s_add_u32 m0, s88, 133632
s_add_u32 s3, s3, 98304
s_cmp_eq_u32 s3, 1572864
s_cselect_b32 s3, 0, s3
buffer_load_dwordx4 v60, s[8:11], s3 offen offset:0 lds
buffer_load_dwordx4 v60, s[8:11], s3 offen offset:1024 lds
buffer_load_dwordx4 v60, s[8:11], s3 offen offset:2048 lds
s_add_u32 m0, s88, 145920
s_add_u32 s3, s3, 98304
buffer_load_dwordx4 v60, s[8:11], s3 offen offset:0 lds
buffer_load_dwordx4 v60, s[8:11], s3 offen offset:1024 lds
buffer_load_dwordx4 v60, s[8:11], s3 offen offset:2048 lds
s_waitcnt vmcnt(9)
s_barrier
ds_read_b64_tr_b16 a[4:5], v16 offset:1024
ds_read_b64_tr_b16 a[6:7], v16 offset:1536
ds_read_b64_tr_b16 a[8:9], v16 offset:2048
ds_read_b64_tr_b16 a[10:11], v16 offset:2560
ds_read_b64_tr_b16 a[0:1], v16 offset:0
ds_read_b64_tr_b16 a[2:3], v16 offset:512
ds_read_b64_tr_b16 a[16:17], v16 offset:13312
ds_read_b64_tr_b16 a[18:19], v16 offset:13824
ds_read_b64_tr_b16 a[20:21], v16 offset:14336
ds_read_b64_tr_b16 a[22:23], v16 offset:14848
ds_read_b64_tr_b16 a[12:13], v16 offset:12288
ds_read_b64_tr_b16 a[14:15], v16 offset:12800
ds_read_b64_tr_b16 a[28:29], v16 offset:25600
ds_read_b64_tr_b16 a[30:31], v16 offset:26112
ds_read_b64_tr_b16 a[32:33], v16 offset:26624
ds_read_b64_tr_b16 a[34:35], v16 offset:27136
ds_read_b64_tr_b16 a[24:25], v16 offset:24576
ds_read_b64_tr_b16 a[26:27], v16 offset:25088
s_add_u32 m0, s88, 33792
s_add_u32 s3, s3, 98304
s_cmp_eq_u32 s3, 1572864
s_cselect_b32 s3, 0, s3
buffer_load_dwordx4 v60, s[8:11], s3 offen offset:0 lds
buffer_load_dwordx4 v60, s[8:11], s3 offen offset:1024 lds
buffer_load_dwordx4 v60, s[8:11], s3 offen offset:2048 lds
s_add_u32 m0, s88, 46080
s_add_u32 s3, s3, 98304
buffer_load_dwordx4 v60, s[8:11], s3 offen offset:0 lds
buffer_load_dwordx4 v60, s[8:11], s3 offen offset:1024 lds
buffer_load_dwordx4 v60, s[8:11], s3 offen offset:2048 lds
s_add_u32 m0, s88, 58368
s_add_u32 s3, s3, 98304
s_cmp_eq_u32 s3, 1572864
s_cselect_b32 s3, 0, s3
buffer_load_dwordx4 v60, s[8:11], s3 offen offset:0 lds
buffer_load_dwordx4 v60, s[8:11], s3 offen offset:1024 lds
buffer_load_dwordx4 v60, s[8:11], s3 offen offset:2048 lds
s_waitcnt vmcnt(9)
s_waitcnt lgkmcnt(0)
s_barrier
ds_read_b64_tr_b16 a[40:41], v17 offset:1024
ds_read_b64_tr_b16 a[42:43], v17 offset:1536
ds_read_b64_tr_b16 a[44:45], v17 offset:2048
ds_read_b64_tr_b16 a[46:47], v17 offset:2560
ds_read_b64_tr_b16 a[36:37], v17 offset:0
ds_read_b64_tr_b16 a[38:39], v17 offset:512
ds_read_b64_tr_b16 a[52:53], v17 offset:13312
ds_read_b64_tr_b16 a[54:55], v17 offset:13824
ds_read_b64_tr_b16 a[56:57], v17 offset:14336
ds_read_b64_tr_b16 a[58:59], v17 offset:14848
ds_read_b64_tr_b16 a[48:49], v17 offset:12288
ds_read_b64_tr_b16 a[50:51], v17 offset:12800
ds_read_b64_tr_b16 a[64:65], v17 offset:25600
ds_read_b64_tr_b16 a[66:67], v17 offset:26112
ds_read_b64_tr_b16 a[68:69], v17 offset:26624
ds_read_b64_tr_b16 a[70:71], v17 offset:27136
ds_read_b64_tr_b16 a[60:61], v17 offset:24576
ds_read_b64_tr_b16 a[62:63], v17 offset:25088
s_add_u32 m0, s88, 70656
s_add_u32 s3, s3, 98304
buffer_load_dwordx4 v60, s[8:11], s3 offen offset:0 lds
buffer_load_dwordx4 v60, s[8:11], s3 offen offset:1024 lds
buffer_load_dwordx4 v60, s[8:11], s3 offen offset:2048 lds
s_waitcnt vmcnt(9)
s_waitcnt lgkmcnt(0)
s_barrier
ds_read_b64_tr_b16 a[76:77], v19 offset:1024
ds_read_b64_tr_b16 a[78:79], v19 offset:1536
ds_read_b64_tr_b16 a[80:81], v19 offset:2048
ds_read_b64_tr_b16 a[82:83], v19 offset:2560
ds_read_b64_tr_b16 a[72:73], v19 offset:0
ds_read_b64_tr_b16 a[74:75], v19 offset:512
s_add_u32 m0, s88, 84480
s_add_u32 s3, s3, 98304
s_cmp_eq_u32 s3, 1572864
s_cselect_b32 s3, 0, s3
buffer_load_dwordx4 v60, s[8:11], s3 offen offset:0 lds
buffer_load_dwordx4 v60, s[8:11], s3 offen offset:1024 lds
buffer_load_dwordx4 v60, s[8:11], s3 offen offset:2048 lds
s_waitcnt vmcnt(9)
s_waitcnt lgkmcnt(0)
s_barrier
ds_read_b64_tr_b16 a[88:89], v19 offset:13312
ds_read_b64_tr_b16 a[90:91], v19 offset:13824
ds_read_b64_tr_b16 a[92:93], v19 offset:14336
ds_read_b64_tr_b16 a[94:95], v19 offset:14848
ds_read_b64_tr_b16 a[84:85], v19 offset:12288
ds_read_b64_tr_b16 a[86:87], v19 offset:12800
s_add_u32 m0, s88, 96768
s_add_u32 s3, s3, 98304
buffer_load_dwordx4 v60, s[8:11], s3 offen offset:0 lds
buffer_load_dwordx4 v60, s[8:11], s3 offen offset:1024 lds
buffer_load_dwordx4 v60, s[8:11], s3 offen offset:2048 lds
s_add_u32 m0, s88, 109056
s_add_u32 s3, s3, 98304
s_cmp_eq_u32 s3, 1572864
s_cselect_b32 s3, 0, s3
buffer_load_dwordx4 v60, s[8:11], s3 offen offset:0 lds
buffer_load_dwordx4 v60, s[8:11], s3 offen offset:1024 lds
buffer_load_dwordx4 v60, s[8:11], s3 offen offset:2048 lds
s_add_u32 m0, s88, 121344
s_add_u32 s3, s3, 98304
buffer_load_dwordx4 v60, s[8:11], s3 offen offset:0 lds
buffer_load_dwordx4 v60, s[8:11], s3 offen offset:1024 lds
buffer_load_dwordx4 v60, s[8:11], s3 offen offset:2048 lds
s_add_u32 m0, s88, 133632
s_add_u32 s3, s3, 98304
s_cmp_eq_u32 s3, 1572864
s_cselect_b32 s3, 0, s3
buffer_load_dwordx4 v60, s[8:11], s3 offen offset:0 lds
buffer_load_dwordx4 v60, s[8:11], s3 offen offset:1024 lds
buffer_load_dwordx4 v60, s[8:11], s3 offen offset:2048 lds
s_add_u32 m0, s88, 145920
s_add_u32 s3, s3, 98304
buffer_load_dwordx4 v60, s[8:11], s3 offen offset:0 lds
buffer_load_dwordx4 v60, s[8:11], s3 offen offset:1024 lds
buffer_load_dwordx4 v60, s[8:11], s3 offen offset:2048 lds
s_waitcnt vmcnt(9)
s_waitcnt lgkmcnt(0)
s_barrier
ds_read_b64_tr_b16 a[100:101], v19 offset:25600
ds_read_b64_tr_b16 a[102:103], v19 offset:26112
ds_read_b64_tr_b16 a[104:105], v19 offset:26624
ds_read_b64_tr_b16 a[106:107], v19 offset:27136
ds_read_b64_tr_b16 a[96:97], v19 offset:24576
ds_read_b64_tr_b16 a[98:99], v19 offset:25088
ds_read_b64_tr_b16 a[112:113], v19 offset:37888
ds_read_b64_tr_b16 a[114:115], v19 offset:38400
ds_read_b64_tr_b16 a[116:117], v19 offset:38912
ds_read_b64_tr_b16 a[118:119], v19 offset:39424
ds_read_b64_tr_b16 a[108:109], v19 offset:36864
ds_read_b64_tr_b16 a[110:111], v19 offset:37376
s_lshl_b32 s57, s2, 2
s_or_b32 s57, s57, s52
s_cmp_lg_u32 s57, 224
s_cbranch_scc1 noep_1
s_mov_b32 s57, 4096
s_mov_b32 s58, 8192
buffer_load_dwordx4 v[64:67], v2, s[44:47], s57 offen offset:0 sc1
buffer_load_dwordx4 v[68:71], v2, s[44:47], s57 offen offset:1024 sc1
buffer_load_dwordx4 v[72:75], v2, s[44:47], s57 offen offset:2048 sc1
buffer_load_dwordx4 v[76:79], v2, s[44:47], s57 offen offset:3072 sc1
buffer_load_dwordx4 v[80:83], v2, s[44:47], s58 offen offset:0 sc1
buffer_load_dwordx4 v[84:87], v2, s[44:47], s58 offen offset:1024 sc1
buffer_load_dwordx4 v[88:91], v2, s[44:47], s58 offen offset:2048 sc1
buffer_load_dwordx4 v[92:95], v2, s[44:47], s58 offen offset:3072 sc1
s_waitcnt vmcnt(0)
v_xor_b32 v100, v65, v9
v_bitop3_b32 v100, v100, v67, v9 bitop3:0xf6
v_bitop3_b32 v100, v100, v69, v9 bitop3:0xf6
v_bitop3_b32 v100, v100, v71, v9 bitop3:0xf6
v_bitop3_b32 v100, v100, v73, v9 bitop3:0xf6
v_bitop3_b32 v100, v100, v75, v9 bitop3:0xf6
v_bitop3_b32 v100, v100, v77, v9 bitop3:0xf6
v_bitop3_b32 v100, v100, v79, v9 bitop3:0xf6
v_bitop3_b32 v100, v100, v81, v9 bitop3:0xf6
v_bitop3_b32 v100, v100, v83, v9 bitop3:0xf6
v_bitop3_b32 v100, v100, v85, v9 bitop3:0xf6
v_bitop3_b32 v100, v100, v87, v9 bitop3:0xf6
v_bitop3_b32 v100, v100, v89, v9 bitop3:0xf6
v_bitop3_b32 v100, v100, v91, v9 bitop3:0xf6
v_bitop3_b32 v100, v100, v93, v9 bitop3:0xf6
v_bitop3_b32 v100, v100, v95, v9 bitop3:0xf6
v_cmp_ne_u32 vcc, 0, v100
s_cbranch_vccz go_2
retry_3:
s_sub_u32 s56, s56, 1
s_cbranch_scc1 L_end
s_sleep 4
buffer_load_dwordx4 v[64:67], v2, s[44:47], s57 offen offset:0 sc1
buffer_load_dwordx4 v[68:71], v2, s[44:47], s57 offen offset:1024 sc1
buffer_load_dwordx4 v[72:75], v2, s[44:47], s57 offen offset:2048 sc1
buffer_load_dwordx4 v[76:79], v2, s[44:47], s57 offen offset:3072 sc1
buffer_load_dwordx4 v[80:83], v2, s[44:47], s58 offen offset:0 sc1
buffer_load_dwordx4 v[84:87], v2, s[44:47], s58 offen offset:1024 sc1
buffer_load_dwordx4 v[88:91], v2, s[44:47], s58 offen offset:2048 sc1
buffer_load_dwordx4 v[92:95], v2, s[44:47], s58 offen offset:3072 sc1
s_waitcnt vmcnt(0)
v_xor_b32 v100, v65, v9
v_bitop3_b32 v100, v100, v67, v9 bitop3:0xf6
v_bitop3_b32 v100, v100, v69, v9 bitop3:0xf6
v_bitop3_b32 v100, v100, v71, v9 bitop3:0xf6
v_bitop3_b32 v100, v100, v73, v9 bitop3:0xf6
v_bitop3_b32 v100, v100, v75, v9 bitop3:0xf6
v_bitop3_b32 v100, v100, v77, v9 bitop3:0xf6
v_bitop3_b32 v100, v100, v79, v9 bitop3:0xf6
v_bitop3_b32 v100, v100, v81, v9 bitop3:0xf6
v_bitop3_b32 v100, v100, v83, v9 bitop3:0xf6
v_bitop3_b32 v100, v100, v85, v9 bitop3:0xf6
v_bitop3_b32 v100, v100, v87, v9 bitop3:0xf6
v_bitop3_b32 v100, v100, v89, v9 bitop3:0xf6
v_bitop3_b32 v100, v100, v91, v9 bitop3:0xf6
v_bitop3_b32 v100, v100, v93, v9 bitop3:0xf6
v_bitop3_b32 v100, v100, v95, v9 bitop3:0xf6
v_cmp_ne_u32 vcc, 0, v100
s_cbranch_vccnz retry_3
go_2:
s_mov_b64 exec, 1
buffer_store_dword v9, v10, s[44:47], 0 offen sc1
s_mov_b64 exec, -1
noep_1:
s_waitcnt lgkmcnt(0)
s_branch L_join
L_pathB:
s_mov_b32 s60, 2162944
s_mov_b32 exec_hi, 0
buffer_load_dword v251, v11, s[44:47], s60 offen
s_mov_b32 exec_hi, -1
s_lshr_b32 s57, s50, 1
s_lshl_b32 s58, s57, 10
s_bitcmp1_b32 s50, 0
s_cselect_b32 s37, 8, 0
s_cselect_b32 s38, 8, 0
s_lshl_b32 s36, s50, 10
s_add_u32 s36, s36, 2113536
s_add_u32 s37, s37, s58
s_add_u32 s37, s37, 2138112
s_lshl_b32 s57, s57, 8
s_add_u32 s38, s38, s57
s_add_u32 s38, s38, 2161664
s_mov_b32 s34, 0xc000c000
s_bitcmp1_b32 s50, 1
s_cselect_b32 s57, 0, 3
s_cselect_b32 s58, -1, 2
s_cmov_b32 s34, 0x00030003
s_lshl_b32 s39, s51, 1
s_add_u32 s39, s39, s58
s_cmp_lg_u32 s52, s57
s_cselect_b32 s39, 64, s39
s_min_u32 s59, s39, 64
s_lshl_b32 s39, s59, 11
s_lshr_b32 s58, s50, 2
s_lshl_b32 s58, s58, 10
s_add_u32 s39, s39, s58
s_and_b32 s58, s50, 1
s_lshl_b32 s58, s58, 9
s_add_u32 s39, s39, s58
s_add_u32 s39, s39, 131072
s_cmp_eq_u32 s59, 64
s_cselect_b32 s34, 0, s34
s_and_b32 s57, s52, 1
s_lshr_b32 s58, s52, 1
s_cmp_eq_u32 s57, s58
s_cselect_b32 s63, 1, 0
s_cmp_eq_u32 s53, 0
s_cselect_b32 s63, 2, s63
s_cmp_eq_u32 s53, 127
s_cselect_b32 s63, 2, s63
s_lshl_b32 s32, s51, 1
s_add_u32 s32, s32, s57
s_lshl_b32 s32, s32, 11
s_add_u32 s32, s32, 131072
s_mov_b32 s64, 0
s_mov_b32 s66, 0
s_cmp_eq_u32 s52, 0
s_cmov_b32 s64, 0x00010001
s_cmov_b32 s66, 0x00030003
s_cmp_eq_u32 s52, 3
s_cmov_b32 s64, 0x80008000
s_cmov_b32 s66, 0xc000c000
s_mov_b32 s65, s64
s_mov_b32 s67, s66
s_not_b64 s[68:69], s[64:65]
s_not_b64 s[70:71], s[66:67]
s_lshl_b32 s33, s53, 14
s_lshl_b32 s58, s50, 7
s_add_u32 s33, s33, s58
s_lshr_b32 s57, s50, 1
s_mul_i32 s57, s57, 704
s_bitcmp1_b32 s50, 0
s_cselect_b32 s92, 384, 0
s_mov_b32 s93, 256
s_cmov_b32 s93, -96
s_cmp_eq_u32 s50, 7
s_cselect_b32 s92, 320, s92
s_add_u32 s92, s92, s57
s_cmp_ge_u32 s50, 6
s_cselect_b32 s93, 2147483648, s93
s_mul_i32 s57, s52, 22016
s_add_u32 s92, s92, s57
v_lshlrev_b32 v5, 1, v3
v_and_b32 v6, 7, v1
v_xor_b32 v5, v5, v6
v_lshrrev_b32 v6, 3, v1
v_mul_u32_u24 v6, 2752, v6
v_lshl_add_u32 v6, v5, 4, v6
v_add_u32 v44, s92, v6
v_mov_b32 v7, 256
v_mov_b32 v8, s93
v_cmp_le_u32 vcc, 4, v5
s_nop 1
v_cndmask_b32 v7, v7, v8, vcc
v_bfrev_b32 v8, 1
v_cmp_le_u32 vcc, 6, v5
s_nop 1
v_cndmask_b32 v7, v7, v8, vcc
v_add_u32 v45, v44, v7
s_mul_i32 s57, s50, 5
s_add_u32 s57, s57, s52
v_lshl_add_u32 v5, v1, 2, s57
v_subrev_u32 v6, 40, v5
v_min_u32 v5, v5, v6
v_add_u32 v6, 5, v5
v_mul_u32_u24 v6, 205, v6
v_lshrrev_b32 v6, 11, v6
v_min_u32 v6, 3, v6
v_add_lshl_u32 v13, v5, v6, 15
s_mul_i32 s57, s52, 360448
s_add_u32 s57, s57, 163840
v_writelane_b32 v13, s57, 10
s_add_u32 m0, s88, 96768
s_add_u32 s3, s3, 98304
buffer_load_dwordx4 v60, s[8:11], s3 offen offset:0 lds
buffer_load_dwordx4 v60, s[8:11], s3 offen offset:1024 lds
buffer_load_dwordx4 v60, s[8:11], s3 offen offset:2048 lds
s_waitcnt vmcnt(12)
s_add_u32 m0, s88, 109056
s_add_u32 s3, s3, 98304
s_cmp_eq_u32 s3, 1572864
s_cselect_b32 s3, 0, s3
buffer_load_dwordx4 v60, s[8:11], s3 offen offset:0 lds
v_lshlrev_b32 v64, 16, v68
v_and_b32 v65, s94, v68
v_lshlrev_b32 v66, 16, v69
v_and_b32 v67, s94, v69
v_lshlrev_b32 v68, 16, v70
v_and_b32 v69, s94, v70
v_lshlrev_b32 v70, 16, v71
v_and_b32 v71, s94, v71
v_pk_add_f32 v[120:121], v[64:65], v[66:67]
v_pk_mul_f32 v[122:123], v[64:65], v[64:65]
v_pk_add_f32 v[120:121], v[120:121], v[68:69]
v_pk_fma_f32 v[122:123], v[66:67], v[66:67], v[122:123]
v_pk_add_f32 v[120:121], v[120:121], v[70:71]
v_pk_fma_f32 v[122:123], v[68:69], v[68:69], v[122:123]
v_pk_fma_f32 v[122:123], v[70:71], v[70:71], v[122:123]
v_add_f32 v112, v120, v121
v_add_f32 v116, v122, v123
v_lshlrev_b32 v72, 16, v76
v_and_b32 v73, s94, v76
v_lshlrev_b32 v74, 16, v77
v_and_b32 v75, s94, v77
buffer_load_dwordx4 v60, s[8:11], s3 offen offset:1024 lds
v_lshlrev_b32 v76, 16, v78
v_and_b32 v77, s94, v78
v_lshlrev_b32 v78, 16, v79
v_and_b32 v79, s94, v79
v_pk_add_f32 v[120:121], v[72:73], v[74:75]
v_pk_mul_f32 v[122:123], v[72:73], v[72:73]
v_pk_add_f32 v[120:121], v[120:121], v[76:77]
v_pk_fma_f32 v[122:123], v[74:75], v[74:75], v[122:123]
v_pk_add_f32 v[120:121], v[120:121], v[78:79]
v_pk_fma_f32 v[122:123], v[76:77], v[76:77], v[122:123]
v_pk_fma_f32 v[122:123], v[78:79], v[78:79], v[122:123]
v_add_f32 v113, v120, v121
v_add_f32 v117, v122, v123
v_lshlrev_b32 v80, 16, v84
v_and_b32 v81, s94, v84
v_lshlrev_b32 v82, 16, v85
v_and_b32 v83, s94, v85
v_lshlrev_b32 v84, 16, v86
v_and_b32 v85, s94, v86
v_lshlrev_b32 v86, 16, v87
buffer_load_dwordx4 v60, s[8:11], s3 offen offset:2048 lds
v_and_b32 v87, s94, v87
v_pk_add_f32 v[120:121], v[80:81], v[82:83]
v_pk_mul_f32 v[122:123], v[80:81], v[80:81]
v_pk_add_f32 v[120:121], v[120:121], v[84:85]
v_pk_fma_f32 v[122:123], v[82:83], v[82:83], v[122:123]
v_pk_add_f32 v[120:121], v[120:121], v[86:87]
v_pk_fma_f32 v[122:123], v[84:85], v[84:85], v[122:123]
v_pk_fma_f32 v[122:123], v[86:87], v[86:87], v[122:123]
v_add_f32 v114, v120, v121
v_add_f32 v118, v122, v123
v_lshlrev_b32 v88, 16, v92
v_and_b32 v89, s94, v92
v_lshlrev_b32 v90, 16, v93
v_and_b32 v91, s94, v93
v_lshlrev_b32 v92, 16, v94
v_and_b32 v93, s94, v94
v_lshlrev_b32 v94, 16, v95
v_and_b32 v95, s94, v95
v_pk_add_f32 v[120:121], v[88:89], v[90:91]
v_pk_mul_f32 v[122:123], v[88:89], v[88:89]
s_add_u32 m0, s88, 121344
s_add_u32 s3, s3, 98304
buffer_load_dwordx4 v60, s[8:11], s3 offen offset:0 lds
v_pk_add_f32 v[120:121], v[120:121], v[92:93]
v_pk_fma_f32 v[122:123], v[90:91], v[90:91], v[122:123]
v_pk_add_f32 v[120:121], v[120:121], v[94:95]
v_pk_fma_f32 v[122:123], v[92:93], v[92:93], v[122:123]
v_pk_fma_f32 v[122:123], v[94:95], v[94:95], v[122:123]
v_add_f32 v115, v120, v121
v_add_f32 v119, v122, v123
v_permlane32_swap_b32 v112, v113
v_permlane32_swap_b32 v114, v115
v_permlane32_swap_b32 v116, v117
v_permlane32_swap_b32 v118, v119
v_add_f32 v112, v112, v113
v_add_f32 v114, v114, v115
v_add_f32 v116, v116, v117
v_add_f32 v118, v118, v119
v_permlane16_swap_b32 v112, v114
s_nop 0
v_permlane16_swap_b32 v116, v118
v_add_f32 v112, v112, v114
v_add_f32 v116, v116, v118
s_nop 0
v_add_f32_dpp v112, v112, v112 row_ror:8 row_mask:0xf bank_mask:0xf
buffer_load_dwordx4 v60, s[8:11], s3 offen offset:1024 lds
v_add_f32_dpp v116, v116, v116 row_ror:8 row_mask:0xf bank_mask:0xf
v_add_f32_dpp v112, v112, v112 row_ror:4 row_mask:0xf bank_mask:0xf
s_nop 0
v_add_f32_dpp v116, v116, v116 row_ror:4 row_mask:0xf bank_mask:0xf
v_add_f32_dpp v112, v112, v112 row_ror:2 row_mask:0xf bank_mask:0xf
s_nop 0
v_add_f32_dpp v116, v116, v116 row_ror:2 row_mask:0xf bank_mask:0xf
v_add_f32_dpp v112, v112, v112 row_ror:1 row_mask:0xf bank_mask:0xf
s_nop 0
v_add_f32_dpp v116, v116, v116 row_ror:1 row_mask:0xf bank_mask:0xf
v_mov_b32 v113, 0x3727c5ac
v_mul_f32 v112, s91, v112
v_fma_f32 v113, -v112, v112, v113
v_fma_f32 v116, v116, s91, v113
v_rsq_f32 v116, v116
s_nop 0
v_mul_f32_e64 v112, -v112, v116
v_readlane_b32 s80, v116, 0
v_readlane_b32 s81, v112, 0
s_nop 1
v_pk_fma_f32 v[64:65], v[64:65], s[80:81], s[80:81] op_sel:[0,0,1] op_sel_hi:[1,0,1]
v_pk_fma_f32 v[66:67], v[66:67], s[80:81], s[80:81] op_sel:[0,0,1] op_sel_hi:[1,0,1]
v_pk_fma_f32 v[68:69], v[68:69], s[80:81], s[80:81] op_sel:[0,0,1] op_sel_hi:[1,0,1]
v_pk_fma_f32 v[70:71], v[70:71], s[80:81], s[80:81] op_sel:[0,0,1] op_sel_hi:[1,0,1]
v_readlane_b32 s80, v116, 32
buffer_load_dwordx4 v60, s[8:11], s3 offen offset:2048 lds
v_readlane_b32 s81, v112, 32
s_nop 1
v_pk_fma_f32 v[72:73], v[72:73], s[80:81], s[80:81] op_sel:[0,0,1] op_sel_hi:[1,0,1]
v_pk_fma_f32 v[74:75], v[74:75], s[80:81], s[80:81] op_sel:[0,0,1] op_sel_hi:[1,0,1]
v_pk_fma_f32 v[76:77], v[76:77], s[80:81], s[80:81] op_sel:[0,0,1] op_sel_hi:[1,0,1]
v_pk_fma_f32 v[78:79], v[78:79], s[80:81], s[80:81] op_sel:[0,0,1] op_sel_hi:[1,0,1]
v_readlane_b32 s80, v116, 16
v_readlane_b32 s81, v112, 16
s_nop 1
v_pk_fma_f32 v[80:81], v[80:81], s[80:81], s[80:81] op_sel:[0,0,1] op_sel_hi:[1,0,1]
v_pk_fma_f32 v[82:83], v[82:83], s[80:81], s[80:81] op_sel:[0,0,1] op_sel_hi:[1,0,1]
v_pk_fma_f32 v[84:85], v[84:85], s[80:81], s[80:81] op_sel:[0,0,1] op_sel_hi:[1,0,1]
v_pk_fma_f32 v[86:87], v[86:87], s[80:81], s[80:81] op_sel:[0,0,1] op_sel_hi:[1,0,1]
v_readlane_b32 s80, v116, 48
v_readlane_b32 s81, v112, 48
s_nop 1
v_pk_fma_f32 v[88:89], v[88:89], s[80:81], s[80:81] op_sel:[0,0,1] op_sel_hi:[1,0,1]
v_pk_fma_f32 v[90:91], v[90:91], s[80:81], s[80:81] op_sel:[0,0,1] op_sel_hi:[1,0,1]
v_pk_fma_f32 v[92:93], v[92:93], s[80:81], s[80:81] op_sel:[0,0,1] op_sel_hi:[1,0,1]
v_pk_fma_f32 v[94:95], v[94:95], s[80:81], s[80:81] op_sel:[0,0,1] op_sel_hi:[1,0,1]
v_lshlrev_b32 v146, 4, v0
v_add_u32 v150, 158208, v146
v_add_u32 v146, 16384, v146
v_add_u32 v147, 24576, v146
s_mov_b32 s82, 12288
v_and_b32 v148, 7, v1
s_lshl_b32 s58, s51, 8
s_add_u32 s58, s58, 4096
v_lshl_add_u32 v148, v148, 5, s58
v_lshlrev_b32 v149, 5, v1
v_add_u32 v149, 158208, v149
s_cmp_ge_u32 s52, 2
s_cselect_b32 s83, 1.0, 0
s_add_u32 m0, s88, 133632
s_add_u32 s3, s3, 98304
s_cmp_eq_u32 s3, 1572864
s_cselect_b32 s3, 0, s3
buffer_load_dwordx4 v60, s[8:11], s3 offen offset:0 lds
buffer_load_dwordx4 v60, s[8:11], s3 offen offset:1024 lds
buffer_load_dwordx4 v60, s[8:11], s3 offen offset:2048 lds
s_add_u32 m0, s88, 145920
s_add_u32 s3, s3, 98304
buffer_load_dwordx4 v60, s[8:11], s3 offen offset:0 lds
buffer_load_dwordx4 v60, s[8:11], s3 offen offset:1024 lds
buffer_load_dwordx4 v60, s[8:11], s3 offen offset:2048 lds
s_waitcnt vmcnt(9)
s_barrier
ds_read_b64_tr_b16 a[4:5], v16 offset:1024
ds_read_b64_tr_b16 a[6:7], v16 offset:1536
ds_read_b64_tr_b16 a[8:9], v16 offset:2048
ds_read_b64_tr_b16 a[10:11], v16 offset:2560
ds_read_b64_tr_b16 a[0:1], v16 offset:0
ds_read_b64_tr_b16 a[2:3], v16 offset:512
ds_read_b64_tr_b16 a[16:17], v16 offset:13312
ds_read_b64_tr_b16 a[18:19], v16 offset:13824
ds_read_b64_tr_b16 a[20:21], v16 offset:14336
ds_read_b64_tr_b16 a[22:23], v16 offset:14848
ds_read_b64_tr_b16 a[12:13], v16 offset:12288
ds_read_b64_tr_b16 a[14:15], v16 offset:12800
ds_read_b64_tr_b16 a[28:29], v16 offset:25600
ds_read_b64_tr_b16 a[30:31], v16 offset:26112
ds_read_b64_tr_b16 a[32:33], v16 offset:26624
ds_read_b64_tr_b16 a[34:35], v16 offset:27136
ds_read_b64_tr_b16 a[24:25], v16 offset:24576
ds_read_b64_tr_b16 a[26:27], v16 offset:25088
s_add_u32 m0, s88, 33792
s_add_u32 s3, s3, 98304
s_cmp_eq_u32 s3, 1572864
s_cselect_b32 s3, 0, s3
buffer_load_dwordx4 v60, s[8:11], s3 offen offset:0 lds
buffer_load_dwordx4 v60, s[8:11], s3 offen offset:1024 lds
buffer_load_dwordx4 v60, s[8:11], s3 offen offset:2048 lds
buffer_load_dwordx4 v[96:99], v146, s[44:47], 0 offen sc1
buffer_load_dwordx4 v[100:103], v146, s[44:47], s82 offen sc1
buffer_load_dwordx4 v[104:107], v147, s[44:47], 0 offen sc1
buffer_load_dwordx4 v[108:111], v147, s[44:47], s82 offen sc1
buffer_load_dwordx2 v[144:145], v148, s[44:47], 0 offen sc1
s_add_u32 m0, s88, 46080
s_add_u32 s3, s3, 98304
buffer_load_dwordx4 v60, s[8:11], s3 offen offset:0 lds
buffer_load_dwordx4 v60, s[8:11], s3 offen offset:1024 lds
buffer_load_dwordx4 v60, s[8:11], s3 offen offset:2048 lds
s_waitcnt vmcnt(8)
s_waitcnt lgkmcnt(0)
s_barrier
ds_read_b64_tr_b16 a[40:41], v17 offset:1024
ds_read_b64_tr_b16 a[42:43], v17 offset:1536
ds_read_b64_tr_b16 a[44:45], v17 offset:2048
ds_read_b64_tr_b16 a[46:47], v17 offset:2560
ds_read_b64_tr_b16 a[36:37], v17 offset:0
ds_read_b64_tr_b16 a[38:39], v17 offset:512
ds_read_b64_tr_b16 a[52:53], v17 offset:13312
ds_read_b64_tr_b16 a[54:55], v17 offset:13824
ds_read_b64_tr_b16 a[56:57], v17 offset:14336
ds_read_b64_tr_b16 a[58:59], v17 offset:14848
ds_read_b64_tr_b16 a[48:49], v17 offset:12288
ds_read_b64_tr_b16 a[50:51], v17 offset:12800
ds_read_b64_tr_b16 a[64:65], v17 offset:25600
ds_read_b64_tr_b16 a[66:67], v17 offset:26112
ds_read_b64_tr_b16 a[68:69], v17 offset:26624
ds_read_b64_tr_b16 a[70:71], v17 offset:27136
ds_read_b64_tr_b16 a[60:61], v17 offset:24576
ds_read_b64_tr_b16 a[62:63], v17 offset:25088
ds_read_b64_tr_b16 a[76:77], v19 offset:1024
ds_read_b64_tr_b16 a[78:79], v19 offset:1536
ds_read_b64_tr_b16 a[80:81], v19 offset:2048
ds_read_b64_tr_b16 a[82:83], v19 offset:2560
ds_read_b64_tr_b16 a[72:73], v19 offset:0
ds_read_b64_tr_b16 a[74:75], v19 offset:512
s_add_u32 m0, s88, 58368
s_add_u32 s3, s3, 98304
s_cmp_eq_u32 s3, 1572864
s_cselect_b32 s3, 0, s3
buffer_load_dwordx4 v60, s[8:11], s3 offen offset:0 lds
buffer_load_dwordx4 v60, s[8:11], s3 offen offset:1024 lds
buffer_load_dwordx4 v60, s[8:11], s3 offen offset:2048 lds
s_waitcnt vmcnt(6)
v_xor_b32 v96, s76, v96
v_xor_b32 v97, s77, v97
v_xor_b32 v98, s78, v98
v_xor_b32 v99, s79, v99
v_xor_b32 v100, s76, v100
v_xor_b32 v101, s77, v101
v_xor_b32 v102, s78, v102
v_xor_b32 v103, s79, v103
v_xor_b32 v104, s76, v104
v_xor_b32 v105, s77, v105
v_xor_b32 v106, s78, v106
v_xor_b32 v107, s79, v107
v_xor_b32 v108, s76, v108
v_xor_b32 v109, s77, v109
v_xor_b32 v110, s78, v110
v_xor_b32 v111, s79, v111
v_or3_b32 v112, v96, v97, v98
v_or3_b32 v113, v99, v100, v101
v_or3_b32 v112, v112, v102, v103
v_or3_b32 v113, v113, v104, v105
v_or3_b32 v112, v112, v106, v107
v_or3_b32 v113, v113, v108, v109
v_or3_b32 v112, v112, v110, v111
v_xor_b32 v114, v145, v9
v_or_b32 v112, v112, v113
v_lshl_or_b32 v112, v112, 24, v114
v_cmp_ne_u32 vcc, 0, v112
s_cbranch_vccz go_4
retry_5:
s_sub_u32 s56, s56, 1
s_cbranch_scc1 L_end
s_sleep 2
buffer_load_dwordx4 v[96:99], v146, s[44:47], 0 offen sc1
buffer_load_dwordx4 v[100:103], v146, s[44:47], s82 offen sc1
buffer_load_dwordx4 v[104:107], v147, s[44:47], 0 offen sc1
buffer_load_dwordx4 v[108:111], v147, s[44:47], s82 offen sc1
buffer_load_dwordx2 v[144:145], v148, s[44:47], 0 offen sc1
s_waitcnt vmcnt(0)
v_xor_b32 v96, s76, v96
v_xor_b32 v97, s77, v97
v_xor_b32 v98, s78, v98
v_xor_b32 v99, s79, v99
v_xor_b32 v100, s76, v100
v_xor_b32 v101, s77, v101
v_xor_b32 v102, s78, v102
v_xor_b32 v103, s79, v103
v_xor_b32 v104, s76, v104
v_xor_b32 v105, s77, v105
v_xor_b32 v106, s78, v106
v_xor_b32 v107, s79, v107
v_xor_b32 v108, s76, v108
v_xor_b32 v109, s77, v109
v_xor_b32 v110, s78, v110
v_xor_b32 v111, s79, v111
v_or3_b32 v112, v96, v97, v98
v_or3_b32 v113, v99, v100, v101
v_or3_b32 v112, v112, v102, v103
v_or3_b32 v113, v113, v104, v105
v_or3_b32 v112, v112, v106, v107
v_or3_b32 v113, v113, v108, v109
v_or3_b32 v112, v112, v110, v111
v_xor_b32 v114, v145, v9
v_or_b32 v112, v112, v113
v_lshl_or_b32 v112, v112, 24, v114
v_cmp_ne_u32 vcc, 0, v112
s_cbranch_vccnz retry_5
go_4:
v_pk_add_f32 v[96:97], v[96:97], v[100:101]
v_pk_add_f32 v[98:99], v[98:99], v[102:103]
v_pk_add_f32 v[104:105], v[104:105], v[108:109]
v_pk_add_f32 v[106:107], v[106:107], v[110:111]
v_pk_add_f32 v[96:97], v[96:97], v[104:105]
v_pk_add_f32 v[98:99], v[98:99], v[106:107]
v_cvt_pk_bf16_f32 v97, v96, v97
v_cvt_pk_bf16_f32 v99, v98, v99
v_lshlrev_b32 v96, 16, v97
v_and_b32 v97, s94, v97
v_lshlrev_b32 v98, 16, v99
v_and_b32 v99, s94, v99
v_add_f32 v96, s83, v96
v_add_f32 v97, s83, v97
v_add_f32 v98, s83, v98
v_add_f32 v99, s83, v99
v_cvt_pk_bf16_f32 v97, v96, v97
v_cvt_pk_bf16_f32 v99, v98, v99
v_lshlrev_b32 v96, 16, v97
v_and_b32 v97, s94, v97
v_lshlrev_b32 v98, 16, v99
v_and_b32 v99, s94, v99
ds_write_b128 v150, v[96:99]
s_add_u32 m0, s88, 70656
s_add_u32 s3, s3, 98304
buffer_load_dwordx4 v60, s[8:11], s3 offen offset:0 lds
buffer_load_dwordx4 v60, s[8:11], s3 offen offset:1024 lds
buffer_load_dwordx4 v60, s[8:11], s3 offen offset:2048 lds
v_cmp_ne_u32 vcc, s55, v144
s_add_u32 s57, s61, 2162944
s_waitcnt lgkmcnt(0)
s_barrier
ds_read_b128 v[128:131], v149 offset:2048
ds_read_b128 v[136:139], v149 offset:0
ds_read_b128 v[132:135], v149 offset:2064
ds_read_b128 v[140:143], v149 offset:16
s_cbranch_vccnz L_hslow
s_waitcnt lgkmcnt(2)
v_pk_fma_f32 v[64:65], v[64:65], v[128:129], v[136:137]
v_pk_fma_f32 v[66:67], v[66:67], v[130:131], v[138:139]
s_waitcnt lgkmcnt(0)
v_pk_fma_f32 v[68:69], v[68:69], v[132:133], v[140:141]
v_pk_fma_f32 v[70:71], v[70:71], v[134:135], v[142:143]
v_cvt_pk_bf16_f32 v64, v64, v65
v_cvt_pk_bf16_f32 v65, v66, v67
v_cvt_pk_bf16_f32 v66, v68, v69
v_cvt_pk_bf16_f32 v67, v70, v71
buffer_store_dwordx4 v[64:67], v2, s[44:47], s75 offen offset:0 sc1
v_pk_fma_f32 v[72:73], v[72:73], v[128:129], v[136:137]
v_pk_fma_f32 v[74:75], v[74:75], v[130:131], v[138:139]
v_pk_fma_f32 v[76:77], v[76:77], v[132:133], v[140:141]
v_pk_fma_f32 v[78:79], v[78:79], v[134:135], v[142:143]
v_cvt_pk_bf16_f32 v72, v72, v73
v_cvt_pk_bf16_f32 v73, v74, v75
v_cvt_pk_bf16_f32 v74, v76, v77
v_cvt_pk_bf16_f32 v75, v78, v79
buffer_store_dwordx4 v[72:75], v2, s[44:47], s75 offen offset:1024 sc1
v_pk_fma_f32 v[80:81], v[80:81], v[128:129], v[136:137]
v_pk_fma_f32 v[82:83], v[82:83], v[130:131], v[138:139]
v_pk_fma_f32 v[84:85], v[84:85], v[132:133], v[140:141]
v_pk_fma_f32 v[86:87], v[86:87], v[134:135], v[142:143]
v_cvt_pk_bf16_f32 v80, v80, v81
v_cvt_pk_bf16_f32 v81, v82, v83
v_cvt_pk_bf16_f32 v82, v84, v85
v_cvt_pk_bf16_f32 v83, v86, v87
buffer_store_dwordx4 v[80:83], v2, s[44:47], s75 offen offset:2048 sc1
v_pk_fma_f32 v[88:89], v[88:89], v[128:129], v[136:137]
v_pk_fma_f32 v[90:91], v[90:91], v[130:131], v[138:139]
v_pk_fma_f32 v[92:93], v[92:93], v[132:133], v[140:141]
v_pk_fma_f32 v[94:95], v[94:95], v[134:135], v[142:143]
v_cvt_pk_bf16_f32 v88, v88, v89
v_cvt_pk_bf16_f32 v89, v90, v91
v_cvt_pk_bf16_f32 v90, v92, v93
v_cvt_pk_bf16_f32 v91, v94, v95
buffer_store_dwordx4 v[88:91], v2, s[44:47], s75 offen offset:3072 sc1
s_add_u32 m0, s88, 84480
s_add_u32 s3, s3, 98304
s_cmp_eq_u32 s3, 1572864
s_cselect_b32 s3, 0, s3
buffer_load_dwordx4 v60, s[8:11], s3 offen offset:0 lds
buffer_load_dwordx4 v60, s[8:11], s3 offen offset:1024 lds
buffer_load_dwordx4 v60, s[8:11], s3 offen offset:2048 lds
s_add_u32 m0, s88, 96768
s_add_u32 s3, s3, 98304
buffer_load_dwordx4 v60, s[8:11], s3 offen offset:0 lds
buffer_load_dwordx4 v60, s[8:11], s3 offen offset:1024 lds
buffer_load_dwordx4 v60, s[8:11], s3 offen offset:2048 lds
s_waitcnt vmcnt(6)
s_mov_b64 exec, 1
buffer_store_dwordx2 v[8:9], v10, s[44:47], s57 offen
s_mov_b64 exec, -1
s_branch L_hdone
L_hslow:
s_waitcnt lgkmcnt(2)
v_pk_fma_f32 v[64:65], v[64:65], v[128:129], v[136:137]
v_pk_fma_f32 v[66:67], v[66:67], v[130:131], v[138:139]
s_waitcnt lgkmcnt(0)
v_pk_fma_f32 v[68:69], v[68:69], v[132:133], v[140:141]
v_pk_fma_f32 v[70:71], v[70:71], v[134:135], v[142:143]
v_cvt_pk_bf16_f32 v64, v64, v65
v_cvt_pk_bf16_f32 v65, v66, v67
v_cvt_pk_bf16_f32 v66, v68, v69
v_cvt_pk_bf16_f32 v67, v70, v71
buffer_store_dwordx4 v[64:67], v2, s[44:47], s75 offen offset:0 sc1
v_pk_fma_f32 v[72:73], v[72:73], v[128:129], v[136:137]
v_pk_fma_f32 v[74:75], v[74:75], v[130:131], v[138:139]
v_pk_fma_f32 v[76:77], v[76:77], v[132:133], v[140:141]
v_pk_fma_f32 v[78:79], v[78:79], v[134:135], v[142:143]
v_cvt_pk_bf16_f32 v72, v72, v73
v_cvt_pk_bf16_f32 v73, v74, v75
v_cvt_pk_bf16_f32 v74, v76, v77
v_cvt_pk_bf16_f32 v75, v78, v79
buffer_store_dwordx4 v[72:75], v2, s[44:47], s75 offen offset:1024 sc1
v_pk_fma_f32 v[80:81], v[80:81], v[128:129], v[136:137]
v_pk_fma_f32 v[82:83], v[82:83], v[130:131], v[138:139]
v_pk_fma_f32 v[84:85], v[84:85], v[132:133], v[140:141]
v_pk_fma_f32 v[86:87], v[86:87], v[134:135], v[142:143]
v_cvt_pk_bf16_f32 v80, v80, v81
v_cvt_pk_bf16_f32 v81, v82, v83
v_cvt_pk_bf16_f32 v82, v84, v85
v_cvt_pk_bf16_f32 v83, v86, v87
buffer_store_dwordx4 v[80:83], v2, s[44:47], s75 offen offset:2048 sc1
v_pk_fma_f32 v[88:89], v[88:89], v[128:129], v[136:137]
v_pk_fma_f32 v[90:91], v[90:91], v[130:131], v[138:139]
v_pk_fma_f32 v[92:93], v[92:93], v[132:133], v[140:141]
v_pk_fma_f32 v[94:95], v[94:95], v[134:135], v[142:143]
v_cvt_pk_bf16_f32 v88, v88, v89
v_cvt_pk_bf16_f32 v89, v90, v91
v_cvt_pk_bf16_f32 v90, v92, v93
v_cvt_pk_bf16_f32 v91, v94, v95
buffer_store_dwordx4 v[88:91], v2, s[44:47], s75 offen offset:3072 sc1
s_add_u32 m0, s88, 84480
s_add_u32 s3, s3, 98304
s_cmp_eq_u32 s3, 1572864
s_cselect_b32 s3, 0, s3
buffer_load_dwordx4 v60, s[8:11], s3 offen offset:0 lds
buffer_load_dwordx4 v60, s[8:11], s3 offen offset:1024 lds
buffer_load_dwordx4 v60, s[8:11], s3 offen offset:2048 lds
s_add_u32 m0, s88, 96768
s_add_u32 s3, s3, 98304
buffer_load_dwordx4 v60, s[8:11], s3 offen offset:0 lds
buffer_load_dwordx4 v60, s[8:11], s3 offen offset:1024 lds
buffer_load_dwordx4 v60, s[8:11], s3 offen offset:2048 lds
s_waitcnt vmcnt(6)
s_mov_b64 exec, 1
buffer_store_dwordx2 v[8:9], v10, s[44:47], s57 offen sc1
s_mov_b64 exec, -1
L_hdone:
s_add_u32 m0, s88, 109056
s_add_u32 s3, s3, 98304
s_cmp_eq_u32 s3, 1572864
s_cselect_b32 s3, 0, s3
buffer_load_dwordx4 v60, s[8:11], s3 offen offset:0 lds
buffer_load_dwordx4 v60, s[8:11], s3 offen offset:1024 lds
buffer_load_dwordx4 v60, s[8:11], s3 offen offset:2048 lds
s_waitcnt vmcnt(6)
s_barrier
ds_read_b64_tr_b16 a[88:89], v19 offset:13312
ds_read_b64_tr_b16 a[90:91], v19 offset:13824
ds_read_b64_tr_b16 a[92:93], v19 offset:14336
ds_read_b64_tr_b16 a[94:95], v19 offset:14848
ds_read_b64_tr_b16 a[84:85], v19 offset:12288
ds_read_b64_tr_b16 a[86:87], v19 offset:12800
ds_read_b64_tr_b16 a[100:101], v19 offset:25600
ds_read_b64_tr_b16 a[102:103], v19 offset:26112
ds_read_b64_tr_b16 a[104:105], v19 offset:26624
ds_read_b64_tr_b16 a[106:107], v19 offset:27136
ds_read_b64_tr_b16 a[96:97], v19 offset:24576
ds_read_b64_tr_b16 a[98:99], v19 offset:25088
ds_read_b64_tr_b16 a[112:113], v19 offset:37888
ds_read_b64_tr_b16 a[114:115], v19 offset:38400
ds_read_b64_tr_b16 a[116:117], v19 offset:38912
ds_read_b64_tr_b16 a[118:119], v19 offset:39424
ds_read_b64_tr_b16 a[108:109], v19 offset:36864
ds_read_b64_tr_b16 a[110:111], v19 offset:37376
s_add_u32 m0, s88, 121344
s_add_u32 s3, s3, 98304
buffer_load_dwordx4 v60, s[8:11], s3 offen offset:0 lds
buffer_load_dwordx4 v60, s[8:11], s3 offen offset:1024 lds
buffer_load_dwordx4 v60, s[8:11], s3 offen offset:2048 lds
s_add_u32 m0, s88, 133632
s_add_u32 s3, s3, 98304
s_cmp_eq_u32 s3, 1572864
s_cselect_b32 s3, 0, s3
buffer_load_dwordx4 v60, s[8:11], s3 offen offset:0 lds
buffer_load_dwordx4 v60, s[8:11], s3 offen offset:1024 lds
buffer_load_dwordx4 v60, s[8:11], s3 offen offset:2048 lds
s_add_u32 m0, s88, 145920
s_add_u32 s3, s3, 98304
buffer_load_dwordx4 v60, s[8:11], s3 offen offset:0 lds
buffer_load_dwordx4 v60, s[8:11], s3 offen offset:1024 lds
buffer_load_dwordx4 v60, s[8:11], s3 offen offset:2048 lds
s_waitcnt lgkmcnt(0)
L_join:
s_mov_b32 s58, 2162944
s_mov_b64 exec, 0x0fffff00
buffer_load_dwordx2 v[96:97], v11, s[44:47], s58 offen sc1
s_mov_b64 exec, -1
v_mul_u32_u24 v36, 12288, v3
v_lshl_add_u32 v36, v4, 4, v36
s_lshl_b32 s58, s50, 8
s_lshl_b32 s57, s52, 11
s_add_u32 s58, s58, s57
s_add_u32 s58, s58, 20480
v_add_u32 v36, s58, v36
v_and_b32 v37, 7, v1
v_lshlrev_b32 v37, 5, v37
s_lshl_b32 s58, s51, 8
s_add_u32 s58, s58, 4096
v_add_u32 v37, s58, v37
v_lshlrev_b32 v47, 4, v0
v_add_u32 v47, 65536, v47
v_mov_b32 v90, 0
v_mov_b32 v91, 0
v_mov_b32 v94, 0
v_mov_b32 v95, 0
v_and_b32 v5, 1, v4
v_cmp_eq_u32 s[80:81], 1, v5
v_lshl_add_u32 v6, v3, 2, v5
v_cmp_le_u32 s[82:83], v6, v4
v_add_u32 v6, 2, v6
v_cmp_le_u32 s[84:85], v6, v4
v_mov_b32 v7, 0xffff
v_mov_b32 v8, s94
v_cndmask_b32 v7, v7, v8, s[80:81]
v_cndmask_b32 v24, 0, v7, s[82:83]
v_cndmask_b32 v25, 0, v7, s[84:85]
v_xor_b32 v26, v24, v7
v_xor_b32 v27, v25, v7
s_cmp_eq_u32 s51, 0
s_cselect_b32 s93, 0xf149f2ca, 0
v_mov_b32 v28, s93
v_mov_b32 v29, s93
v_mov_b32 v30, s93
v_mov_b32 v31, s93
s_mov_b32 s93, 0x3eb8aa3b
s_mov_b32 s58, 2162944
s_mov_b64 exec, 0x0fffff00
s_mul_i32 s59, s52, 4224
s_waitcnt vmcnt(0)
v_cmp_ne_u32 vcc, v97, v9
s_cbranch_vccz go_6
retry_7:
s_sub_u32 s56, s56, 1
s_cbranch_scc1 L_end
s_sleep 1
buffer_load_dwordx2 v[96:97], v11, s[44:47], s58 offen sc1
s_waitcnt vmcnt(0)
v_cmp_ne_u32 vcc, v97, v9
s_cbranch_vccnz retry_7
go_6:
s_mov_b64 exec, -1
s_barrier
s_add_u32 m0, s59, 0
s_mov_b32 s58, 2137088
buffer_load_dwordx4 v22, s[44:47], s58 offen offset:0 sc1 lds
s_add_u32 m0, m0, 32
s_nop 0
buffer_load_dwordx4 v22, s[44:47], s58 offen offset:1024 sc1 lds
s_add_u32 m0, m0, 32
s_nop 0
buffer_load_dwordx4 v22, s[44:47], s58 offen offset:2048 sc1 lds
s_add_u32 m0, m0, 32
s_nop 0
buffer_load_dwordx4 v22, s[44:47], s58 offen offset:3072 sc1 lds
s_add_u32 m0, s59, 16896
s_mov_b32 s58, 2141184
buffer_load_dwordx4 v18, s[44:47], s58 offen offset:0 sc1 lds
s_add_u32 m0, m0, 32
s_nop 0
buffer_load_dwordx4 v18, s[44:47], s58 offen offset:1024 sc1 lds
s_add_u32 m0, m0, 32
s_nop 0
buffer_load_dwordx4 v18, s[44:47], s58 offen offset:2048 sc1 lds
s_add_u32 m0, m0, 32
s_nop 0
buffer_load_dwordx4 v18, s[44:47], s58 offen offset:3072 sc1 lds
ds_read_b64_tr_b16 a[124:125], v16 offset:1024
ds_read_b64_tr_b16 a[126:127], v16 offset:1536
ds_read_b64_tr_b16 a[128:129], v16 offset:2048
ds_read_b64_tr_b16 a[130:131], v16 offset:2560
ds_read_b64_tr_b16 a[120:121], v16 offset:0
ds_read_b64_tr_b16 a[122:123], v16 offset:512
ds_read_b64_tr_b16 a[136:137], v16 offset:13312
ds_read_b64_tr_b16 a[138:139], v16 offset:13824
ds_read_b64_tr_b16 a[140:141], v16 offset:14336
ds_read_b64_tr_b16 a[142:143], v16 offset:14848
ds_read_b64_tr_b16 a[132:133], v16 offset:12288
ds_read_b64_tr_b16 a[134:135], v16 offset:12800
ds_read_b64_tr_b16 a[148:149], v16 offset:25600
ds_read_b64_tr_b16 a[150:151], v16 offset:26112
ds_read_b64_tr_b16 a[152:153], v16 offset:26624
ds_read_b64_tr_b16 a[154:155], v16 offset:27136
ds_read_b64_tr_b16 a[144:145], v16 offset:24576
ds_read_b64_tr_b16 a[146:147], v16 offset:25088
ds_read_b64_tr_b16 a[160:161], v17 offset:1024
ds_read_b64_tr_b16 a[162:163], v17 offset:1536
ds_read_b64_tr_b16 a[164:165], v17 offset:2048
ds_read_b64_tr_b16 a[166:167], v17 offset:2560
ds_read_b64_tr_b16 a[156:157], v17 offset:0
ds_read_b64_tr_b16 a[158:159], v17 offset:512
ds_read_b64_tr_b16 a[172:173], v17 offset:13312
ds_read_b64_tr_b16 a[174:175], v17 offset:13824
ds_read_b64_tr_b16 a[176:177], v17 offset:14336
ds_read_b64_tr_b16 a[178:179], v17 offset:14848
ds_read_b64_tr_b16 a[168:169], v17 offset:12288
ds_read_b64_tr_b16 a[170:171], v17 offset:12800
ds_read_b64_tr_b16 a[184:185], v17 offset:25600
ds_read_b64_tr_b16 a[186:187], v17 offset:26112
ds_read_b64_tr_b16 a[188:189], v17 offset:26624
ds_read_b64_tr_b16 a[190:191], v17 offset:27136
ds_read_b64_tr_b16 a[180:181], v17 offset:24576
ds_read_b64_tr_b16 a[182:183], v17 offset:25088
s_waitcnt vmcnt(4)
s_waitcnt lgkmcnt(0)
s_barrier
ds_read_b128 a[192:195], v20 offset:0
ds_read_b128 a[196:199], v20 offset:64
ds_read_b128 a[200:203], v20 offset:128
ds_read_b128 a[204:207], v20 offset:192
ds_read_b128 a[208:211], v20 offset:256
ds_read_b128 a[212:215], v20 offset:320
buffer_load_dword v251, v235, s[12:15], 0 offen offset:384
s_waitcnt lgkmcnt(4)
v_mfma_f32_16x16x32_bf16 v[72:75], a[4:7], a[192:195], 0
ds_read_b128 a[216:219], v20 offset:384
v_mfma_f32_16x16x32_bf16 v[76:79], a[192:195], a[8:11], 0
s_add_u32 m0, s59, 33792
s_mov_b32 s58, 2207744
buffer_load_dwordx4 v18, s[44:47], s58 offen offset:0 sc1 lds
s_add_u32 m0, m0, 32
v_mfma_f32_16x16x32_bf16 v[72:75], a[16:19], a[196:199], v[72:75]
ds_read_b128 a[220:223], v20 offset:448
v_mfma_f32_16x16x32_bf16 v[76:79], a[196:199], a[20:23], v[76:79]
s_waitcnt lgkmcnt(4)
v_mfma_f32_16x16x32_bf16 v[72:75], a[28:31], a[200:203], v[72:75]
ds_read_b128 a[224:227], v20 offset:512
v_mfma_f32_16x16x32_bf16 v[76:79], a[200:203], a[32:35], v[76:79]
buffer_load_dwordx4 v18, s[44:47], s58 offen offset:1024 sc1 lds
s_add_u32 m0, m0, 32
v_mfma_f32_16x16x32_bf16 v[72:75], a[40:43], a[204:207], v[72:75]
ds_read_b128 a[228:231], v20 offset:576
v_mfma_f32_16x16x32_bf16 v[76:79], a[204:207], a[44:47], v[76:79]
s_waitcnt lgkmcnt(4)
v_mfma_f32_16x16x32_bf16 v[72:75], a[52:55], a[208:211], v[72:75]
ds_read_b128 a[232:235], v20 offset:640
v_mfma_f32_16x16x32_bf16 v[76:79], a[208:211], a[56:59], v[76:79]
buffer_load_dwordx4 v18, s[44:47], s58 offen offset:2048 sc1 lds
s_add_u32 m0, m0, 32
v_mfma_f32_16x16x32_bf16 v[72:75], a[64:67], a[212:215], v[72:75]
ds_read_b128 a[236:239], v20 offset:704
v_mfma_f32_16x16x32_bf16 v[76:79], a[212:215], a[68:71], v[76:79]
s_waitcnt lgkmcnt(4)
v_mfma_f32_16x16x32_bf16 v[72:75], a[76:79], a[216:219], v[72:75]
ds_read_b128 a[240:243], v20 offset:768
v_mfma_f32_16x16x32_bf16 v[76:79], a[216:219], a[80:83], v[76:79]
buffer_load_dwordx4 v18, s[44:47], s58 offen offset:3072 sc1 lds
v_mfma_f32_16x16x32_bf16 v[72:75], a[88:91], a[220:223], v[72:75]
ds_read_b128 a[244:247], v20 offset:832
v_mfma_f32_16x16x32_bf16 v[76:79], a[220:223], a[92:95], v[76:79]
s_waitcnt lgkmcnt(4)
v_mfma_f32_16x16x32_bf16 v[72:75], a[100:103], a[224:227], v[72:75]
ds_read_b128 a[248:251], v20 offset:896
v_mfma_f32_16x16x32_bf16 v[76:79], a[224:227], a[104:107], v[76:79]
s_add_u32 m0, s59, 50688
s_mov_b32 s58, 2274304
buffer_load_dwordx4 v18, s[44:47], s58 offen offset:0 sc1 lds
s_add_u32 m0, m0, 32
v_mfma_f32_16x16x32_bf16 v[72:75], a[112:115], a[228:231], v[72:75]
ds_read_b128 a[252:255], v20 offset:960
v_mfma_f32_16x16x32_bf16 v[76:79], a[228:231], a[116:119], v[76:79]
s_waitcnt lgkmcnt(4)
v_mfma_f32_16x16x32_bf16 v[72:75], a[124:127], a[232:235], v[72:75]
s_waitcnt vmcnt(6)
s_barrier
ds_read_b128 a[192:195], v20 offset:16896
v_mfma_f32_16x16x32_bf16 v[76:79], a[232:235], a[128:131], v[76:79]
buffer_load_dwordx4 v18, s[44:47], s58 offen offset:1024 sc1 lds
s_add_u32 m0, m0, 32
v_mfma_f32_16x16x32_bf16 v[72:75], a[136:139], a[236:239], v[72:75]
ds_read_b128 a[196:199], v20 offset:16960
v_mfma_f32_16x16x32_bf16 v[76:79], a[236:239], a[140:143], v[76:79]
s_waitcnt lgkmcnt(4)
v_mfma_f32_16x16x32_bf16 v[72:75], a[148:151], a[240:243], v[72:75]
ds_read_b128 a[200:203], v20 offset:17024
v_mfma_f32_16x16x32_bf16 v[76:79], a[240:243], a[152:155], v[76:79]
buffer_load_dwordx4 v18, s[44:47], s58 offen offset:2048 sc1 lds
s_add_u32 m0, m0, 32
v_mfma_f32_16x16x32_bf16 v[72:75], a[160:163], a[244:247], v[72:75]
ds_read_b128 a[204:207], v20 offset:17088
v_mfma_f32_16x16x32_bf16 v[76:79], a[244:247], a[164:167], v[76:79]
s_waitcnt lgkmcnt(4)
v_mfma_f32_16x16x32_bf16 v[72:75], a[172:175], a[248:251], v[72:75]
ds_read_b128 a[208:211], v20 offset:17152
v_mfma_f32_16x16x32_bf16 v[76:79], a[248:251], a[176:179], v[76:79]
buffer_load_dwordx4 v18, s[44:47], s58 offen offset:3072 sc1 lds
v_mfma_f32_16x16x32_bf16 v[72:75], a[184:187], a[252:255], v[72:75]
ds_read_b128 a[212:215], v20 offset:17216
v_mfma_f32_16x16x32_bf16 v[76:79], a[252:255], a[188:191], v[76:79]
s_waitcnt lgkmcnt(4)
v_mfma_f32_16x16x32_bf16 v[104:107], a[4:7], a[192:195], 0
ds_read_b128 a[216:219], v20 offset:17280
v_mfma_f32_16x16x32_bf16 v[108:111], a[192:195], a[8:11], 0
s_add_u32 m0, s59, 67584
s_mov_b32 s58, 2340864
buffer_load_dwordx4 v18, s[44:47], s58 offen offset:0 sc1 lds
s_add_u32 m0, m0, 32
v_mfma_f32_16x16x32_bf16 v[112:115], a[0:3], a[192:195], 0
v_mfma_f32_16x16x32_bf16 v[104:107], a[16:19], a[196:199], v[104:107]
ds_read_b128 a[220:223], v20 offset:17344
v_cvt_pk_bf16_f32 v80, v72, v73
v_mfma_f32_16x16x32_bf16 v[108:111], a[196:199], a[20:23], v[108:111]
v_cvt_pk_bf16_f32 v81, v74, v75
v_cvt_pk_bf16_f32 v64, v76, v77
v_mfma_f32_16x16x32_bf16 v[112:115], a[12:15], a[196:199], v[112:115]
v_cvt_pk_bf16_f32 v65, v78, v79
buffer_load_dwordx4 v18, s[44:47], s58 offen offset:1024 sc1 lds
s_add_u32 m0, m0, 32
s_waitcnt lgkmcnt(4)
v_mfma_f32_16x16x32_bf16 v[104:107], a[28:31], a[200:203], v[104:107]
ds_read_b128 a[224:227], v20 offset:17408
v_mfma_f32_16x16x32_bf16 v[108:111], a[200:203], a[32:35], v[108:111]
v_mfma_f32_16x16x32_bf16 v[112:115], a[24:27], a[200:203], v[112:115]
v_mfma_f32_16x16x32_bf16 v[104:107], a[40:43], a[204:207], v[104:107]
ds_read_b128 a[228:231], v20 offset:17472
buffer_load_dwordx4 v18, s[44:47], s58 offen offset:2048 sc1 lds
s_add_u32 m0, m0, 32
v_mfma_f32_16x16x32_bf16 v[108:111], a[204:207], a[44:47], v[108:111]
v_mfma_f32_16x16x32_bf16 v[112:115], a[36:39], a[204:207], v[112:115]
s_waitcnt lgkmcnt(4)
v_mfma_f32_16x16x32_bf16 v[104:107], a[52:55], a[208:211], v[104:107]
ds_read_b128 a[232:235], v20 offset:17536
v_mfma_f32_16x16x32_bf16 v[108:111], a[208:211], a[56:59], v[108:111]
buffer_load_dwordx4 v18, s[44:47], s58 offen offset:3072 sc1 lds
v_mfma_f32_16x16x32_bf16 v[112:115], a[48:51], a[208:211], v[112:115]
v_mfma_f32_16x16x32_bf16 v[104:107], a[64:67], a[212:215], v[104:107]
ds_read_b128 a[236:239], v20 offset:17600
v_mfma_f32_16x16x32_bf16 v[108:111], a[212:215], a[68:71], v[108:111]
v_mfma_f32_16x16x32_bf16 v[112:115], a[60:63], a[212:215], v[112:115]
s_waitcnt lgkmcnt(4)
v_mfma_f32_16x16x32_bf16 v[104:107], a[76:79], a[216:219], v[104:107]
ds_read_b128 a[240:243], v20 offset:17664
v_mfma_f32_16x16x32_bf16 v[108:111], a[216:219], a[80:83], v[108:111]
s_lshr_b32 s3, s90, 1
s_add_u32 m0, s3, 150016
s_lshl_b32 s3, s53, 14
buffer_load_dwordx4 v61, s[4:7], s3 offen offset:0 lds
v_mfma_f32_16x16x32_bf16 v[112:115], a[72:75], a[216:219], v[112:115]
v_mfma_f32_16x16x32_bf16 v[104:107], a[88:91], a[220:223], v[104:107]
ds_read_b128 a[244:247], v20 offset:17728
v_mfma_f32_16x16x32_bf16 v[108:111], a[220:223], a[92:95], v[108:111]
s_add_u32 s3, s3, 7168
buffer_load_dwordx4 v61, s[4:7], s3 offen offset:1024 lds
v_mfma_f32_16x16x32_bf16 v[112:115], a[84:87], a[220:223], v[112:115]
s_waitcnt lgkmcnt(4)
v_mfma_f32_16x16x32_bf16 v[104:107], a[100:103], a[224:227], v[104:107]
ds_read_b128 a[248:251], v20 offset:17792
v_mfma_f32_16x16x32_bf16 v[108:111], a[224:227], a[104:107], v[108:111]
v_mfma_f32_16x16x32_bf16 v[112:115], a[96:99], a[224:227], v[112:115]
v_mfma_f32_16x16x32_bf16 v[104:107], a[112:115], a[228:231], v[104:107]
ds_read_b128 a[252:255], v20 offset:17856
s_add_u32 m0, s90, 84480
s_add_u32 s3, s89, 0
buffer_load_dwordx4 v52, s[12:15], s3 offen offset:0 lds
v_mfma_f32_16x16x32_bf16 v[108:111], a[228:231], a[116:119], v[108:111]
v_mfma_f32_16x16x32_bf16 v[112:115], a[108:111], a[228:231], v[112:115]
s_waitcnt lgkmcnt(4)
v_mfma_f32_16x16x32_bf16 v[104:107], a[124:127], a[232:235], v[104:107]
s_waitcnt vmcnt(11)
s_barrier
ds_read_b128 a[192:195], v20 offset:33792
v_mfma_f32_16x16x32_bf16 v[108:111], a[232:235], a[128:131], v[108:111]
buffer_load_dwordx4 v53, s[12:15], s3 offen offset:1024 lds
v_mfma_f32_16x16x32_bf16 v[112:115], a[120:123], a[232:235], v[112:115]
v_mfma_f32_16x16x32_bf16 v[104:107], a[136:139], a[236:239], v[104:107]
ds_read_b128 a[196:199], v20 offset:33856
v_mfma_f32_16x16x32_bf16 v[108:111], a[236:239], a[140:143], v[108:111]
v_mfma_f32_16x16x32_bf16 v[112:115], a[132:135], a[236:239], v[112:115]
s_waitcnt lgkmcnt(4)
v_mfma_f32_16x16x32_bf16 v[104:107], a[148:151], a[240:243], v[104:107]
ds_read_b128 a[200:203], v20 offset:33920
v_mfma_f32_16x16x32_bf16 v[108:111], a[240:243], a[152:155], v[108:111]
buffer_load_dwordx4 v54, s[12:15], s3 offen offset:2048 lds
v_mfma_f32_16x16x32_bf16 v[112:115], a[144:147], a[240:243], v[112:115]
v_mfma_f32_16x16x32_bf16 v[104:107], a[160:163], a[244:247], v[104:107]
ds_read_b128 a[204:207], v20 offset:33984
v_mfma_f32_16x16x32_bf16 v[108:111], a[244:247], a[164:167], v[108:111]
buffer_load_dwordx4 v55, s[12:15], s3 offen offset:3072 lds
v_mfma_f32_16x16x32_bf16 v[112:115], a[156:159], a[244:247], v[112:115]
s_waitcnt lgkmcnt(4)
v_mfma_f32_16x16x32_bf16 v[104:107], a[172:175], a[248:251], v[104:107]
ds_read_b128 a[208:211], v20 offset:34048
v_mfma_f32_16x16x32_bf16 v[108:111], a[248:251], a[176:179], v[108:111]
v_mfma_f32_16x16x32_bf16 v[112:115], a[168:171], a[248:251], v[112:115]
v_mfma_f32_16x16x32_bf16 v[104:107], a[184:187], a[252:255], v[104:107]
ds_read_b128 a[212:215], v20 offset:34112
s_add_u32 m0, s90, 100864
s_add_u32 s3, s89, 131072
buffer_load_dwordx4 v52, s[12:15], s3 offen offset:0 lds
v_mfma_f32_16x16x32_bf16 v[108:111], a[252:255], a[188:191], v[108:111]
v_mfma_f32_16x16x32_bf16 v[112:115], a[180:183], a[252:255], v[112:115]
buffer_load_dwordx4 v[32:35], v36, s[44:47], 0 offen sc1
buffer_load_dwordx4 v[40:43], v47, s[44:47], 0 offen sc1
buffer_load_dwordx2 v[38:39], v37, s[44:47], 0 offen sc1
buffer_load_dword v251, v235, s[16:19], 0 offen offset:384
s_waitcnt lgkmcnt(4)
v_mfma_f32_16x16x32_bf16 v[136:139], a[4:7], a[192:195], 0
ds_read_b128 a[216:219], v20 offset:34176
v_mfma_f32_16x16x32_bf16 v[140:143], a[192:195], a[8:11], 0
buffer_load_dwordx4 v53, s[12:15], s3 offen offset:1024 lds
v_mfma_f32_16x16x32_bf16 v[144:147], a[0:3], a[192:195], 0
v_mfma_f32_16x16x32_bf16 v[136:139], a[16:19], a[196:199], v[136:139]
ds_read_b128 a[220:223], v20 offset:34240
v_cvt_pk_bf16_f32 v82, v104, v105
v_mfma_f32_16x16x32_bf16 v[140:143], a[196:199], a[20:23], v[140:143]
v_cvt_pk_bf16_f32 v83, v106, v107
v_cvt_pk_bf16_f32 v92, v112, v113
v_mfma_f32_16x16x32_bf16 v[144:147], a[12:15], a[196:199], v[144:147]
v_cvt_pk_bf16_f32 v93, v114, v115
buffer_load_dwordx4 v54, s[12:15], s3 offen offset:2048 lds
s_waitcnt lgkmcnt(4)
v_mfma_f32_16x16x32_bf16 v[136:139], a[28:31], a[200:203], v[136:139]
ds_read_b128 a[224:227], v20 offset:34304
v_mfma_f32_16x16x32_bf16 v[140:143], a[200:203], a[32:35], v[140:143]
v_mfma_f32_16x16x32_bf16 v[116:119], v[80:83], v[90:93], 0
v_mfma_f32_16x16x32_bf16 v[144:147], a[24:27], a[200:203], v[144:147]
v_mfma_f32_16x16x32_bf16 v[120:123], v[80:83], v[92:95], v[28:31]
v_mfma_f32_16x16x32_bf16 v[136:139], a[40:43], a[204:207], v[136:139]
ds_read_b128 a[228:231], v20 offset:34368
buffer_load_dwordx4 v55, s[12:15], s3 offen offset:3072 lds
v_mfma_f32_16x16x32_bf16 v[140:143], a[204:207], a[44:47], v[140:143]
s_nop 1
v_cndmask_b32 v116, v116, v117, s[80:81]
v_mfma_f32_16x16x32_bf16 v[144:147], a[36:39], a[204:207], v[144:147]
v_cndmask_b32 v120, v120, v121, s[80:81]
s_waitcnt lgkmcnt(4)
v_mfma_f32_16x16x32_bf16 v[136:139], a[52:55], a[208:211], v[136:139]
ds_read_b128 a[232:235], v20 offset:34432
v_mfma_f32_16x16x32_bf16 v[140:143], a[208:211], a[56:59], v[140:143]
v_cndmask_b32 v118, v118, v119, s[80:81]
v_cndmask_b32 v122, v122, v123, s[80:81]
v_mfma_f32_16x16x32_bf16 v[144:147], a[48:51], a[208:211], v[144:147]
v_cndmask_b32 v104, v120, v116, s[82:83]
v_cndmask_b32 v105, v122, v118, s[84:85]
v_mfma_f32_16x16x32_bf16 v[136:139], a[64:67], a[212:215], v[136:139]
ds_read_b128 a[236:239], v20 offset:34496
v_max_f32 v106, v104, v105
v_mfma_f32_16x16x32_bf16 v[140:143], a[212:215], a[68:71], v[140:143]
v_mov_b32 v107, v106
s_add_u32 m0, s90, 133632
s_add_u32 s3, s89, 393216
buffer_load_dwordx4 v52, s[12:15], s3 offen offset:0 lds
v_mfma_f32_16x16x32_bf16 v[144:147], a[60:63], a[212:215], v[144:147]
v_permlane32_swap_b32 v106, v107
s_waitcnt lgkmcnt(4)
v_mfma_f32_16x16x32_bf16 v[136:139], a[76:79], a[216:219], v[136:139]
ds_read_b128 a[240:243], v20 offset:34560
v_mfma_f32_16x16x32_bf16 v[140:143], a[216:219], a[80:83], v[140:143]
v_max_f32 v106, v106, v107
v_mov_b32 v107, v106
v_mfma_f32_16x16x32_bf16 v[144:147], a[72:75], a[216:219], v[144:147]
s_nop 0
v_permlane16_swap_b32 v106, v107
v_mfma_f32_16x16x32_bf16 v[136:139], a[88:91], a[220:223], v[136:139]
ds_read_b128 a[244:247], v20 offset:34624
v_max_f32 v106, v106, v107
v_mfma_f32_16x16x32_bf16 v[140:143], a[220:223], a[92:95], v[140:143]
buffer_load_dwordx4 v53, s[12:15], s3 offen offset:1024 lds
v_mul_f32_e64 v106, -v106, s93
v_mfma_f32_16x16x32_bf16 v[144:147], a[84:87], a[220:223], v[144:147]
v_fma_f32 v104, v104, s93, v106
v_fma_f32 v105, v105, s93, v106
s_waitcnt lgkmcnt(4)
v_mfma_f32_16x16x32_bf16 v[136:139], a[100:103], a[224:227], v[136:139]
ds_read_b128 a[248:251], v20 offset:34688
v_mfma_f32_16x16x32_bf16 v[140:143], a[224:227], a[104:107], v[140:143]
v_exp_f32 v104, v104
v_mfma_f32_16x16x32_bf16 v[144:147], a[96:99], a[224:227], v[144:147]
v_exp_f32 v105, v105
v_mfma_f32_16x16x32_bf16 v[136:139], a[112:115], a[228:231], v[136:139]
ds_read_b128 a[252:255], v20 offset:34752
buffer_load_dwordx4 v54, s[12:15], s3 offen offset:2048 lds
v_mfma_f32_16x16x32_bf16 v[140:143], a[228:231], a[116:119], v[140:143]
v_add_f32 v106, v104, v105
v_mov_b32 v107, v106
v_mfma_f32_16x16x32_bf16 v[144:147], a[108:111], a[228:231], v[144:147]
s_nop 0
v_permlane32_swap_b32 v106, v107
s_waitcnt lgkmcnt(4)
v_mfma_f32_16x16x32_bf16 v[136:139], a[124:127], a[232:235], v[136:139]
s_waitcnt vmcnt(21)
s_barrier
ds_read_b128 a[192:195], v21 offset:0
v_mfma_f32_16x16x32_bf16 v[140:143], a[232:235], a[128:131], v[140:143]
buffer_load_dwordx4 v55, s[12:15], s3 offen offset:3072 lds
v_add_f32 v106, v106, v107
v_mfma_f32_16x16x32_bf16 v[144:147], a[120:123], a[232:235], v[144:147]
v_mov_b32 v107, v106
s_nop 1
v_permlane16_swap_b32 v106, v107
v_mfma_f32_16x16x32_bf16 v[136:139], a[136:139], a[236:239], v[136:139]
ds_read_b128 a[196:199], v21 offset:64
v_add_f32 v106, v106, v107
v_mfma_f32_16x16x32_bf16 v[140:143], a[236:239], a[140:143], v[140:143]
v_rcp_f32 v106, v106
v_mfma_f32_16x16x32_bf16 v[144:147], a[132:135], a[236:239], v[144:147]
v_mul_f32 v104, v104, v106
v_mul_f32 v105, v105, v106
s_waitcnt lgkmcnt(4)
v_mfma_f32_16x16x32_bf16 v[136:139], a[148:151], a[240:243], v[136:139]
ds_read_b128 a[200:203], v21 offset:128
v_mfma_f32_16x16x32_bf16 v[140:143], a[240:243], a[152:155], v[140:143]
s_add_u32 m0, s90, 117248
s_add_u32 s3, s89, 262144
buffer_load_dwordx4 v52, s[12:15], s3 offen offset:0 lds
v_mfma_f32_16x16x32_bf16 v[144:147], a[144:147], a[240:243], v[144:147]
v_cvt_pk_bf16_f32 v104, v104, v104
v_cvt_pk_bf16_f32 v105, v105, v105
v_mfma_f32_16x16x32_bf16 v[136:139], a[160:163], a[244:247], v[136:139]
ds_read_b128 a[204:207], v21 offset:192
v_and_b32 v126, v104, v24
v_mfma_f32_16x16x32_bf16 v[140:143], a[244:247], a[164:167], v[140:143]
buffer_load_dwordx4 v53, s[12:15], s3 offen offset:1024 lds
v_and_b32 v124, v104, v26
v_mfma_f32_16x16x32_bf16 v[144:147], a[156:159], a[244:247], v[144:147]
v_and_b32 v127, v105, v25
v_and_b32 v125, v105, v27
s_waitcnt lgkmcnt(4)
v_mfma_f32_16x16x32_bf16 v[136:139], a[172:175], a[248:251], v[136:139]
ds_read_b128 a[208:211], v21 offset:256
v_mfma_f32_16x16x32_bf16 v[140:143], a[248:251], a[176:179], v[140:143]
v_cvt_pk_bf16_f32 v66, v108, v109
v_cvt_pk_bf16_f32 v67, v110, v111
v_mfma_f32_16x16x32_bf16 v[144:147], a[168:171], a[248:251], v[144:147]
s_nop 0
v_mfma_f32_16x16x32_bf16 v[112:115], v[64:67], v[124:127], 0
v_mfma_f32_16x16x32_bf16 v[136:139], a[184:187], a[252:255], v[136:139]
ds_read_b128 a[212:215], v21 offset:320
buffer_load_dwordx4 v54, s[12:15], s3 offen offset:2048 lds
v_mfma_f32_16x16x32_bf16 v[140:143], a[252:255], a[188:191], v[140:143]
s_nop 3
v_cvt_pk_bf16_f32 v224, v112, v113
v_cvt_pk_bf16_f32 v225, v114, v115
v_mfma_f32_16x16x32_bf16 v[144:147], a[180:183], a[252:255], v[144:147]
buffer_load_dwordx4 v55, s[12:15], s3 offen offset:3072 lds
s_waitcnt lgkmcnt(4)
v_mfma_f32_16x16x32_bf16 v[168:171], a[4:7], a[192:195], 0
ds_read_b128 a[216:219], v21 offset:384
v_mfma_f32_16x16x32_bf16 v[172:175], a[192:195], a[8:11], 0
s_add_u32 m0, s90, 0
s_add_u32 s3, s87, 0
s_and_b32 s3, s3, 0x7ffff
buffer_load_dwordx4 v48, s[16:19], s3 offen offset:0 lds
v_mfma_f32_16x16x32_bf16 v[176:179], a[0:3], a[192:195], 0
v_mfma_f32_16x16x32_bf16 v[168:171], a[16:19], a[196:199], v[168:171]
ds_read_b128 a[220:223], v21 offset:448
v_cvt_pk_bf16_f32 v84, v136, v137
v_mfma_f32_16x16x32_bf16 v[172:175], a[196:199], a[20:23], v[172:175]
v_cvt_pk_bf16_f32 v85, v138, v139
v_cvt_pk_bf16_f32 v92, v144, v145
v_mfma_f32_16x16x32_bf16 v[176:179], a[12:15], a[196:199], v[176:179]
v_cvt_pk_bf16_f32 v93, v146, v147
buffer_load_dwordx4 v49, s[16:19], s3 offen offset:1024 lds
s_waitcnt lgkmcnt(4)
v_mfma_f32_16x16x32_bf16 v[168:171], a[28:31], a[200:203], v[168:171]
ds_read_b128 a[224:227], v21 offset:512
v_mfma_f32_16x16x32_bf16 v[172:175], a[200:203], a[32:35], v[172:175]
v_mfma_f32_16x16x32_bf16 v[148:151], v[82:85], v[90:93], 0
v_mfma_f32_16x16x32_bf16 v[176:179], a[24:27], a[200:203], v[176:179]
v_mfma_f32_16x16x32_bf16 v[152:155], v[82:85], v[92:95], 0
v_mfma_f32_16x16x32_bf16 v[168:171], a[40:43], a[204:207], v[168:171]
ds_read_b128 a[228:231], v21 offset:576
buffer_load_dwordx4 v50, s[16:19], s3 offen offset:2048 lds
v_mfma_f32_16x16x32_bf16 v[172:175], a[204:207], a[44:47], v[172:175]
s_nop 1
v_cndmask_b32 v148, v148, v149, s[80:81]
v_mfma_f32_16x16x32_bf16 v[176:179], a[36:39], a[204:207], v[176:179]
v_cndmask_b32 v152, v152, v153, s[80:81]
s_waitcnt lgkmcnt(4)
v_mfma_f32_16x16x32_bf16 v[168:171], a[52:55], a[208:211], v[168:171]
ds_read_b128 a[232:235], v21 offset:640
v_mfma_f32_16x16x32_bf16 v[172:175], a[208:211], a[56:59], v[172:175]
v_cndmask_b32 v150, v150, v151, s[80:81]
v_cndmask_b32 v154, v154, v155, s[80:81]
v_mfma_f32_16x16x32_bf16 v[176:179], a[48:51], a[208:211], v[176:179]
v_cndmask_b32 v136, v152, v148, s[82:83]
v_cndmask_b32 v137, v154, v150, s[84:85]
v_mfma_f32_16x16x32_bf16 v[168:171], a[64:67], a[212:215], v[168:171]
ds_read_b128 a[236:239], v21 offset:704
v_max_f32 v138, v136, v137
v_mfma_f32_16x16x32_bf16 v[172:175], a[212:215], a[68:71], v[172:175]
v_mov_b32 v139, v138
buffer_load_dwordx4 v51, s[16:19], s3 offen offset:3072 lds
v_mfma_f32_16x16x32_bf16 v[176:179], a[60:63], a[212:215], v[176:179]
v_permlane32_swap_b32 v138, v139
s_waitcnt lgkmcnt(4)
v_mfma_f32_16x16x32_bf16 v[168:171], a[76:79], a[216:219], v[168:171]
ds_read_b128 a[240:243], v21 offset:768
v_mfma_f32_16x16x32_bf16 v[172:175], a[216:219], a[80:83], v[172:175]
v_max_f32 v138, v138, v139
v_mov_b32 v139, v138
v_mfma_f32_16x16x32_bf16 v[176:179], a[72:75], a[216:219], v[176:179]
s_nop 0
v_permlane16_swap_b32 v138, v139
v_mfma_f32_16x16x32_bf16 v[168:171], a[88:91], a[220:223], v[168:171]
ds_read_b128 a[244:247], v21 offset:832
v_max_f32 v138, v138, v139
v_mfma_f32_16x16x32_bf16 v[172:175], a[220:223], a[92:95], v[172:175]
s_add_u32 m0, s90, 16384
s_add_u32 s3, s87, 131072
s_and_b32 s3, s3, 0x7ffff
buffer_load_dwordx4 v48, s[16:19], s3 offen offset:0 lds
v_mfma_f32_16x16x32_bf16 v[176:179], a[84:87], a[220:223], v[176:179]
v_mul_f32_e64 v138, -v138, s93
v_fma_f32 v136, v136, s93, v138
s_waitcnt lgkmcnt(4)
v_mfma_f32_16x16x32_bf16 v[168:171], a[100:103], a[224:227], v[168:171]
ds_read_b128 a[248:251], v21 offset:896
v_mfma_f32_16x16x32_bf16 v[172:175], a[224:227], a[104:107], v[172:175]
v_fma_f32 v137, v137, s93, v138
v_exp_f32 v136, v136
v_mfma_f32_16x16x32_bf16 v[176:179], a[96:99], a[224:227], v[176:179]
v_exp_f32 v137, v137
v_mfma_f32_16x16x32_bf16 v[168:171], a[112:115], a[228:231], v[168:171]
ds_read_b128 a[252:255], v21 offset:960
buffer_load_dwordx4 v49, s[16:19], s3 offen offset:1024 lds
v_mfma_f32_16x16x32_bf16 v[172:175], a[228:231], a[116:119], v[172:175]
v_add_f32 v138, v136, v137
v_mov_b32 v139, v138
v_mfma_f32_16x16x32_bf16 v[176:179], a[108:111], a[228:231], v[176:179]
s_nop 0
v_permlane32_swap_b32 v138, v139
s_waitcnt lgkmcnt(4)
v_mfma_f32_16x16x32_bf16 v[168:171], a[124:127], a[232:235], v[168:171]
s_waitcnt vmcnt(28)
s_barrier
ds_read_b128 a[192:195], v21 offset:16896
v_mfma_f32_16x16x32_bf16 v[172:175], a[232:235], a[128:131], v[172:175]
buffer_load_dwordx4 v50, s[16:19], s3 offen offset:2048 lds
v_add_f32 v138, v138, v139
v_mfma_f32_16x16x32_bf16 v[176:179], a[120:123], a[232:235], v[176:179]
v_mov_b32 v139, v138
s_nop 1
v_permlane16_swap_b32 v138, v139
v_mfma_f32_16x16x32_bf16 v[168:171], a[136:139], a[236:239], v[168:171]
ds_read_b128 a[196:199], v21 offset:16960
v_add_f32 v138, v138, v139
v_mfma_f32_16x16x32_bf16 v[172:175], a[236:239], a[140:143], v[172:175]
v_rcp_f32 v138, v138
v_mfma_f32_16x16x32_bf16 v[176:179], a[132:135], a[236:239], v[176:179]
v_mul_f32 v136, v136, v138
v_mul_f32 v137, v137, v138
s_waitcnt lgkmcnt(4)
v_mfma_f32_16x16x32_bf16 v[168:171], a[148:151], a[240:243], v[168:171]
ds_read_b128 a[200:203], v21 offset:17024
v_mfma_f32_16x16x32_bf16 v[172:175], a[240:243], a[152:155], v[172:175]
buffer_load_dwordx4 v51, s[16:19], s3 offen offset:3072 lds
v_cvt_pk_bf16_f32 v136, v136, v136
v_mfma_f32_16x16x32_bf16 v[176:179], a[144:147], a[240:243], v[176:179]
v_cvt_pk_bf16_f32 v137, v137, v137
v_and_b32 v158, v136, v24
v_mfma_f32_16x16x32_bf16 v[168:171], a[160:163], a[244:247], v[168:171]
ds_read_b128 a[204:207], v21 offset:17088
v_and_b32 v156, v136, v26
v_mfma_f32_16x16x32_bf16 v[172:175], a[244:247], a[164:167], v[172:175]
s_add_u32 m0, s90, 32768
s_add_u32 s3, s87, 262144
s_and_b32 s3, s3, 0x7ffff
buffer_load_dwordx4 v48, s[16:19], s3 offen offset:0 lds
v_mfma_f32_16x16x32_bf16 v[176:179], a[156:159], a[244:247], v[176:179]
v_and_b32 v159, v137, v25
v_and_b32 v157, v137, v27
s_waitcnt lgkmcnt(4)
v_mfma_f32_16x16x32_bf16 v[168:171], a[172:175], a[248:251], v[168:171]
ds_read_b128 a[208:211], v21 offset:17152
v_mfma_f32_16x16x32_bf16 v[172:175], a[248:251], a[176:179], v[172:175]
v_cvt_pk_bf16_f32 v68, v140, v141
v_cvt_pk_bf16_f32 v69, v142, v143
v_mfma_f32_16x16x32_bf16 v[176:179], a[168:171], a[248:251], v[176:179]
s_nop 0
v_mfma_f32_16x16x32_bf16 v[144:147], v[66:69], v[156:159], 0
v_mfma_f32_16x16x32_bf16 v[168:171], a[184:187], a[252:255], v[168:171]
ds_read_b128 a[212:215], v21 offset:17216
buffer_load_dwordx4 v49, s[16:19], s3 offen offset:1024 lds
v_mfma_f32_16x16x32_bf16 v[172:175], a[252:255], a[188:191], v[172:175]
s_nop 3
v_cvt_pk_bf16_f32 v226, v144, v145
v_cvt_pk_bf16_f32 v227, v146, v147
v_mfma_f32_16x16x32_bf16 v[176:179], a[180:183], a[252:255], v[176:179]
v_permlane16_swap_b32 v224, v226
s_waitcnt vmcnt(22)
v_xor_b32 v32, s76, v32
v_xor_b32 v33, s77, v33
v_xor_b32 v34, s78, v34
v_xor_b32 v35, s79, v35
v_or3_b32 v5, v32, v33, v34
v_xor_b32 v6, v39, v9
v_or_b32 v5, v5, v35
v_bitop3_b32 v6, v6, v41, v9 bitop3:0xf6
v_bitop3_b32 v6, v6, v43, v9 bitop3:0xf6
v_lshl_or_b32 v5, v5, 24, v6
v_cmp_ne_u32 vcc, 0, v5
s_cbranch_vccz go_8
retry_9:
s_sub_u32 s56, s56, 1
s_cbranch_scc1 L_end
s_sleep 2
buffer_load_dwordx4 v[32:35], v36, s[44:47], 0 offen sc1
buffer_load_dwordx4 v[40:43], v47, s[44:47], 0 offen sc1
buffer_load_dwordx2 v[38:39], v37, s[44:47], 0 offen sc1
s_waitcnt vmcnt(0)
v_xor_b32 v32, s76, v32
v_xor_b32 v33, s77, v33
v_xor_b32 v34, s78, v34
v_xor_b32 v35, s79, v35
v_or3_b32 v5, v32, v33, v34
v_xor_b32 v6, v39, v9
v_or_b32 v5, v5, v35
v_bitop3_b32 v6, v6, v41, v9 bitop3:0xf6
v_bitop3_b32 v6, v6, v43, v9 bitop3:0xf6
v_lshl_or_b32 v5, v5, 24, v6
v_cmp_ne_u32 vcc, 0, v5
s_cbranch_vccnz retry_9
go_8:
s_bitcmp1_b32 s52, 0
s_cselect_b32 s60, 8192, 0
s_add_u32 s60, s60, s1
s_cmp_eq_u32 s49, 2
s_cselect_b32 exec_lo, -1, 0
s_mov_b32 exec_hi, 0
buffer_load_dword v251, v255, s[44:47], s60 offen sc1 nt
buffer_load_dword v251, v255, s[44:47], s60 offen sc1
s_mov_b64 exec, -1
s_bitcmp1_b32 s52, 0
s_cselect_b32 s60, 8192, 0
s_add_u32 s60, s60, s1
s_add_u32 s60, s60, 4096
s_cmp_eq_u32 s49, 3
s_cselect_b32 exec_lo, -1, 0
s_mov_b32 exec_hi, 0
buffer_load_dword v251, v255, s[44:47], s60 offen sc1 nt
buffer_load_dword v251, v255, s[44:47], s60 offen sc1
s_mov_b64 exec, -1
s_bitcmp1_b32 s52, 0
s_cselect_b32 s60, 3072, 0
s_add_u32 s60, s60, s1
s_add_u32 s60, s60, 60416
s_cmp_eq_u32 s49, 1
s_cselect_b32 exec_lo, 16777215, 0
s_mov_b32 exec_hi, 0
buffer_load_dword v251, v255, s[44:47], s60 offen sc1 nt
buffer_load_dword v251, v255, s[44:47], s60 offen sc1
s_mov_b64 exec, -1
s_mul_i32 s60, s0, 5504
s_cmp_eq_u32 s49, 0
s_cselect_b32 exec_lo, -1, 0
s_cselect_b32 exec_hi, 2047, 0
buffer_load_dword v251, v255, s[24:27], s60 offen
s_mov_b64 exec, -1
s_waitcnt lgkmcnt(4)
v_mfma_f32_16x16x32_bf16 v[200:203], a[4:7], a[192:195], 0
ds_read_b128 a[216:219], v21 offset:17280
v_mfma_f32_16x16x32_bf16 v[204:207], a[192:195], a[8:11], 0
v_permlane16_swap_b32 v225, v227
v_mfma_f32_16x16x32_bf16 v[208:211], a[0:3], a[192:195], 0
v_cmp_ne_u32 s[74:75], s55, v38
v_permlane32_swap_b32 v32, v33
v_mfma_f32_16x16x32_bf16 v[200:203], a[16:19], a[196:199], v[200:203]
ds_read_b128 a[220:223], v21 offset:17344
v_permlane32_swap_b32 v34, v35
v_mfma_f32_16x16x32_bf16 v[204:207], a[196:199], a[20:23], v[204:207]
v_cvt_pk_bf16_f32 v86, v168, v169
v_add_f32 v32, v32, v33
v_mfma_f32_16x16x32_bf16 v[208:211], a[12:15], a[196:199], v[208:211]
v_cvt_pk_bf16_f32 v87, v170, v171
v_add_f32 v34, v34, v35
s_waitcnt lgkmcnt(4)
v_mfma_f32_16x16x32_bf16 v[200:203], a[28:31], a[200:203], v[200:203]
ds_read_b128 a[224:227], v21 offset:17408
v_mfma_f32_16x16x32_bf16 v[204:207], a[200:203], a[32:35], v[204:207]
v_cvt_pk_bf16_f32 v92, v176, v177
v_cvt_pk_bf16_f32 v93, v178, v179
v_mfma_f32_16x16x32_bf16 v[208:211], a[24:27], a[200:203], v[208:211]
s_nop 0
v_mfma_f32_16x16x32_bf16 v[180:183], v[84:87], v[90:93], 0
v_mfma_f32_16x16x32_bf16 v[200:203], a[40:43], a[204:207], v[200:203]
ds_read_b128 a[228:231], v21 offset:17472
s_cmp_eq_u32 s52, 2
s_cselect_b32 s57, 1.0, 0
v_mfma_f32_16x16x32_bf16 v[204:207], a[204:207], a[44:47], v[204:207]
v_mfma_f32_16x16x32_bf16 v[184:187], v[84:87], v[92:95], 0
v_mfma_f32_16x16x32_bf16 v[208:211], a[36:39], a[204:207], v[208:211]
v_permlane16_swap_b32 v32, v34
s_waitcnt lgkmcnt(4)
v_mfma_f32_16x16x32_bf16 v[200:203], a[52:55], a[208:211], v[200:203]
ds_read_b128 a[232:235], v21 offset:17536
v_mfma_f32_16x16x32_bf16 v[204:207], a[208:211], a[56:59], v[204:207]
v_add_f32 v32, v32, v34
v_cndmask_b32 v180, v180, v181, s[80:81]
v_mfma_f32_16x16x32_bf16 v[208:211], a[48:51], a[208:211], v[208:211]
v_cndmask_b32 v184, v184, v185, s[80:81]
v_cvt_pk_bf16_f32 v32, v32, v32
v_mfma_f32_16x16x32_bf16 v[200:203], a[64:67], a[212:215], v[200:203]
ds_read_b128 a[236:239], v21 offset:17600
v_cndmask_b32 v182, v182, v183, s[80:81]
v_mfma_f32_16x16x32_bf16 v[204:207], a[212:215], a[68:71], v[204:207]
v_cndmask_b32 v186, v186, v187, s[80:81]
v_and_b32 v34, 1, v3
v_mfma_f32_16x16x32_bf16 v[208:211], a[60:63], a[212:215], v[208:211]
v_cndmask_b32 v168, v184, v180, s[82:83]
v_and_b32 v32, s94, v32
s_waitcnt lgkmcnt(4)
v_mfma_f32_16x16x32_bf16 v[200:203], a[76:79], a[216:219], v[200:203]
ds_read_b128 a[240:243], v21 offset:17664
v_mfma_f32_16x16x32_bf16 v[204:207], a[216:219], a[80:83], v[204:207]
v_cndmask_b32 v169, v186, v182, s[84:85]
v_max_f32 v170, v168, v169
v_mfma_f32_16x16x32_bf16 v[208:211], a[72:75], a[216:219], v[208:211]
v_mov_b32 v171, v170
v_add_f32 v32, s57, v32
v_mfma_f32_16x16x32_bf16 v[200:203], a[88:91], a[220:223], v[200:203]
ds_read_b128 a[244:247], v21 offset:17728
v_permlane32_swap_b32 v170, v171
v_mfma_f32_16x16x32_bf16 v[204:207], a[220:223], a[92:95], v[204:207]
v_max_f32 v170, v170, v171
v_cvt_pk_bf16_f32 v32, v32, v32
v_mfma_f32_16x16x32_bf16 v[208:211], a[84:87], a[220:223], v[208:211]
v_mov_b32 v171, v170
v_lshrrev_b32 v35, 1, v3
s_waitcnt lgkmcnt(4)
v_mfma_f32_16x16x32_bf16 v[200:203], a[100:103], a[224:227], v[200:203]
ds_read_b128 a[248:251], v21 offset:17792
v_mfma_f32_16x16x32_bf16 v[204:207], a[224:227], a[104:107], v[204:207]
v_permlane16_swap_b32 v170, v171
v_mfma_f32_16x16x32_bf16 v[208:211], a[96:99], a[224:227], v[208:211]
v_max_f32 v170, v170, v171
v_mul_f32_e64 v170, -v170, s93
v_mfma_f32_16x16x32_bf16 v[200:203], a[112:115], a[228:231], v[200:203]
ds_read_b128 a[252:255], v21 offset:17856
v_lshl_add_u32 v34, v34, 1, v35
v_mfma_f32_16x16x32_bf16 v[204:207], a[228:231], a[116:119], v[204:207]
v_fma_f32 v168, v168, s93, v170
v_fma_f32 v169, v169, s93, v170
v_mfma_f32_16x16x32_bf16 v[208:211], a[108:111], a[228:231], v[208:211]
v_lshl_add_u32 v34, v4, 2, v34
v_exp_f32 v168, v168
s_waitcnt lgkmcnt(4)
v_mfma_f32_16x16x32_bf16 v[200:203], a[124:127], a[232:235], v[200:203]
v_exp_f32 v169, v169
v_mfma_f32_16x16x32_bf16 v[204:207], a[232:235], a[128:131], v[204:207]
v_and_b32 v32, s94, v32
v_add_f32 v170, v168, v169
v_mfma_f32_16x16x32_bf16 v[208:211], a[120:123], a[232:235], v[208:211]
v_mov_b32 v171, v170
s_lshl_b32 s57, s52, 8
v_mfma_f32_16x16x32_bf16 v[200:203], a[136:139], a[236:239], v[200:203]
v_permlane32_swap_b32 v170, v171
v_mfma_f32_16x16x32_bf16 v[204:207], a[236:239], a[140:143], v[204:207]
v_add_f32 v170, v170, v171
s_add_u32 s57, s57, 162304
v_mfma_f32_16x16x32_bf16 v[208:211], a[132:135], a[236:239], v[208:211]
v_mov_b32 v171, v170
v_lshl_add_u32 v34, v34, 2, s57
s_waitcnt lgkmcnt(2)
v_mfma_f32_16x16x32_bf16 v[200:203], a[148:151], a[240:243], v[200:203]
v_permlane16_swap_b32 v170, v171
v_mfma_f32_16x16x32_bf16 v[204:207], a[240:243], a[152:155], v[204:207]
v_add_f32 v170, v170, v171
ds_write_b32 v34, v32
v_mfma_f32_16x16x32_bf16 v[208:211], a[144:147], a[240:243], v[208:211]
v_rcp_f32 v170, v170
v_mfma_f32_16x16x32_bf16 v[200:203], a[160:163], a[244:247], v[200:203]
v_mul_f32 v168, v168, v170
v_add_f32_dpp v32, v32, v32 row_ror:8 row_mask:0xf bank_mask:0xf
v_mfma_f32_16x16x32_bf16 v[204:207], a[244:247], a[164:167], v[204:207]
v_mul_f32 v169, v169, v170
v_cvt_pk_bf16_f32 v168, v168, v168
v_mfma_f32_16x16x32_bf16 v[208:211], a[156:159], a[244:247], v[208:211]
v_add_f32_dpp v32, v32, v32 row_ror:4 row_mask:0xf bank_mask:0xf
v_cvt_pk_bf16_f32 v169, v169, v169
s_waitcnt lgkmcnt(1)
v_mfma_f32_16x16x32_bf16 v[200:203], a[172:175], a[248:251], v[200:203]
v_and_b32 v190, v168, v24
v_mfma_f32_16x16x32_bf16 v[204:207], a[248:251], a[176:179], v[204:207]
v_add_f32_dpp v32, v32, v32 row_ror:2 row_mask:0xf bank_mask:0xf
v_and_b32 v188, v168, v26
v_mfma_f32_16x16x32_bf16 v[208:211], a[168:171], a[248:251], v[208:211]
v_and_b32 v191, v169, v25
v_add_f32_dpp v32, v32, v32 row_ror:1 row_mask:0xf bank_mask:0xf
v_mfma_f32_16x16x32_bf16 v[200:203], a[184:187], a[252:255], v[200:203]
v_and_b32 v189, v169, v27
v_mov_b32 v34, v32
v_mfma_f32_16x16x32_bf16 v[204:207], a[252:255], a[188:191], v[204:207]
v_cvt_pk_bf16_f32 v70, v172, v173
v_cvt_pk_bf16_f32 v71, v174, v175
v_mfma_f32_16x16x32_bf16 v[208:211], a[180:183], a[252:255], v[208:211]
v_permlane32_swap_b32 v32, v34
v_add_f32 v32, v32, v34
v_mov_b32 v34, v32
s_nop 1
v_permlane16_swap_b32 v32, v34
v_add_f32 v32, v32, v34
v_mov_b32 v33, v9
s_waitcnt vmcnt(17)
s_waitcnt lgkmcnt(0)
s_barrier
v_mfma_f32_16x16x32_bf16 v[176:179], v[68:71], v[188:191], 0
s_nop 7
v_cvt_pk_bf16_f32 v228, v176, v177
v_cvt_pk_bf16_f32 v229, v178, v179
v_cvt_pk_bf16_f32 v88, v200, v201
v_cvt_pk_bf16_f32 v89, v202, v203
v_cvt_pk_bf16_f32 v92, v208, v209
v_cvt_pk_bf16_f32 v93, v210, v211
s_nop 1
v_mfma_f32_16x16x32_bf16 v[212:215], v[86:89], v[90:93], 0
v_mfma_f32_16x16x32_bf16 v[216:219], v[86:89], v[92:95], 0
s_nop 6
v_cndmask_b32 v212, v212, v213, s[80:81]
v_cndmask_b32 v216, v216, v217, s[80:81]
v_cndmask_b32 v214, v214, v215, s[80:81]
v_cndmask_b32 v218, v218, v219, s[80:81]
v_cndmask_b32 v200, v216, v212, s[82:83]
v_cndmask_b32 v201, v218, v214, s[84:85]
v_max_f32 v202, v200, v201
v_mov_b32 v203, v202
s_nop 1
v_permlane32_swap_b32 v202, v203
v_max_f32 v202, v202, v203
v_mov_b32 v203, v202
s_nop 1
v_permlane16_swap_b32 v202, v203
v_max_f32 v202, v202, v203
v_mul_f32_e64 v202, -v202, s93
v_fma_f32 v200, v200, s93, v202
v_fma_f32 v201, v201, s93, v202
v_exp_f32 v200, v200
v_exp_f32 v201, v201
s_nop 0
v_add_f32 v202, v200, v201
v_mov_b32 v203, v202
s_nop 1
v_permlane32_swap_b32 v202, v203
v_add_f32 v202, v202, v203
v_mov_b32 v203, v202
s_nop 1
v_permlane16_swap_b32 v202, v203
v_add_f32 v202, v202, v203
v_rcp_f32 v202, v202
s_nop 0
v_mul_f32 v200, v200, v202
v_mul_f32 v201, v201, v202
v_cvt_pk_bf16_f32 v200, v200, v200
v_cvt_pk_bf16_f32 v201, v201, v201
v_and_b32 v222, v200, v24
v_and_b32 v220, v200, v26
v_and_b32 v223, v201, v25
v_and_b32 v221, v201, v27
v_cvt_pk_bf16_f32 v72, v204, v205
v_cvt_pk_bf16_f32 v73, v206, v207
s_nop 1
v_mfma_f32_16x16x32_bf16 v[208:211], v[70:73], v[220:223], 0
s_nop 7
v_cvt_pk_bf16_f32 v230, v208, v209
v_cvt_pk_bf16_f32 v231, v210, v211
s_nop 0
v_permlane16_swap_b32 v228, v230
v_permlane16_swap_b32 v229, v231
s_cmp_lg_u64 s[74:75], 0
s_cbranch_scc1 L_slow
s_add_u32 s57, s95, 2097152
s_add_u32 s58, s95, 2230272
buffer_store_dwordx4 v[224:227], v252, s[44:47], s57 offen
buffer_store_dwordx4 v[228:231], v252, s[44:47], s58 offen
v_mov_b32 v60, v44
v_mov_b32 v61, v45
buffer_load_dwordx4 v50, s[16:19], s3 offen offset:2048 lds
buffer_load_dwordx4 v51, s[16:19], s3 offen offset:3072 lds
s_add_u32 m0, s90, 49152
s_add_u32 s3, s87, 393216
s_and_b32 s3, s3, 0x7ffff
buffer_load_dwordx4 v48, s[16:19], s3 offen offset:0 lds
buffer_load_dwordx4 v49, s[16:19], s3 offen offset:1024 lds
ds_read_b64_tr_b16 a[0:1], v56 offset:0
ds_read_b64_tr_b16 a[2:3], v56 offset:512
ds_read_b64_tr_b16 a[4:5], v57 offset:0
ds_read_b64_tr_b16 a[6:7], v57 offset:512
ds_read_b64_tr_b16 a[8:9], v58 offset:0
ds_read_b64_tr_b16 a[10:11], v58 offset:512
ds_read_b64_tr_b16 a[12:13], v59 offset:0
ds_read_b64_tr_b16 a[14:15], v59 offset:512
ds_read_b64_tr_b16 a[16:17], v56 offset:4096
ds_read_b64_tr_b16 a[18:19], v56 offset:4608
ds_read_b64_tr_b16 a[20:21], v57 offset:4096
ds_read_b64_tr_b16 a[22:23], v57 offset:4608
ds_read_b64_tr_b16 a[24:25], v58 offset:4096
ds_read_b64_tr_b16 a[26:27], v58 offset:4608
ds_read_b64_tr_b16 a[28:29], v59 offset:4096
ds_read_b64_tr_b16 a[30:31], v59 offset:4608
ds_read_b64_tr_b16 a[32:33], v56 offset:8192
ds_read_b64_tr_b16 a[34:35], v56 offset:8704
ds_read_b64_tr_b16 a[36:37], v57 offset:8192
ds_read_b64_tr_b16 a[38:39], v57 offset:8704
ds_read_b64_tr_b16 a[40:41], v58 offset:8192
ds_read_b64_tr_b16 a[42:43], v58 offset:8704
ds_read_b64_tr_b16 a[44:45], v59 offset:8192
ds_read_b64_tr_b16 a[46:47], v59 offset:8704
ds_read_b64_tr_b16 a[48:49], v56 offset:12288
ds_read_b64_tr_b16 a[50:51], v56 offset:12800
ds_read_b64_tr_b16 a[52:53], v57 offset:12288
ds_read_b64_tr_b16 a[54:55], v57 offset:12800
ds_read_b64_tr_b16 a[56:57], v58 offset:12288
ds_read_b64_tr_b16 a[58:59], v58 offset:12800
s_waitcnt vmcnt(4)
s_add_u32 s57, s61, 2162688
s_mov_b64 exec, 1
buffer_store_dwordx2 v[32:33], v10, s[44:47], s57 offen
s_mov_b64 exec, -1
buffer_load_dwordx4 v50, s[16:19], s3 offen offset:2048 lds
buffer_load_dwordx4 v51, s[16:19], s3 offen offset:3072 lds
ds_read_b64_tr_b16 a[60:61], v59 offset:12288
ds_read_b64_tr_b16 a[62:63], v59 offset:12800
ds_read_b64_tr_b16 a[64:65], v56 offset:16384
ds_read_b64_tr_b16 a[66:67], v56 offset:16896
ds_read_b64_tr_b16 a[68:69], v57 offset:16384
ds_read_b64_tr_b16 a[70:71], v57 offset:16896
ds_read_b64_tr_b16 a[72:73], v58 offset:16384
ds_read_b64_tr_b16 a[74:75], v58 offset:16896
ds_read_b64_tr_b16 a[76:77], v59 offset:16384
ds_read_b64_tr_b16 a[78:79], v59 offset:16896
ds_read_b64_tr_b16 a[80:81], v56 offset:20480
ds_read_b64_tr_b16 a[82:83], v56 offset:20992
s_mov_b32 s58, 2162688
s_mov_b32 exec_hi, 0
buffer_load_dwordx2 v[200:201], v11, s[44:47], s58 offen sc1
s_mov_b64 exec, -1
s_add_u32 m0, s90, 65536
s_add_u32 s3, s89, 0
buffer_load_dwordx4 v48, s[20:23], s3 offen offset:0 lds
buffer_load_dwordx4 v49, s[20:23], s3 offen offset:1024 lds
buffer_load_dwordx4 v50, s[20:23], s3 offen offset:2048 lds
v_cvt_pk_bf16_f32 v41, v40, v42
v_lshrrev_b32 v5, 4, v0
v_lshlrev_b32 v5, 6, v5
v_lshlrev_b32 v43, 16, v41
v_sub_f32 v40, v40, v43
v_bfe_u32 v6, v0, 1, 2
v_lshl_add_u32 v5, v6, 4, v5
v_and_b32 v43, s94, v41
v_sub_f32 v42, v42, v43
v_and_b32 v6, 8, v0
v_add_u32 v5, v5, v6
v_and_b32 v6, 1, v0
v_lshl_add_u32 v5, v6, 2, v5
v_cvt_pk_bf16_f32 v40, v40, v42
v_add_u32 v5, 160256, v5
ds_write_b32 v5, v41
ds_write_b32 v5, v40 offset:1024
v_and_b32 v6, 1, v4
v_lshlrev_b32 v6, 10, v6
v_lshl_add_u32 v6, v3, 4, v6
s_cmp_eq_u32 s52, 0
s_cselect_b32 s57, 256, 0
s_add_u32 s59, s57, 160256
s_sub_u32 s57, 160256, s57
v_add_u32 v249, s59, v6
v_add_u32 v250, s57, v6
v_and_b32 v5, 1, v3
v_lshlrev_b32 v5, 5, v5
v_lshrrev_b32 v6, 1, v3
v_lshl_add_u32 v5, v6, 4, v5
v_lshl_add_u32 v252, v4, 10, v5
ds_read_b64_tr_b16 a[84:85], v57 offset:20480
ds_read_b64_tr_b16 a[86:87], v57 offset:20992
ds_read_b64_tr_b16 a[88:89], v58 offset:20480
ds_read_b64_tr_b16 a[90:91], v58 offset:20992
ds_read_b64_tr_b16 a[92:93], v59 offset:20480
ds_read_b64_tr_b16 a[94:95], v59 offset:20992
ds_read_b64_tr_b16 a[96:97], v56 offset:24576
ds_read_b64_tr_b16 a[98:99], v56 offset:25088
ds_read_b64_tr_b16 a[100:101], v57 offset:24576
ds_read_b64_tr_b16 a[102:103], v57 offset:25088
ds_read_b64_tr_b16 a[104:105], v58 offset:24576
ds_read_b64_tr_b16 a[106:107], v58 offset:25088
ds_read_b64_tr_b16 a[108:109], v59 offset:24576
ds_read_b64_tr_b16 a[110:111], v59 offset:25088
ds_read_b64_tr_b16 a[112:113], v56 offset:28672
ds_read_b64_tr_b16 a[114:115], v56 offset:29184
ds_read_b64_tr_b16 a[116:117], v57 offset:28672
ds_read_b64_tr_b16 a[118:119], v57 offset:29184
ds_read_b64_tr_b16 a[120:121], v58 offset:28672
ds_read_b64_tr_b16 a[122:123], v58 offset:29184
ds_read_b64_tr_b16 a[124:125], v59 offset:28672
ds_read_b64_tr_b16 a[126:127], v59 offset:29184
ds_read_b64_tr_b16 a[128:129], v56 offset:32768
ds_read_b64_tr_b16 a[130:131], v56 offset:33280
ds_read_b64_tr_b16 a[132:133], v57 offset:32768
ds_read_b64_tr_b16 a[134:135], v57 offset:33280
ds_read_b64_tr_b16 a[136:137], v58 offset:32768
ds_read_b64_tr_b16 a[138:139], v58 offset:33280
ds_read_b64_tr_b16 a[140:141], v59 offset:32768
ds_read_b64_tr_b16 a[142:143], v59 offset:33280
s_mov_b32 exec_hi, 0
s_waitcnt vmcnt(3)
v_cmp_ne_u32 vcc, v201, v9
s_cbranch_vccz go_10
retry_11:
s_sub_u32 s56, s56, 1
s_cbranch_scc1 L_end
buffer_load_dwordx2 v[200:201], v11, s[44:47], s58 offen sc1
s_waitcnt vmcnt(0)
v_cmp_ne_u32 vcc, v201, v9
s_cbranch_vccnz retry_11
go_10:
s_mov_b64 exec, -1
s_mov_b32 s59, 2097152
buffer_load_dwordx4 v[64:67], v12, s[44:47], s59 offen offset:0 sc1
ds_read_b64_tr_b16 a[144:145], v56 offset:36864
ds_read_b64_tr_b16 a[146:147], v56 offset:37376
buffer_load_dwordx4 v[68:71], v12, s[44:47], s59 offen offset:1024 sc1
ds_read_b64_tr_b16 a[148:149], v57 offset:36864
ds_read_b64_tr_b16 a[150:151], v57 offset:37376
buffer_load_dwordx4 v[72:75], v12, s[44:47], s59 offen offset:2048 sc1
ds_read_b64_tr_b16 a[152:153], v58 offset:36864
ds_read_b64_tr_b16 a[154:155], v58 offset:37376
buffer_load_dwordx4 v[76:79], v12, s[44:47], s59 offen offset:3072 sc1
ds_read_b64_tr_b16 a[156:157], v59 offset:36864
ds_read_b64_tr_b16 a[158:159], v59 offset:37376
s_mov_b32 s59, 2101248
buffer_load_dwordx4 v[80:83], v12, s[44:47], s59 offen offset:0 sc1
ds_read_b64_tr_b16 a[160:161], v56 offset:40960
ds_read_b64_tr_b16 a[162:163], v56 offset:41472
buffer_load_dwordx4 v[84:87], v12, s[44:47], s59 offen offset:1024 sc1
ds_read_b64_tr_b16 a[164:165], v57 offset:40960
ds_read_b64_tr_b16 a[166:167], v57 offset:41472
s_waitcnt vmcnt(5) lgkmcnt(15)
v_mfma_f32_16x16x32_bf16 v[128:131], a[0:3], v[64:67], 0
buffer_load_dwordx4 v[88:91], v12, s[44:47], s59 offen offset:2048 sc1
ds_read_b64_tr_b16 a[168:169], v58 offset:40960
v_mfma_f32_16x16x32_bf16 v[132:135], a[4:7], v[64:67], 0
ds_read_b64_tr_b16 a[170:171], v58 offset:41472
v_mfma_f32_16x16x32_bf16 v[136:139], a[8:11], v[64:67], 0
buffer_load_dwordx4 v[92:95], v12, s[44:47], s59 offen offset:3072 sc1
ds_read_b64_tr_b16 a[172:173], v59 offset:40960
v_mfma_f32_16x16x32_bf16 v[140:143], a[12:15], v[64:67], 0
ds_read_b64_tr_b16 a[174:175], v59 offset:41472
s_waitcnt vmcnt(6)
v_mfma_f32_16x16x32_bf16 v[128:131], a[16:19], v[68:71], v[128:131]
s_mov_b32 s59, 2105344
buffer_load_dwordx4 v[96:99], v12, s[44:47], s59 offen offset:0 sc1
ds_read_b64_tr_b16 a[176:177], v56 offset:45056
v_mfma_f32_16x16x32_bf16 v[132:135], a[20:23], v[68:71], v[132:135]
ds_read_b64_tr_b16 a[178:179], v56 offset:45568
v_mfma_f32_16x16x32_bf16 v[136:139], a[24:27], v[68:71], v[136:139]
buffer_load_dwordx4 v[100:103], v12, s[44:47], s59 offen offset:1024 sc1
ds_read_b64_tr_b16 a[180:181], v57 offset:45056
v_mfma_f32_16x16x32_bf16 v[140:143], a[28:31], v[68:71], v[140:143]
s_waitcnt lgkmcnt(7)
s_barrier
s_waitcnt vmcnt(7)
v_mfma_f32_16x16x32_bf16 v[128:131], a[32:35], v[72:75], v[128:131]
buffer_load_dwordx4 v[104:107], v12, s[44:47], s59 offen offset:2048 sc1
ds_read_b64_tr_b16 a[182:183], v57 offset:45568
v_mfma_f32_16x16x32_bf16 v[132:135], a[36:39], v[72:75], v[132:135]
ds_read_b64_tr_b16 a[184:185], v58 offset:45056
ds_read_b64 v[18:19], v254 offset:0
v_mfma_f32_16x16x32_bf16 v[136:139], a[40:43], v[72:75], v[136:139]
ds_read_b64_tr_b16 a[186:187], v58 offset:45568
ds_read_b64 v[22:23], v254 offset:32
v_mfma_f32_16x16x32_bf16 v[140:143], a[44:47], v[72:75], v[140:143]
ds_read_b64_tr_b16 a[188:189], v59 offset:45056
s_waitcnt vmcnt(7)
v_mfma_f32_16x16x32_bf16 v[128:131], a[48:51], v[76:79], v[128:131]
buffer_load_dwordx4 v[108:111], v12, s[44:47], s59 offen offset:3072 sc1
ds_read_b64_tr_b16 a[190:191], v59 offset:45568
v_mfma_f32_16x16x32_bf16 v[132:135], a[52:55], v[76:79], v[132:135]
ds_read_b64_tr_b16 a[192:193], v56 offset:49152
ds_read_b64 v[26:27], v254 offset:64
v_mfma_f32_16x16x32_bf16 v[136:139], a[56:59], v[76:79], v[136:139]
ds_read_b64_tr_b16 a[194:195], v56 offset:49664
ds_read_b64 v[30:31], v254 offset:96
v_mfma_f32_16x16x32_bf16 v[140:143], a[60:63], v[76:79], v[140:143]
ds_read_b64_tr_b16 a[196:197], v57 offset:49152
s_waitcnt vmcnt(7)
v_mfma_f32_16x16x32_bf16 v[128:131], a[64:67], v[80:83], v[128:131]
s_mov_b32 s59, 2109440
buffer_load_dwordx4 v[112:115], v12, s[44:47], s59 offen offset:0 sc1
ds_read_b64_tr_b16 a[198:199], v57 offset:49664
v_mfma_f32_16x16x32_bf16 v[132:135], a[68:71], v[80:83], v[132:135]
ds_read_b64_tr_b16 a[200:201], v58 offset:49152
ds_read_b128 v[144:147], v14 offset:0
v_mfma_f32_16x16x32_bf16 v[136:139], a[72:75], v[80:83], v[136:139]
ds_read_b64_tr_b16 a[202:203], v58 offset:49664
ds_read_b128 v[148:151], v14 offset:64
v_mfma_f32_16x16x32_bf16 v[140:143], a[76:79], v[80:83], v[140:143]
ds_read_b64_tr_b16 a[204:205], v59 offset:49152
s_waitcnt vmcnt(7)
v_mfma_f32_16x16x32_bf16 v[128:131], a[80:83], v[84:87], v[128:131]
buffer_load_dwordx4 v[116:119], v12, s[44:47], s59 offen offset:1024 sc1
ds_read_b64_tr_b16 a[206:207], v59 offset:49664
v_mfma_f32_16x16x32_bf16 v[132:135], a[84:87], v[84:87], v[132:135]
ds_read_b64_tr_b16 a[208:209], v56 offset:53248
ds_read_b128 v[152:155], v14 offset:128
v_mfma_f32_16x16x32_bf16 v[136:139], a[88:91], v[84:87], v[136:139]
ds_read_b64_tr_b16 a[210:211], v56 offset:53760
ds_read_b128 v[156:159], v14 offset:192
v_mfma_f32_16x16x32_bf16 v[140:143], a[92:95], v[84:87], v[140:143]
ds_read_b64_tr_b16 a[212:213], v57 offset:53248
s_waitcnt vmcnt(7)
v_mfma_f32_16x16x32_bf16 v[128:131], a[96:99], v[88:91], v[128:131]
buffer_load_dwordx4 v[120:123], v12, s[44:47], s59 offen offset:2048 sc1
ds_read_b64_tr_b16 a[214:215], v57 offset:53760
v_mfma_f32_16x16x32_bf16 v[132:135], a[100:103], v[88:91], v[132:135]
ds_read_b64_tr_b16 a[216:217], v58 offset:53248
ds_read_b128 v[160:163], v14 offset:512
v_mfma_f32_16x16x32_bf16 v[136:139], a[104:107], v[88:91], v[136:139]
ds_read_b64_tr_b16 a[218:219], v58 offset:53760
ds_read_b128 v[164:167], v14 offset:576
v_mfma_f32_16x16x32_bf16 v[140:143], a[108:111], v[88:91], v[140:143]
ds_read_b64_tr_b16 a[220:221], v59 offset:53248
s_waitcnt vmcnt(7)
v_mfma_f32_16x16x32_bf16 v[128:131], a[112:115], v[92:95], v[128:131]
buffer_load_dwordx4 v[124:127], v12, s[44:47], s59 offen offset:3072 sc1
ds_read_b64_tr_b16 a[222:223], v59 offset:53760
v_mfma_f32_16x16x32_bf16 v[132:135], a[116:119], v[92:95], v[132:135]
ds_read_b64_tr_b16 a[224:225], v56 offset:57344
ds_read_b128 v[168:171], v14 offset:640
v_mfma_f32_16x16x32_bf16 v[136:139], a[120:123], v[92:95], v[136:139]
ds_read_b64_tr_b16 a[226:227], v56 offset:57856
ds_read_b128 v[172:175], v14 offset:704
v_mfma_f32_16x16x32_bf16 v[140:143], a[124:127], v[92:95], v[140:143]
ds_read_b64_tr_b16 a[228:229], v57 offset:57344
s_waitcnt vmcnt(7)
v_mfma_f32_16x16x32_bf16 v[128:131], a[128:131], v[96:99], v[128:131]
buffer_load_dword v251, v235, s[20:23], 0 offen offset:384
buffer_load_dwordx4 v51, s[20:23], s3 offen offset:3072 lds
ds_read_b64_tr_b16 a[230:231], v57 offset:57856
v_mfma_f32_16x16x32_bf16 v[132:135], a[132:135], v[96:99], v[132:135]
ds_read_b64_tr_b16 a[232:233], v58 offset:57344
s_waitcnt lgkmcnt(15)
v_lshlrev_b32 v16, 16, v18
v_mfma_f32_16x16x32_bf16 v[136:139], a[136:139], v[96:99], v[136:139]
ds_read_b64_tr_b16 a[234:235], v58 offset:57856
v_and_b32 v17, s94, v18
v_mfma_f32_16x16x32_bf16 v[140:143], a[140:143], v[96:99], v[140:143]
ds_read_b64_tr_b16 a[236:237], v59 offset:57344
s_waitcnt vmcnt(8)
v_mfma_f32_16x16x32_bf16 v[128:131], a[144:147], v[100:103], v[128:131]
s_add_u32 m0, s90, 81920
s_add_u32 s3, s89, 131072
buffer_load_dwordx4 v48, s[20:23], s3 offen offset:0 lds
ds_read_b64_tr_b16 a[238:239], v59 offset:57856
v_mfma_f32_16x16x32_bf16 v[132:135], a[148:151], v[100:103], v[132:135]
ds_read_b64_tr_b16 a[240:241], v56 offset:61440
v_lshlrev_b32 v18, 16, v19
v_mfma_f32_16x16x32_bf16 v[136:139], a[152:155], v[100:103], v[136:139]
ds_read_b64_tr_b16 a[242:243], v56 offset:61952
v_and_b32 v19, s94, v19
v_mfma_f32_16x16x32_bf16 v[140:143], a[156:159], v[100:103], v[140:143]
ds_read_b64_tr_b16 a[244:245], v57 offset:61440
s_waitcnt vmcnt(8)
v_mfma_f32_16x16x32_bf16 v[128:131], a[160:163], v[104:107], v[128:131]
buffer_load_dwordx4 v49, s[20:23], s3 offen offset:1024 lds
ds_read_b64_tr_b16 a[246:247], v57 offset:61952
v_mfma_f32_16x16x32_bf16 v[132:135], a[164:167], v[104:107], v[132:135]
ds_read_b64_tr_b16 a[248:249], v58 offset:61440
v_lshlrev_b32 v20, 16, v22
v_mfma_f32_16x16x32_bf16 v[136:139], a[168:171], v[104:107], v[136:139]
ds_read_b64_tr_b16 a[250:251], v58 offset:61952
v_and_b32 v21, s94, v22
v_mfma_f32_16x16x32_bf16 v[140:143], a[172:175], v[104:107], v[140:143]
ds_read_b64_tr_b16 a[252:253], v59 offset:61440
s_waitcnt vmcnt(8)
v_mfma_f32_16x16x32_bf16 v[128:131], a[176:179], v[108:111], v[128:131]
buffer_load_dwordx4 v50, s[20:23], s3 offen offset:2048 lds
ds_read_b64_tr_b16 a[254:255], v59 offset:61952
v_mfma_f32_16x16x32_bf16 v[132:135], a[180:183], v[108:111], v[132:135]
ds_read_b64_tr_b16 a[0:1], v236 offset:0
v_lshlrev_b32 v22, 16, v23
v_mfma_f32_16x16x32_bf16 v[136:139], a[184:187], v[108:111], v[136:139]
ds_read_b64_tr_b16 a[2:3], v236 offset:2048
v_and_b32 v23, s94, v23
v_mfma_f32_16x16x32_bf16 v[140:143], a[188:191], v[108:111], v[140:143]
ds_read_b64_tr_b16 a[4:5], v237 offset:0
s_waitcnt vmcnt(8)
v_mfma_f32_16x16x32_bf16 v[128:131], a[192:195], v[112:115], v[128:131]
buffer_load_dwordx4 v51, s[20:23], s3 offen offset:3072 lds
ds_read_b64_tr_b16 a[6:7], v237 offset:2048
v_mfma_f32_16x16x32_bf16 v[132:135], a[196:199], v[112:115], v[132:135]
ds_read_b64_tr_b16 a[8:9], v238 offset:0
v_lshlrev_b32 v24, 16, v26
v_mfma_f32_16x16x32_bf16 v[136:139], a[200:203], v[112:115], v[136:139]
ds_read_b64_tr_b16 a[10:11], v238 offset:2048
v_and_b32 v25, s94, v26
v_mfma_f32_16x16x32_bf16 v[140:143], a[204:207], v[112:115], v[140:143]
ds_read_b64_tr_b16 a[12:13], v239 offset:0
s_waitcnt vmcnt(8) lgkmcnt(15)
v_mfma_f32_16x16x32_bf16 v[128:131], a[208:211], v[116:119], v[128:131]
s_add_u32 m0, s90, 98304
s_add_u32 s3, s89, 262144
buffer_load_dwordx4 v48, s[20:23], s3 offen offset:0 lds
ds_read_b64_tr_b16 a[14:15], v239 offset:2048
v_mfma_f32_16x16x32_bf16 v[132:135], a[212:215], v[116:119], v[132:135]
ds_read_b64_tr_b16 a[16:17], v236 offset:4096
v_lshlrev_b32 v26, 16, v27
v_mfma_f32_16x16x32_bf16 v[136:139], a[216:219], v[116:119], v[136:139]
ds_read_b64_tr_b16 a[18:19], v236 offset:6144
v_and_b32 v27, s94, v27
v_mfma_f32_16x16x32_bf16 v[140:143], a[220:223], v[116:119], v[140:143]
ds_read_b64_tr_b16 a[20:21], v237 offset:4096
s_waitcnt vmcnt(8)
v_mfma_f32_16x16x32_bf16 v[128:131], a[224:227], v[120:123], v[128:131]
buffer_load_dwordx4 v49, s[20:23], s3 offen offset:1024 lds
ds_read_b64_tr_b16 a[22:23], v237 offset:6144
v_mfma_f32_16x16x32_bf16 v[132:135], a[228:231], v[120:123], v[132:135]
ds_read_b64_tr_b16 a[24:25], v238 offset:4096
v_lshlrev_b32 v28, 16, v30
v_mfma_f32_16x16x32_bf16 v[136:139], a[232:235], v[120:123], v[136:139]
ds_read_b64_tr_b16 a[26:27], v238 offset:6144
v_and_b32 v29, s94, v30
v_mfma_f32_16x16x32_bf16 v[140:143], a[236:239], v[120:123], v[140:143]
ds_read_b64_tr_b16 a[28:29], v239 offset:4096
s_waitcnt vmcnt(8) lgkmcnt(15)
v_mfma_f32_16x16x32_bf16 v[128:131], a[240:243], v[124:127], v[128:131]
buffer_load_dwordx4 v50, s[20:23], s3 offen offset:2048 lds
ds_read_b64_tr_b16 a[30:31], v239 offset:6144
v_mfma_f32_16x16x32_bf16 v[132:135], a[244:247], v[124:127], v[132:135]
ds_read_b64_tr_b16 a[32:33], v236 offset:8192
v_lshlrev_b32 v30, 16, v31
v_mfma_f32_16x16x32_bf16 v[136:139], a[248:251], v[124:127], v[136:139]
ds_read_b64_tr_b16 a[34:35], v236 offset:10240
v_and_b32 v31, s94, v31
v_mfma_f32_16x16x32_bf16 v[140:143], a[252:255], v[124:127], v[140:143]
ds_read_b64_tr_b16 a[36:37], v237 offset:8192
s_waitcnt lgkmcnt(0)
s_barrier
v_pk_fma_f32 v[16:17], v[128:129], v[144:145], v[16:17]
v_pk_fma_f32 v[18:19], v[130:131], v[146:147], v[18:19]
v_pk_fma_f32 v[20:21], v[132:133], v[148:149], v[20:21]
v_pk_fma_f32 v[22:23], v[134:135], v[150:151], v[22:23]
v_pk_fma_f32 v[24:25], v[136:137], v[152:153], v[24:25]
v_pk_fma_f32 v[26:27], v[138:139], v[154:155], v[26:27]
v_pk_fma_f32 v[28:29], v[140:141], v[156:157], v[28:29]
v_pk_fma_f32 v[30:31], v[142:143], v[158:159], v[30:31]
v_pk_add_f32 v[224:225], v[16:17], v[18:19]
v_pk_add_f32 v[224:225], v[224:225], v[20:21]
v_pk_add_f32 v[224:225], v[224:225], v[22:23]
v_pk_add_f32 v[224:225], v[224:225], v[24:25]
v_pk_add_f32 v[224:225], v[224:225], v[26:27]
v_pk_add_f32 v[224:225], v[224:225], v[28:29]
v_pk_add_f32 v[224:225], v[224:225], v[30:31]
v_add_f32 v204, v224, v225
v_pk_mul_f32 v[226:227], v[16:17], v[16:17]
v_pk_fma_f32 v[226:227], v[18:19], v[18:19], v[226:227]
v_pk_fma_f32 v[226:227], v[20:21], v[20:21], v[226:227]
v_pk_fma_f32 v[226:227], v[22:23], v[22:23], v[226:227]
v_pk_fma_f32 v[226:227], v[24:25], v[24:25], v[226:227]
v_pk_fma_f32 v[226:227], v[26:27], v[26:27], v[226:227]
v_pk_fma_f32 v[226:227], v[28:29], v[28:29], v[226:227]
v_pk_fma_f32 v[226:227], v[30:31], v[30:31], v[226:227]
v_add_f32 v205, v226, v227
v_pk_mul_f32 v[228:229], v[16:17], v[160:161]
v_pk_fma_f32 v[228:229], v[18:19], v[162:163], v[228:229]
v_pk_fma_f32 v[228:229], v[20:21], v[164:165], v[228:229]
v_pk_fma_f32 v[228:229], v[22:23], v[166:167], v[228:229]
v_pk_fma_f32 v[228:229], v[24:25], v[168:169], v[228:229]
v_pk_fma_f32 v[228:229], v[26:27], v[170:171], v[228:229]
v_pk_fma_f32 v[228:229], v[28:29], v[172:173], v[228:229]
v_pk_fma_f32 v[228:229], v[30:31], v[174:175], v[228:229]
v_add_f32 v206, v228, v229
v_mov_b32 v207, v9
s_lshr_b32 s57, s62, 3
s_add_u32 s57, s57, 2157568
s_mov_b32 s58, 2157568
v_mov_b32 v208, v204
v_mov_b32 v209, v205
v_mov_b32 v210, v206
v_permlane32_swap_b32 v204, v208
v_permlane32_swap_b32 v205, v209
v_permlane32_swap_b32 v206, v210
v_add_f32 v204, v204, v208
v_add_f32 v205, v205, v209
v_add_f32 v206, v206, v210
v_mov_b32 v208, v204
v_mov_b32 v209, v205
v_mov_b32 v210, v206
v_permlane16_swap_b32 v204, v208
v_permlane16_swap_b32 v205, v209
v_permlane16_swap_b32 v206, v210
v_add_f32 v204, v204, v208
v_add_f32 v205, v205, v209
v_add_f32 v206, v206, v210
s_mov_b64 exec, 0xffff
buffer_store_dwordx4 v[204:207], v12, s[44:47], s57 offen
s_mov_b64 exec, -1
buffer_load_dwordx4 v51, s[20:23], s3 offen offset:3072 lds
s_add_u32 m0, s90, 114688
s_add_u32 s3, s89, 393216
buffer_load_dwordx4 v48, s[20:23], s3 offen offset:0 lds
ds_read_b64_tr_b16 a[38:39], v237 offset:10240
ds_read_b64_tr_b16 a[40:41], v238 offset:8192
ds_read_b64_tr_b16 a[42:43], v238 offset:10240
ds_read_b64_tr_b16 a[44:45], v239 offset:8192
ds_read_b64_tr_b16 a[46:47], v239 offset:10240
ds_read_b64_tr_b16 a[48:49], v236 offset:12288
ds_read_b64_tr_b16 a[50:51], v236 offset:14336
ds_read_b64_tr_b16 a[52:53], v237 offset:12288
ds_read_b64_tr_b16 a[54:55], v237 offset:14336
ds_read_b64_tr_b16 a[56:57], v238 offset:12288
ds_read_b64_tr_b16 a[58:59], v238 offset:14336
ds_read_b64_tr_b16 a[60:61], v239 offset:12288
ds_read_b64_tr_b16 a[62:63], v239 offset:14336
ds_read_b64_tr_b16 a[64:65], v236 offset:16384
ds_read_b64_tr_b16 a[66:67], v236 offset:18432
ds_read_b64_tr_b16 a[68:69], v237 offset:16384
buffer_load_dwordx4 v[212:215], v12, s[44:47], s58 offen sc1
buffer_load_dwordx4 v[216:219], v12, s[44:47], s58 offen offset:1024 sc1
buffer_load_dwordx4 v49, s[20:23], s3 offen offset:1024 lds
buffer_load_dwordx4 v50, s[20:23], s3 offen offset:2048 lds
buffer_load_dwordx4 v51, s[20:23], s3 offen offset:3072 lds
s_add_u32 m0, s86, 131072
s_mul_i32 s3, s50, 176128
buffer_load_dwordx4 v60, s[24:27], s3 offen offset:0 lds
s_add_u32 m0, m0, 3968
ds_read_b128 v[176:179], v14 offset:256
ds_read_b128 v[180:183], v14 offset:320
ds_read_b128 v[184:187], v14 offset:384
ds_read_b128 v[188:191], v14 offset:448
v_add_f32_dpp v200, v200, v200 row_ror:4 row_mask:0xf bank_mask:0xf
ds_read_b64_tr_b16 a[70:71], v237 offset:18432
ds_read_b64_tr_b16 a[72:73], v238 offset:16384
v_add_f32_dpp v200, v200, v200 row_ror:8 row_mask:0xf bank_mask:0xf
v_mov_b32 v201, v200
ds_read_b64_tr_b16 a[74:75], v238 offset:18432
ds_read_b64_tr_b16 a[76:77], v239 offset:16384
v_permlane16_swap_b32 v200, v201
v_add_f32 v200, v200, v201
v_mul_f32 v200, s91, v200
ds_read_b64_tr_b16 a[78:79], v239 offset:18432
v_readlane_b32 s93, v200, 1
v_readlane_b32 s92, v200, 2
ds_read_b64_tr_b16 a[80:81], v236 offset:20480
ds_read_b64_tr_b16 a[82:83], v236 offset:22528
ds_read_b64_tr_b16 a[84:85], v237 offset:20480
ds_read_b64_tr_b16 a[86:87], v237 offset:22528
ds_read_b64_tr_b16 a[88:89], v238 offset:20480
ds_read_b64_tr_b16 a[90:91], v238 offset:22528
ds_read_b64_tr_b16 a[92:93], v239 offset:20480
ds_read_b64_tr_b16 a[94:95], v239 offset:22528
ds_read_b64_tr_b16 a[96:97], v236 offset:24576
ds_read_b64_tr_b16 a[98:99], v236 offset:26624
ds_read_b64_tr_b16 a[100:101], v237 offset:24576
ds_read_b64_tr_b16 a[102:103], v237 offset:26624
s_waitcnt vmcnt(4)
v_xor_b32 v211, v215, v9
v_bitop3_b32 v211, v211, v219, v9 bitop3:0xf6
v_cmp_ne_u32 vcc, 0, v211
s_cbranch_vccz go_12
retry_13:
s_sub_u32 s56, s56, 1
s_cbranch_scc1 L_end
buffer_load_dwordx4 v[212:215], v12, s[44:47], s58 offen sc1
buffer_load_dwordx4 v[216:219], v12, s[44:47], s58 offen offset:1024 sc1
s_waitcnt vmcnt(0)
v_xor_b32 v211, v215, v9
v_bitop3_b32 v211, v211, v219, v9 bitop3:0xf6
v_cmp_ne_u32 vcc, 0, v211
s_cbranch_vccnz retry_13
go_12:
v_add_f32 v204, v212, v216
v_add_f32 v205, v213, v217
v_add_f32 v206, v214, v218
v_mov_b32 v208, v204
v_mov_b32 v209, v205
v_mov_b32 v210, v206
v_permlane32_swap_b32 v204, v208
v_permlane32_swap_b32 v205, v209
v_permlane32_swap_b32 v206, v210
v_add_f32 v204, v204, v208
v_add_f32 v205, v205, v209
v_add_f32 v206, v206, v210
v_mov_b32 v208, v204
v_mov_b32 v209, v205
v_mov_b32 v210, v206
v_permlane16_swap_b32 v204, v208
v_permlane16_swap_b32 v205, v209
v_permlane16_swap_b32 v206, v210
v_add_f32 v204, v204, v208
v_add_f32 v205, v205, v209
v_add_f32 v206, v206, v210
s_waitcnt lgkmcnt(0)
v_mov_b32 v208, 0x3727c5ac
v_mul_f32 v204, s91, v204
v_mul_f32 v206, s91, v206
v_fma_f32 v208, -v204, v204, v208
v_fma_f32 v208, v205, s91, v208
v_rsq_f32 v208, v208
v_fma_f32 v206, -v204, s92, v206
v_mul_f32_e64 v209, -v204, v208
v_fma_f32 v210, v206, v208, s93
v_pk_fma_f32 v[32:33], v[16:17], v[208:209], v[208:209] op_sel:[0,0,1] op_sel_hi:[1,0,1]
v_pk_fma_f32 v[34:35], v[18:19], v[208:209], v[208:209] op_sel:[0,0,1] op_sel_hi:[1,0,1]
v_pk_fma_f32 v[36:37], v[20:21], v[208:209], v[208:209] op_sel:[0,0,1] op_sel_hi:[1,0,1]
v_pk_fma_f32 v[38:39], v[22:23], v[208:209], v[208:209] op_sel:[0,0,1] op_sel_hi:[1,0,1]
v_pk_fma_f32 v[40:41], v[24:25], v[208:209], v[208:209] op_sel:[0,0,1] op_sel_hi:[1,0,1]
v_pk_fma_f32 v[42:43], v[26:27], v[208:209], v[208:209] op_sel:[0,0,1] op_sel_hi:[1,0,1]
v_pk_fma_f32 v[44:45], v[28:29], v[208:209], v[208:209] op_sel:[0,0,1] op_sel_hi:[1,0,1]
v_pk_fma_f32 v[46:47], v[30:31], v[208:209], v[208:209] op_sel:[0,0,1] op_sel_hi:[1,0,1]
v_pk_fma_f32 v[32:33], v[32:33], v[160:161], v[176:177]
v_pk_fma_f32 v[34:35], v[34:35], v[162:163], v[178:179]
v_pk_fma_f32 v[36:37], v[36:37], v[164:165], v[180:181]
v_pk_fma_f32 v[38:39], v[38:39], v[166:167], v[182:183]
v_pk_fma_f32 v[40:41], v[40:41], v[168:169], v[184:185]
v_pk_fma_f32 v[42:43], v[42:43], v[170:171], v[186:187]
v_pk_fma_f32 v[44:45], v[44:45], v[172:173], v[188:189]
v_pk_fma_f32 v[46:47], v[46:47], v[174:175], v[190:191]
v_pk_add_f32 v[144:145], v[32:33], v[210:211] op_sel:[0,0] op_sel_hi:[1,0] neg_lo:[0,1] neg_hi:[0,1]
v_pk_add_f32 v[146:147], v[34:35], v[210:211] op_sel:[0,0] op_sel_hi:[1,0] neg_lo:[0,1] neg_hi:[0,1]
v_pk_add_f32 v[148:149], v[36:37], v[210:211] op_sel:[0,0] op_sel_hi:[1,0] neg_lo:[0,1] neg_hi:[0,1]
v_pk_add_f32 v[150:151], v[38:39], v[210:211] op_sel:[0,0] op_sel_hi:[1,0] neg_lo:[0,1] neg_hi:[0,1]
v_pk_add_f32 v[152:153], v[40:41], v[210:211] op_sel:[0,0] op_sel_hi:[1,0] neg_lo:[0,1] neg_hi:[0,1]
v_pk_add_f32 v[154:155], v[42:43], v[210:211] op_sel:[0,0] op_sel_hi:[1,0] neg_lo:[0,1] neg_hi:[0,1]
v_pk_add_f32 v[156:157], v[44:45], v[210:211] op_sel:[0,0] op_sel_hi:[1,0] neg_lo:[0,1] neg_hi:[0,1]
v_pk_add_f32 v[158:159], v[46:47], v[210:211] op_sel:[0,0] op_sel_hi:[1,0] neg_lo:[0,1] neg_hi:[0,1]
v_cvt_pk_bf16_f32 v64, v144, v145
v_cvt_pk_bf16_f32 v65, v146, v147
v_cvt_pk_bf16_f32 v66, v148, v149
v_cvt_pk_bf16_f32 v67, v150, v151
v_cvt_pk_bf16_f32 v68, v152, v153
v_cvt_pk_bf16_f32 v69, v154, v155
v_cvt_pk_bf16_f32 v70, v156, v157
v_cvt_pk_bf16_f32 v71, v158, v159
s_add_u32 s57, s62, 2097152
buffer_store_dwordx4 v[64:67], v12, s[44:47], s57 offen
buffer_store_dwordx4 v[68:71], v12, s[44:47], s57 offen offset:1024
v_mov_b32 v248, v210
v_pk_mul_f32 v[224:225], v[144:145], v[144:145]
v_pk_fma_f32 v[224:225], v[146:147], v[146:147], v[224:225]
v_pk_fma_f32 v[224:225], v[148:149], v[148:149], v[224:225]
v_pk_fma_f32 v[224:225], v[150:151], v[150:151], v[224:225]
v_pk_fma_f32 v[224:225], v[152:153], v[152:153], v[224:225]
v_pk_fma_f32 v[224:225], v[154:155], v[154:155], v[224:225]
v_pk_fma_f32 v[224:225], v[156:157], v[156:157], v[224:225]
v_pk_fma_f32 v[224:225], v[158:159], v[158:159], v[224:225]
v_add_f32 v204, v224, v225
v_mov_b32 v206, v204
s_nop 1
v_permlane32_swap_b32 v204, v206
v_add_f32 v204, v204, v206
v_mov_b32 v206, v204
s_nop 1
v_permlane16_swap_b32 v204, v206
v_add_f32 v204, v204, v206
v_mov_b32 v205, v9
buffer_load_dwordx4 v60, s[24:27], s3 offen offset:128 lds
s_add_u32 m0, m0, 4224
s_nop 0
buffer_load_dwordx4 v61, s[24:27], s3 offen offset:0 lds
s_add_u32 m0, s86, 143360
s_add_u32 s3, s3, 88064
buffer_load_dwordx4 v60, s[24:27], s3 offen offset:0 lds
s_add_u32 m0, m0, 3968
s_nop 0
buffer_load_dwordx4 v60, s[24:27], s3 offen offset:128 lds
s_add_u32 m0, m0, 4224
ds_read_b64_tr_b16 a[104:105], v238 offset:24576
ds_read_b64_tr_b16 a[106:107], v238 offset:26624
ds_read_b64_tr_b16 a[108:109], v239 offset:24576
ds_read_b64_tr_b16 a[110:111], v239 offset:26624
ds_read_b64_tr_b16 a[112:113], v236 offset:28672
ds_read_b64_tr_b16 a[114:115], v236 offset:30720
ds_read_b64_tr_b16 a[116:117], v237 offset:28672
ds_read_b64_tr_b16 a[118:119], v237 offset:30720
ds_read_b64_tr_b16 a[120:121], v238 offset:28672
ds_read_b64_tr_b16 a[122:123], v238 offset:30720
ds_read_b64_tr_b16 a[124:125], v239 offset:28672
ds_read_b64_tr_b16 a[126:127], v239 offset:30720
ds_read_b64_tr_b16 a[128:129], v236 offset:32768
ds_read_b64_tr_b16 a[130:131], v236 offset:34816
ds_read_b64_tr_b16 a[132:133], v237 offset:32768
ds_read_b64_tr_b16 a[134:135], v237 offset:34816
ds_read_b64_tr_b16 a[136:137], v238 offset:32768
ds_read_b64_tr_b16 a[138:139], v238 offset:34816
ds_read_b64_tr_b16 a[140:141], v239 offset:32768
ds_read_b64_tr_b16 a[142:143], v239 offset:34816
s_waitcnt vmcnt(4)
s_mov_b64 exec, 0xffff
buffer_store_dwordx2 v[204:205], v12, s[44:47], s38 offen
s_mov_b64 exec, -1
buffer_load_dwordx4 v61, s[24:27], s3 offen offset:0 lds
ds_read_b64_tr_b16 a[144:145], v236 offset:36864
ds_read_b64_tr_b16 a[146:147], v236 offset:38912
ds_read_b64_tr_b16 a[148:149], v237 offset:36864
ds_read_b64_tr_b16 a[150:151], v237 offset:38912
ds_read_b64_tr_b16 a[152:153], v238 offset:36864
ds_read_b64_tr_b16 a[154:155], v238 offset:38912
ds_read_b64_tr_b16 a[156:157], v239 offset:36864
ds_read_b64_tr_b16 a[158:159], v239 offset:38912
ds_read_b64_tr_b16 a[160:161], v236 offset:40960
ds_read_b64_tr_b16 a[162:163], v236 offset:43008
ds_read_b64_tr_b16 a[164:165], v237 offset:40960
ds_read_b64_tr_b16 a[166:167], v237 offset:43008
ds_read_b64_tr_b16 a[168:169], v238 offset:40960
ds_read_b64_tr_b16 a[170:171], v238 offset:43008
ds_read_b64_tr_b16 a[172:173], v239 offset:40960
ds_read_b64_tr_b16 a[174:175], v239 offset:43008
ds_read_b64_tr_b16 a[176:177], v236 offset:45056
ds_read_b64_tr_b16 a[178:179], v236 offset:47104
s_mov_b32 s58, 2161664
buffer_load_dwordx4 v[200:203], v12, s[44:47], s58 offen sc1
s_cmp_eq_u32 s52, 0
s_cselect_b32 s72, 16384, 0
s_add_u32 s73, s72, 65536
s_sub_u32 s72, 65536, s72
v_add_u32 v56, s73, v236
v_add_u32 v57, s73, v237
v_add_u32 v58, s73, v238
v_add_u32 v59, s73, v239
v_add_u32 v52, s72, v236
v_add_u32 v53, s72, v237
v_add_u32 v54, s72, v238
v_add_u32 v55, s72, v239
ds_read_b64_tr_b16 a[180:181], v237 offset:45056
ds_read_b64_tr_b16 a[182:183], v237 offset:47104
ds_read_b64_tr_b16 a[184:185], v238 offset:45056
ds_read_b64_tr_b16 a[186:187], v238 offset:47104
ds_read_b64_tr_b16 a[188:189], v239 offset:45056
ds_read_b64_tr_b16 a[190:191], v239 offset:47104
ds_read_b64_tr_b16 a[192:193], v236 offset:49152
ds_read_b64_tr_b16 a[194:195], v236 offset:51200
ds_read_b64_tr_b16 a[196:197], v237 offset:49152
ds_read_b64_tr_b16 a[198:199], v237 offset:51200
ds_read_b64_tr_b16 a[200:201], v238 offset:49152
ds_read_b64_tr_b16 a[202:203], v238 offset:51200
ds_read_b64_tr_b16 a[204:205], v239 offset:49152
ds_read_b64_tr_b16 a[206:207], v239 offset:51200
ds_read_b64_tr_b16 a[208:209], v236 offset:53248
ds_read_b64_tr_b16 a[210:211], v236 offset:55296
ds_read_b64_tr_b16 a[212:213], v237 offset:53248
ds_read_b64_tr_b16 a[214:215], v237 offset:55296
ds_read_b64_tr_b16 a[216:217], v238 offset:53248
ds_read_b64_tr_b16 a[218:219], v238 offset:55296
ds_read_b64_tr_b16 a[220:221], v239 offset:53248
ds_read_b64_tr_b16 a[222:223], v239 offset:55296
ds_read_b64_tr_b16 a[224:225], v236 offset:57344
ds_read_b64_tr_b16 a[226:227], v236 offset:59392
s_waitcnt vmcnt(0)
v_xor_b32 v5, v201, v9
v_bitop3_b32 v5, v5, v203, v9 bitop3:0xf6
v_cmp_ne_u32 vcc, 0, v5
s_cbranch_vccz go_14
retry_15:
s_sub_u32 s56, s56, 1
s_cbranch_scc1 L_end
buffer_load_dwordx4 v[200:203], v12, s[44:47], s58 offen sc1
s_waitcnt vmcnt(0)
v_xor_b32 v5, v201, v9
v_bitop3_b32 v5, v5, v203, v9 bitop3:0xf6
v_cmp_ne_u32 vcc, 0, v5
s_cbranch_vccnz retry_15
go_14:
v_add_u32 v7, 2097152, v12
s_add_u32 s59, s62, 2048
s_and_b32 s59, s59, 0x3fff
buffer_load_dwordx4 v[72:75], v7, s[44:47], s59 offen offset:0 sc1
buffer_load_dwordx4 v[76:79], v7, s[44:47], s59 offen offset:1024 sc1
s_add_u32 s59, s59, 2048
s_and_b32 s59, s59, 0x3fff
buffer_load_dwordx4 v[80:83], v7, s[44:47], s59 offen offset:0 sc1
buffer_load_dwordx4 v[84:87], v7, s[44:47], s59 offen offset:1024 sc1
s_add_u32 s59, s59, 2048
s_and_b32 s59, s59, 0x3fff
buffer_load_dwordx4 v[88:91], v7, s[44:47], s59 offen offset:0 sc1
buffer_load_dwordx4 v[92:95], v7, s[44:47], s59 offen offset:1024 sc1
v_mfma_f32_16x16x32_bf16 v[128:131], a[0:3], v[64:67], 0
s_add_u32 s59, s59, 2048
s_and_b32 s59, s59, 0x3fff
buffer_load_dwordx4 v[96:99], v7, s[44:47], s59 offen offset:0 sc1
ds_read_b64_tr_b16 a[228:229], v237 offset:57344
v_mfma_f32_16x16x32_bf16 v[132:135], a[4:7], v[64:67], 0
ds_read_b64_tr_b16 a[230:231], v237 offset:59392
s_lshr_b32 s72, s50, 2
v_mfma_f32_16x16x32_bf16 v[136:139], a[8:11], v[64:67], 0
buffer_load_dwordx4 v[100:103], v7, s[44:47], s59 offen offset:1024 sc1
ds_read_b64_tr_b16 a[232:233], v238 offset:57344
v_mfma_f32_16x16x32_bf16 v[140:143], a[12:15], v[64:67], 0
ds_read_b64_tr_b16 a[234:235], v238 offset:59392
v_mfma_f32_16x16x32_bf16 v[128:131], a[16:19], v[68:71], v[128:131]
s_add_u32 s59, s59, 2048
s_and_b32 s59, s59, 0x3fff
buffer_load_dwordx4 v[104:107], v7, s[44:47], s59 offen offset:0 sc1
ds_read_b64_tr_b16 a[236:237], v239 offset:57344
v_mfma_f32_16x16x32_bf16 v[132:135], a[20:23], v[68:71], v[132:135]
ds_read_b64_tr_b16 a[238:239], v239 offset:59392
s_add_u32 s72, s72, 1
v_mfma_f32_16x16x32_bf16 v[136:139], a[24:27], v[68:71], v[136:139]
buffer_load_dwordx4 v[108:111], v7, s[44:47], s59 offen offset:1024 sc1
ds_read_b64_tr_b16 a[240:241], v240 offset:0
v_mfma_f32_16x16x32_bf16 v[140:143], a[28:31], v[68:71], v[140:143]
s_waitcnt lgkmcnt(7)
s_barrier
s_waitcnt vmcnt(9)
v_mfma_f32_16x16x32_bf16 v[128:131], a[32:35], v[72:75], v[128:131]
s_add_u32 s59, s59, 2048
s_and_b32 s59, s59, 0x3fff
buffer_load_dwordx4 v[112:115], v7, s[44:47], s59 offen offset:0 sc1
ds_read_b64_tr_b16 a[242:243], v240 offset:2048
v_mfma_f32_16x16x32_bf16 v[132:135], a[36:39], v[72:75], v[132:135]
ds_read_b64_tr_b16 a[244:245], v241 offset:0
s_sub_u32 s73, 0, s72
v_mfma_f32_16x16x32_bf16 v[136:139], a[40:43], v[72:75], v[136:139]
ds_read_b64_tr_b16 a[246:247], v241 offset:2048
s_bitcmp1_b32 s50, 1
s_cselect_b32 s72, s73, s72
v_mfma_f32_16x16x32_bf16 v[140:143], a[44:47], v[72:75], v[140:143]
ds_read_b64_tr_b16 a[248:249], v242 offset:0
s_waitcnt vmcnt(9)
v_mfma_f32_16x16x32_bf16 v[128:131], a[48:51], v[76:79], v[128:131]
buffer_load_dwordx4 v[116:119], v7, s[44:47], s59 offen offset:1024 sc1
ds_read_b64_tr_b16 a[250:251], v242 offset:2048
v_mfma_f32_16x16x32_bf16 v[132:135], a[52:55], v[76:79], v[132:135]
ds_read_b64_tr_b16 a[252:253], v243 offset:0
v_add_u32 v5, s72, v4
v_mfma_f32_16x16x32_bf16 v[136:139], a[56:59], v[76:79], v[136:139]
ds_read_b64_tr_b16 a[254:255], v243 offset:2048
v_ashrrev_i32 v5, 4, v5
v_mfma_f32_16x16x32_bf16 v[140:143], a[60:63], v[76:79], v[140:143]
ds_read_b64_tr_b16 a[0:1], v56 offset:0
s_waitcnt vmcnt(9)
v_mfma_f32_16x16x32_bf16 v[128:131], a[64:67], v[80:83], v[128:131]
s_add_u32 s59, s59, 2048
s_and_b32 s59, s59, 0x3fff
buffer_load_dwordx4 v[120:123], v7, s[44:47], s59 offen offset:0 sc1
ds_read_b64_tr_b16 a[2:3], v56 offset:2048
v_mfma_f32_16x16x32_bf16 v[132:135], a[68:71], v[80:83], v[132:135]
ds_read_b64_tr_b16 a[4:5], v57 offset:0
s_lshl_b32 s72, s72, 4
v_mfma_f32_16x16x32_bf16 v[136:139], a[72:75], v[80:83], v[136:139]
ds_read_b64_tr_b16 a[6:7], v57 offset:2048
s_add_u32 s72, s72, 66560
v_mfma_f32_16x16x32_bf16 v[140:143], a[76:79], v[80:83], v[140:143]
ds_read_b64_tr_b16 a[8:9], v58 offset:0
s_waitcnt vmcnt(9)
v_mfma_f32_16x16x32_bf16 v[128:131], a[80:83], v[84:87], v[128:131]
buffer_load_dwordx4 v[124:127], v7, s[44:47], s59 offen offset:1024 sc1
ds_read_b64_tr_b16 a[10:11], v58 offset:2048
v_mfma_f32_16x16x32_bf16 v[132:135], a[84:87], v[84:87], v[132:135]
ds_read_b64_tr_b16 a[12:13], v59 offset:0
v_add_u32 v6, s52, v5
v_mfma_f32_16x16x32_bf16 v[136:139], a[88:91], v[84:87], v[136:139]
ds_read_b64_tr_b16 a[14:15], v59 offset:2048
v_mul_i32_i24 v5, 66304, v5
v_mfma_f32_16x16x32_bf16 v[140:143], a[92:95], v[84:87], v[140:143]
ds_read_b64_tr_b16 a[16:17], v56 offset:4096
s_waitcnt vmcnt(9)
v_mfma_f32_16x16x32_bf16 v[128:131], a[96:99], v[88:91], v[128:131]
s_mul_i32 s60, s0, 5504
s_cmp_eq_u32 s49, 1
s_cselect_b32 exec_lo, -1, 0
s_cselect_b32 exec_hi, 2047, 0
buffer_load_dword v251, v255, s[28:31], s60 offen
s_mov_b64 exec, -1
s_add_u32 m0, s86, 0
s_add_u32 s3, s3, 88064
s_cmp_eq_u32 s3, 1409024
s_cselect_b32 s3, 0, s3
buffer_load_dwordx4 v60, s[24:27], s3 offen offset:0 lds
s_add_u32 m0, m0, 3968
ds_read_b64_tr_b16 a[18:19], v56 offset:6144
v_mfma_f32_16x16x32_bf16 v[132:135], a[100:103], v[88:91], v[132:135]
ds_read_b64_tr_b16 a[20:21], v57 offset:4096
v_and_b32 v6, 4, v6
v_mfma_f32_16x16x32_bf16 v[136:139], a[104:107], v[88:91], v[136:139]
ds_read_b64_tr_b16 a[22:23], v57 offset:6144
v_add3_u32 v228, v12, v5, s72
v_mfma_f32_16x16x32_bf16 v[140:143], a[108:111], v[88:91], v[140:143]
ds_read_b64_tr_b16 a[24:25], v58 offset:4096
s_waitcnt vmcnt(10)
v_mfma_f32_16x16x32_bf16 v[128:131], a[112:115], v[92:95], v[128:131]
buffer_load_dwordx4 v60, s[24:27], s3 offen offset:128 lds
s_add_u32 m0, m0, 4224
ds_read_b64_tr_b16 a[26:27], v58 offset:6144
v_mfma_f32_16x16x32_bf16 v[132:135], a[116:119], v[92:95], v[132:135]
ds_read_b64_tr_b16 a[28:29], v59 offset:4096
v_lshl_or_b32 v228, v6, 29, v228
v_mfma_f32_16x16x32_bf16 v[136:139], a[120:123], v[92:95], v[136:139]
ds_read_b64_tr_b16 a[30:31], v59 offset:6144
v_add_f32 v200, v200, v202
v_mfma_f32_16x16x32_bf16 v[140:143], a[124:127], v[92:95], v[140:143]
ds_read_b64_tr_b16 a[32:33], v56 offset:8192
s_waitcnt vmcnt(10)
v_mfma_f32_16x16x32_bf16 v[128:131], a[128:131], v[96:99], v[128:131]
buffer_load_dwordx4 v61, s[24:27], s3 offen offset:0 lds
ds_read_b64_tr_b16 a[34:35], v56 offset:10240
v_mfma_f32_16x16x32_bf16 v[132:135], a[132:135], v[96:99], v[132:135]
ds_read_b64_tr_b16 a[36:37], v57 offset:8192
v_mov_b32 v202, v200
v_mfma_f32_16x16x32_bf16 v[136:139], a[136:139], v[96:99], v[136:139]
ds_read_b64_tr_b16 a[38:39], v57 offset:10240
v_permlane32_swap_b32 v200, v202
v_mfma_f32_16x16x32_bf16 v[140:143], a[140:143], v[96:99], v[140:143]
ds_read_b64_tr_b16 a[40:41], v58 offset:8192
s_waitcnt vmcnt(10)
v_mfma_f32_16x16x32_bf16 v[128:131], a[144:147], v[100:103], v[128:131]
s_add_u32 m0, s86, 12288
s_add_u32 s3, s3, 88064
buffer_load_dwordx4 v60, s[24:27], s3 offen offset:0 lds
s_add_u32 m0, m0, 3968
ds_read_b64_tr_b16 a[42:43], v58 offset:10240
v_mfma_f32_16x16x32_bf16 v[132:135], a[148:151], v[100:103], v[132:135]
ds_read_b64_tr_b16 a[44:45], v59 offset:8192
v_add_f32 v200, v200, v202
v_mfma_f32_16x16x32_bf16 v[136:139], a[152:155], v[100:103], v[136:139]
ds_read_b64_tr_b16 a[46:47], v59 offset:10240
v_mov_b32 v202, v200
v_mfma_f32_16x16x32_bf16 v[140:143], a[156:159], v[100:103], v[140:143]
ds_read_b64_tr_b16 a[48:49], v56 offset:12288
s_waitcnt vmcnt(10)
v_mfma_f32_16x16x32_bf16 v[128:131], a[160:163], v[104:107], v[128:131]
buffer_load_dwordx4 v60, s[24:27], s3 offen offset:128 lds
s_add_u32 m0, m0, 4224
ds_read_b64_tr_b16 a[50:51], v56 offset:14336
v_mfma_f32_16x16x32_bf16 v[132:135], a[164:167], v[104:107], v[132:135]
ds_read_b64_tr_b16 a[52:53], v57 offset:12288
v_permlane16_swap_b32 v200, v202
v_mfma_f32_16x16x32_bf16 v[136:139], a[168:171], v[104:107], v[136:139]
ds_read_b64_tr_b16 a[54:55], v57 offset:14336
v_add_f32 v200, v200, v202
v_mfma_f32_16x16x32_bf16 v[140:143], a[172:175], v[104:107], v[140:143]
ds_read_b64_tr_b16 a[56:57], v58 offset:12288
s_waitcnt vmcnt(10)
v_mfma_f32_16x16x32_bf16 v[128:131], a[176:179], v[108:111], v[128:131]
buffer_load_dwordx4 v61, s[24:27], s3 offen offset:0 lds
ds_read_b64_tr_b16 a[58:59], v58 offset:14336
v_mfma_f32_16x16x32_bf16 v[132:135], a[180:183], v[108:111], v[132:135]
ds_read_b64_tr_b16 a[60:61], v59 offset:12288
v_mov_b32 v201, 0x3727c5ac
v_mfma_f32_16x16x32_bf16 v[136:139], a[184:187], v[108:111], v[136:139]
ds_read_b64_tr_b16 a[62:63], v59 offset:14336
v_fmac_f32 v201, s91, v200
v_mfma_f32_16x16x32_bf16 v[140:143], a[188:191], v[108:111], v[140:143]
ds_read_b64_tr_b16 a[64:65], v56 offset:32768
s_waitcnt vmcnt(10)
v_mfma_f32_16x16x32_bf16 v[128:131], a[192:195], v[112:115], v[128:131]
s_add_u32 m0, s86, 24576
s_add_u32 s3, s3, 88064
s_cmp_eq_u32 s3, 1409024
s_cselect_b32 s3, 0, s3
buffer_load_dwordx4 v60, s[24:27], s3 offen offset:0 lds
s_add_u32 m0, m0, 3968
ds_read_b64_tr_b16 a[66:67], v56 offset:34816
v_mfma_f32_16x16x32_bf16 v[132:135], a[196:199], v[112:115], v[132:135]
ds_read_b64_tr_b16 a[68:69], v57 offset:32768
v_rsq_f32 v223, v201
v_mfma_f32_16x16x32_bf16 v[136:139], a[200:203], v[112:115], v[136:139]
ds_read_b64_tr_b16 a[70:71], v57 offset:34816
v_mul_f32 v222, v201, v223
v_mfma_f32_16x16x32_bf16 v[140:143], a[204:207], v[112:115], v[140:143]
ds_read_b64_tr_b16 a[72:73], v58 offset:32768
s_waitcnt vmcnt(10)
v_mfma_f32_16x16x32_bf16 v[128:131], a[208:211], v[116:119], v[128:131]
buffer_load_dwordx4 v60, s[24:27], s3 offen offset:128 lds
s_add_u32 m0, m0, 4224
ds_read_b64_tr_b16 a[74:75], v58 offset:34816
v_mfma_f32_16x16x32_bf16 v[132:135], a[212:215], v[116:119], v[132:135]
ds_read_b64_tr_b16 a[76:77], v59 offset:32768
v_mul_f32 v221, 0xc0135761, v223
v_mfma_f32_16x16x32_bf16 v[136:139], a[216:219], v[116:119], v[136:139]
ds_read_b64_tr_b16 a[78:79], v59 offset:34816
v_mul_f32 v220, v223, v223
v_mfma_f32_16x16x32_bf16 v[140:143], a[220:223], v[116:119], v[140:143]
ds_read_b64_tr_b16 a[80:81], v56 offset:36864
s_waitcnt vmcnt(10) lgkmcnt(15)
v_mfma_f32_16x16x32_bf16 v[128:131], a[224:227], v[120:123], v[128:131]
ds_read_b64_tr_b16 a[82:83], v56 offset:38912
v_mfma_f32_16x16x32_bf16 v[132:135], a[228:231], v[120:123], v[132:135]
ds_read_b64_tr_b16 a[84:85], v57 offset:36864
v_mul_f32 v220, v220, v223
v_mfma_f32_16x16x32_bf16 v[136:139], a[232:235], v[120:123], v[136:139]
ds_read_b64_tr_b16 a[86:87], v57 offset:38912
v_mul_f32 v220, 0xbdd2d3e8, v220
v_mfma_f32_16x16x32_bf16 v[140:143], a[236:239], v[120:123], v[140:143]
ds_read_b64_tr_b16 a[88:89], v58 offset:36864
s_waitcnt vmcnt(9)
v_mfma_f32_16x16x32_bf16 v[128:131], a[240:243], v[124:127], v[128:131]
ds_read_b64_tr_b16 a[90:91], v58 offset:38912
v_mfma_f32_16x16x32_bf16 v[132:135], a[244:247], v[124:127], v[132:135]
ds_read_b64_tr_b16 a[92:93], v59 offset:36864
v_mfma_f32_16x16x32_bf16 v[136:139], a[248:251], v[124:127], v[136:139]
ds_read_b64_tr_b16 a[94:95], v59 offset:38912
v_mfma_f32_16x16x32_bf16 v[140:143], a[252:255], v[124:127], v[140:143]
ds_read_b64_tr_b16 a[96:97], v56 offset:40960
s_waitcnt lgkmcnt(0)
s_barrier
v_pk_mul_f32 v[144:145], v[128:129], v[128:129]
v_pk_mul_f32 v[146:147], v[130:131], v[130:131]
v_pk_mul_f32 v[148:149], v[132:133], v[132:133]
v_pk_mul_f32 v[150:151], v[134:135], v[134:135]
v_pk_mul_f32 v[152:153], v[136:137], v[136:137]
v_pk_mul_f32 v[154:155], v[138:139], v[138:139]
v_pk_mul_f32 v[156:157], v[140:141], v[140:141]
v_pk_mul_f32 v[158:159], v[142:143], v[142:143]
v_pk_fma_f32 v[144:145], v[144:145], v[220:221], v[220:221] op_sel:[0,0,1] op_sel_hi:[1,0,1]
v_pk_fma_f32 v[146:147], v[146:147], v[220:221], v[220:221] op_sel:[0,0,1] op_sel_hi:[1,0,1]
v_pk_fma_f32 v[148:149], v[148:149], v[220:221], v[220:221] op_sel:[0,0,1] op_sel_hi:[1,0,1]
v_pk_fma_f32 v[150:151], v[150:151], v[220:221], v[220:221] op_sel:[0,0,1] op_sel_hi:[1,0,1]
v_pk_fma_f32 v[152:153], v[152:153], v[220:221], v[220:221] op_sel:[0,0,1] op_sel_hi:[1,0,1]
v_pk_fma_f32 v[154:155], v[154:155], v[220:221], v[220:221] op_sel:[0,0,1] op_sel_hi:[1,0,1]
v_pk_fma_f32 v[156:157], v[156:157], v[220:221], v[220:221] op_sel:[0,0,1] op_sel_hi:[1,0,1]
v_pk_fma_f32 v[158:159], v[158:159], v[220:221], v[220:221] op_sel:[0,0,1] op_sel_hi:[1,0,1]
v_pk_mul_f32 v[144:145], v[144:145], v[128:129]
v_pk_mul_f32 v[146:147], v[146:147], v[130:131]
v_pk_mul_f32 v[148:149], v[148:149], v[132:133]
v_pk_mul_f32 v[150:151], v[150:151], v[134:135]
buffer_load_dwordx4 v61, s[24:27], s3 offen offset:0 lds
v_pk_mul_f32 v[152:153], v[152:153], v[136:137]
v_pk_mul_f32 v[154:155], v[154:155], v[138:139]
v_pk_mul_f32 v[156:157], v[156:157], v[140:141]
v_pk_mul_f32 v[158:159], v[158:159], v[142:143]
v_exp_f32 v144, v144
v_exp_f32 v145, v145
v_exp_f32 v146, v146
v_exp_f32 v147, v147
v_exp_f32 v148, v148
v_exp_f32 v149, v149
v_exp_f32 v150, v150
v_exp_f32 v151, v151
v_exp_f32 v152, v152
v_exp_f32 v153, v153
v_exp_f32 v154, v154
v_exp_f32 v155, v155
v_exp_f32 v156, v156
v_exp_f32 v157, v157
v_exp_f32 v158, v158
v_exp_f32 v159, v159
s_add_u32 m0, s86, 36864
s_add_u32 s3, s3, 88064
buffer_load_dwordx4 v60, s[24:27], s3 offen offset:0 lds
s_add_u32 m0, m0, 3968
v_pk_fma_f32 v[144:145], v[144:145], v[222:223], v[222:223] op_sel:[0,0,0] op_sel_hi:[1,0,0]
v_pk_fma_f32 v[146:147], v[146:147], v[222:223], v[222:223] op_sel:[0,0,0] op_sel_hi:[1,0,0]
v_pk_fma_f32 v[148:149], v[148:149], v[222:223], v[222:223] op_sel:[0,0,0] op_sel_hi:[1,0,0]
v_pk_fma_f32 v[150:151], v[150:151], v[222:223], v[222:223] op_sel:[0,0,0] op_sel_hi:[1,0,0]
v_pk_fma_f32 v[152:153], v[152:153], v[222:223], v[222:223] op_sel:[0,0,0] op_sel_hi:[1,0,0]
v_pk_fma_f32 v[154:155], v[154:155], v[222:223], v[222:223] op_sel:[0,0,0] op_sel_hi:[1,0,0]
v_pk_fma_f32 v[156:157], v[156:157], v[222:223], v[222:223] op_sel:[0,0,0] op_sel_hi:[1,0,0]
v_pk_fma_f32 v[158:159], v[158:159], v[222:223], v[222:223] op_sel:[0,0,0] op_sel_hi:[1,0,0]
v_rcp_f32 v144, v144
v_rcp_f32 v145, v145
v_rcp_f32 v146, v146
v_rcp_f32 v147, v147
v_rcp_f32 v148, v148
v_rcp_f32 v149, v149
v_rcp_f32 v150, v150
v_rcp_f32 v151, v151
v_rcp_f32 v152, v152
v_rcp_f32 v153, v153
v_rcp_f32 v154, v154
v_rcp_f32 v155, v155
buffer_load_dwordx4 v60, s[24:27], s3 offen offset:128 lds
s_add_u32 m0, m0, 4224
v_rcp_f32 v156, v156
v_rcp_f32 v157, v157
v_rcp_f32 v158, v158
v_rcp_f32 v159, v159
v_pk_mul_f32 v[144:145], v[144:145], v[128:129]
v_pk_mul_f32 v[146:147], v[146:147], v[130:131]
v_pk_mul_f32 v[148:149], v[148:149], v[132:133]
v_pk_mul_f32 v[150:151], v[150:151], v[134:135]
v_pk_mul_f32 v[152:153], v[152:153], v[136:137]
v_pk_mul_f32 v[154:155], v[154:155], v[138:139]
v_pk_mul_f32 v[156:157], v[156:157], v[140:141]
v_pk_mul_f32 v[158:159], v[158:159], v[142:143]
v_cvt_pk_bf16_f32 v192, v144, v145
v_cvt_pk_bf16_f32 v193, v146, v147
v_cvt_pk_bf16_f32 v194, v148, v149
v_cvt_pk_bf16_f32 v195, v150, v151
v_cvt_pk_bf16_f32 v196, v152, v153
v_cvt_pk_bf16_f32 v197, v154, v155
v_cvt_pk_bf16_f32 v198, v156, v157
v_cvt_pk_bf16_f32 v199, v158, v159
buffer_load_dwordx4 v61, s[24:27], s3 offen offset:0 lds
s_add_u32 s57, s62, 2074624
buffer_store_dwordx4 v[192:195], v228, s[44:47], s57 offen
buffer_store_dwordx4 v[196:199], v228, s[44:47], s57 offen offset:1024
s_add_u32 m0, s86, 49152
s_add_u32 s3, s3, 88064
s_cmp_eq_u32 s3, 1409024
s_cselect_b32 s3, 0, s3
buffer_load_dwordx4 v60, s[24:27], s3 offen offset:0 lds
s_add_u32 m0, m0, 3968
s_nop 0
buffer_load_dwordx4 v60, s[24:27], s3 offen offset:128 lds
s_add_u32 m0, m0, 4224
s_nop 0
buffer_load_dwordx4 v61, s[24:27], s3 offen offset:0 lds
ds_read_b64_tr_b16 a[98:99], v56 offset:43008
ds_read_b64_tr_b16 a[100:101], v57 offset:40960
ds_read_b64_tr_b16 a[102:103], v57 offset:43008
ds_read_b64_tr_b16 a[104:105], v58 offset:40960
ds_read_b64_tr_b16 a[106:107], v58 offset:43008
ds_read_b64_tr_b16 a[108:109], v59 offset:40960
ds_read_b64_tr_b16 a[110:111], v59 offset:43008
ds_read_b64_tr_b16 a[112:113], v56 offset:45056
ds_read_b64_tr_b16 a[114:115], v56 offset:47104
ds_read_b64_tr_b16 a[116:117], v57 offset:45056
ds_read_b64_tr_b16 a[118:119], v57 offset:47104
ds_read_b64_tr_b16 a[120:121], v58 offset:45056
ds_read_b64_tr_b16 a[122:123], v58 offset:47104
ds_read_b64_tr_b16 a[124:125], v59 offset:45056
ds_read_b64_tr_b16 a[126:127], v59 offset:47104
ds_read_b64_tr_b16 a[128:129], v52 offset:16384
ds_read_b64_tr_b16 a[130:131], v52 offset:18432
ds_read_b64_tr_b16 a[132:133], v53 offset:16384
ds_read_b64_tr_b16 a[134:135], v53 offset:18432
ds_read_b64_tr_b16 a[136:137], v54 offset:16384
s_waitcnt vmcnt(3)
s_add_u32 s57, s61, 2229248
s_mov_b64 exec, 1
buffer_store_dwordx2 v[8:9], v10, s[44:47], s57 offen
s_mov_b64 exec, -1
s_cmp_eq_u32 s34, 0
s_cbranch_scc1 nohalo_16
s_mov_b32 exec_lo, s34
s_mov_b32 exec_hi, s34
v_mov_b32 v144, v192
v_mov_b32 v145, v9
v_mov_b32 v146, v193
v_mov_b32 v147, v9
buffer_store_dwordx4 v[144:147], v253, s[44:47], s39 offen offset:0 sc1
v_mov_b32 v148, v194
v_mov_b32 v149, v9
v_mov_b32 v150, v195
v_mov_b32 v151, v9
buffer_store_dwordx4 v[148:151], v253, s[44:47], s39 offen offset:128 sc1
v_mov_b32 v152, v196
v_mov_b32 v153, v9
v_mov_b32 v154, v197
v_mov_b32 v155, v9
buffer_store_dwordx4 v[152:155], v253, s[44:47], s39 offen offset:256 sc1
v_mov_b32 v156, v198
v_mov_b32 v157, v9
v_mov_b32 v158, v199
v_mov_b32 v159, v9
buffer_store_dwordx4 v[156:159], v253, s[44:47], s39 offen offset:384 sc1
s_mov_b64 exec, -1
nohalo_16:
ds_read_b64_tr_b16 a[138:139], v54 offset:18432
ds_read_b64_tr_b16 a[140:141], v55 offset:16384
ds_read_b64_tr_b16 a[142:143], v55 offset:18432
ds_read_b64_tr_b16 a[144:145], v52 offset:20480
ds_read_b64_tr_b16 a[146:147], v52 offset:22528
ds_read_b64_tr_b16 a[148:149], v53 offset:20480
ds_read_b64_tr_b16 a[150:151], v53 offset:22528
ds_read_b64_tr_b16 a[152:153], v54 offset:20480
ds_read_b64_tr_b16 a[154:155], v54 offset:22528
ds_read_b64_tr_b16 a[156:157], v55 offset:20480
ds_read_b64_tr_b16 a[158:159], v55 offset:22528
ds_read_b64_tr_b16 a[160:161], v52 offset:24576
ds_read_b64_tr_b16 a[162:163], v52 offset:26624
ds_read_b64_tr_b16 a[164:165], v53 offset:24576
ds_read_b64_tr_b16 a[166:167], v53 offset:26624
ds_read_b64_tr_b16 a[168:169], v54 offset:24576
ds_read_b64_tr_b16 a[170:171], v54 offset:26624
ds_read_b64_tr_b16 a[172:173], v55 offset:24576
s_mov_b32 s58, 2229248
s_mov_b64 exec, s[98:99]
buffer_load_dwordx2 v[200:201], v11, s[44:47], s58 offen sc1
s_mov_b64 exec, -1
s_cmp_eq_u32 s52, 0
s_cselect_b32 s73, 4096, 0
v_add_u32 v228, s73, v12
s_sub_u32 s73, 4096, s73
v_add_u32 v229, s73, v12
s_and_b32 s72, s52, 1
s_lshl_b32 s72, s72, 10
s_add_u32 s72, s72, 158208
v_add_u32 v233, s72, v253
v_xor_b32 v232, 16, v233
v_and_b32 v5, 7, v1
v_lshlrev_b32 v5, 4, v5
v_lshl_add_u32 v5, v3, 7, v5
v_and_b32 v6, 8, v1
v_add3_u32 v234, v5, v6, s72
ds_read_b64_tr_b16 a[174:175], v55 offset:26624
ds_read_b64_tr_b16 a[176:177], v52 offset:28672
ds_read_b64_tr_b16 a[178:179], v52 offset:30720
ds_read_b64_tr_b16 a[180:181], v53 offset:28672
ds_read_b64_tr_b16 a[182:183], v53 offset:30720
ds_read_b64_tr_b16 a[184:185], v54 offset:28672
ds_read_b64_tr_b16 a[186:187], v54 offset:30720
ds_read_b64_tr_b16 a[188:189], v55 offset:28672
ds_read_b64_tr_b16 a[190:191], v55 offset:30720
ds_read_b64_tr_b16 a[192:193], v52 offset:49152
ds_read_b64_tr_b16 a[194:195], v52 offset:51200
ds_read_b64_tr_b16 a[196:197], v53 offset:49152
ds_read_b64_tr_b16 a[198:199], v53 offset:51200
ds_read_b64_tr_b16 a[200:201], v54 offset:49152
ds_read_b64_tr_b16 a[202:203], v54 offset:51200
ds_read_b64_tr_b16 a[204:205], v55 offset:49152
ds_read_b64_tr_b16 a[206:207], v55 offset:51200
ds_read_b64_tr_b16 a[208:209], v52 offset:53248
ds_read_b64_tr_b16 a[210:211], v52 offset:55296
ds_read_b64_tr_b16 a[212:213], v53 offset:53248
s_mov_b64 exec, s[98:99]
s_waitcnt vmcnt(0)
v_cmp_ne_u32 vcc, v201, v9
s_cbranch_vccz go_17
retry_18:
s_sub_u32 s56, s56, 1
s_cbranch_scc1 L_end
buffer_load_dwordx2 v[200:201], v11, s[44:47], s58 offen sc1
s_waitcnt vmcnt(0)
v_cmp_ne_u32 vcc, v201, v9
s_cbranch_vccnz retry_18
go_17:
s_mov_b64 exec, -1
ds_read_b128 v[160:163], v249 offset:0
ds_read_b128 v[164:167], v249 offset:64
ds_read_b128 v[168:171], v249 offset:128
ds_read_b128 v[172:175], v249 offset:192
ds_read_b128 v[176:179], v249 offset:512
ds_read_b128 v[180:183], v249 offset:576
s_mov_b32 s59, 2141184
buffer_load_dwordx4 v[64:67], v228, s[44:47], s59 offen offset:0 sc1
ds_read_b64_tr_b16 a[214:215], v53 offset:55296
ds_read_b64_tr_b16 a[216:217], v54 offset:53248
buffer_load_dwordx4 v[68:71], v228, s[44:47], s59 offen offset:1024 sc1
ds_read_b64_tr_b16 a[218:219], v54 offset:55296
ds_read_b64_tr_b16 a[220:221], v55 offset:53248
buffer_load_dwordx4 v[72:75], v228, s[44:47], s59 offen offset:2048 sc1
ds_read_b64_tr_b16 a[222:223], v55 offset:55296
ds_read_b64_tr_b16 a[224:225], v52 offset:57344
buffer_load_dwordx4 v[76:79], v228, s[44:47], s59 offen offset:3072 sc1
ds_read_b64_tr_b16 a[226:227], v52 offset:59392
ds_read_b64_tr_b16 a[228:229], v53 offset:57344
s_mov_b32 s59, 2149376
buffer_load_dwordx4 v[80:83], v228, s[44:47], s59 offen offset:0 sc1
ds_read_b64_tr_b16 a[230:231], v53 offset:59392
ds_read_b64_tr_b16 a[232:233], v54 offset:57344
buffer_load_dwordx4 v[84:87], v228, s[44:47], s59 offen offset:1024 sc1
ds_read_b64_tr_b16 a[234:235], v54 offset:59392
ds_read_b64_tr_b16 a[236:237], v55 offset:57344
s_waitcnt vmcnt(5) lgkmcnt(15)
v_mfma_f32_16x16x32_bf16 v[128:131], v[160:163], v[64:67], 0
ds_read_b128 v[184:187], v249 offset:640
v_mfma_f32_16x16x32_bf16 v[32:35], a[0:3], v[64:67], v[32:35]
buffer_load_dwordx4 v[88:91], v228, s[44:47], s59 offen offset:2048 sc1
ds_read_b64_tr_b16 a[238:239], v55 offset:59392
v_mfma_f32_16x16x32_bf16 v[36:39], a[4:7], v[64:67], v[36:39]
ds_read_b64_tr_b16 a[240:241], v52 offset:61440
v_mfma_f32_16x16x32_bf16 v[40:43], a[8:11], v[64:67], v[40:43]
buffer_load_dwordx4 v[92:95], v228, s[44:47], s59 offen offset:3072 sc1
ds_read_b64_tr_b16 a[242:243], v52 offset:63488
v_mfma_f32_16x16x32_bf16 v[44:47], a[12:15], v[64:67], v[44:47]
ds_read_b64_tr_b16 a[244:245], v53 offset:61440
s_waitcnt vmcnt(6)
v_mfma_f32_16x16x32_bf16 v[128:131], v[164:167], v[68:71], v[128:131]
ds_read_b128 v[188:191], v249 offset:704
v_mfma_f32_16x16x32_bf16 v[32:35], a[16:19], v[68:71], v[32:35]
s_mov_b32 s59, 2141184
s_mov_b64 exec, s[68:69]
buffer_load_dwordx4 v[96:99], v229, s[44:47], s59 offen offset:0 sc1
s_mov_b64 exec, -1
ds_read_b64_tr_b16 a[246:247], v53 offset:63488
v_mfma_f32_16x16x32_bf16 v[36:39], a[20:23], v[68:71], v[36:39]
ds_read_b64_tr_b16 a[248:249], v54 offset:61440
v_mfma_f32_16x16x32_bf16 v[40:43], a[24:27], v[68:71], v[40:43]
s_mov_b64 exec, s[68:69]
buffer_load_dwordx4 v[100:103], v229, s[44:47], s59 offen offset:1024 sc1
s_mov_b64 exec, -1
ds_read_b64_tr_b16 a[250:251], v54 offset:63488
v_mfma_f32_16x16x32_bf16 v[44:47], a[28:31], v[68:71], v[44:47]
s_waitcnt lgkmcnt(7)
s_barrier
s_waitcnt vmcnt(7)
v_mfma_f32_16x16x32_bf16 v[128:131], v[168:171], v[72:75], v[128:131]
ds_read_b128 v[160:163], v250 offset:256
v_mfma_f32_16x16x32_bf16 v[32:35], a[32:35], v[72:75], v[32:35]
s_mov_b64 exec, s[68:69]
buffer_load_dwordx4 v[104:107], v229, s[44:47], s59 offen offset:2048 sc1
s_mov_b64 exec, -1
ds_read_b64_tr_b16 a[252:253], v55 offset:61440
v_mfma_f32_16x16x32_bf16 v[36:39], a[36:39], v[72:75], v[36:39]
ds_read_b64_tr_b16 a[254:255], v55 offset:63488
v_mfma_f32_16x16x32_bf16 v[40:43], a[40:43], v[72:75], v[40:43]
ds_read_b64_tr_b16 a[0:1], v244 offset:8192
v_mfma_f32_16x16x32_bf16 v[44:47], a[44:47], v[72:75], v[44:47]
ds_read_b64_tr_b16 a[2:3], v244 offset:10240
s_cmp_eq_u32 s63, 1
s_cselect_b64 exec, -1, 0
buffer_load_dwordx4 v[144:147], v2, s[44:47], s32 offen sc1
buffer_load_dwordx4 v[148:151], v2, s[44:47], s32 offen offset:1024 sc1
s_mov_b64 exec, -1
s_waitcnt vmcnt(9)
v_mfma_f32_16x16x32_bf16 v[128:131], v[172:175], v[76:79], v[128:131]
ds_read_b128 v[164:167], v250 offset:320
v_mfma_f32_16x16x32_bf16 v[32:35], a[48:51], v[76:79], v[32:35]
s_mov_b64 exec, s[68:69]
buffer_load_dwordx4 v[108:111], v229, s[44:47], s59 offen offset:3072 sc1
s_mov_b64 exec, -1
ds_read_b64_tr_b16 a[4:5], v245 offset:8192
v_mfma_f32_16x16x32_bf16 v[36:39], a[52:55], v[76:79], v[36:39]
ds_read_b64_tr_b16 a[6:7], v245 offset:10240
v_mfma_f32_16x16x32_bf16 v[40:43], a[56:59], v[76:79], v[40:43]
ds_read_b64_tr_b16 a[8:9], v246 offset:8192
v_mfma_f32_16x16x32_bf16 v[44:47], a[60:63], v[76:79], v[44:47]
ds_read_b64_tr_b16 a[10:11], v246 offset:10240
s_waitcnt vmcnt(9)
v_mfma_f32_16x16x32_bf16 v[128:131], v[176:179], v[80:83], v[128:131]
ds_read_b128 v[168:171], v250 offset:384
v_mfma_f32_16x16x32_bf16 v[32:35], a[64:67], v[80:83], v[32:35]
s_mov_b32 s59, 2149376
s_mov_b64 exec, s[70:71]
buffer_load_dwordx4 v[112:115], v229, s[44:47], s59 offen offset:0 sc1
s_mov_b64 exec, -1
ds_read_b64_tr_b16 a[12:13], v247 offset:8192
v_mfma_f32_16x16x32_bf16 v[36:39], a[68:71], v[80:83], v[36:39]
ds_read_b64_tr_b16 a[14:15], v247 offset:10240
v_mfma_f32_16x16x32_bf16 v[40:43], a[72:75], v[80:83], v[40:43]
ds_read_b64_tr_b16 a[16:17], v244 offset:12288
v_mfma_f32_16x16x32_bf16 v[44:47], a[76:79], v[80:83], v[44:47]
ds_read_b64_tr_b16 a[18:19], v244 offset:14336
s_waitcnt vmcnt(9)
v_mfma_f32_16x16x32_bf16 v[128:131], v[180:183], v[84:87], v[128:131]
ds_read_b128 v[172:175], v250 offset:448
v_mfma_f32_16x16x32_bf16 v[32:35], a[80:83], v[84:87], v[32:35]
s_mov_b64 exec, s[70:71]
buffer_load_dwordx4 v[116:119], v229, s[44:47], s59 offen offset:1024 sc1
s_mov_b64 exec, -1
ds_read_b64_tr_b16 a[20:21], v245 offset:12288
v_mfma_f32_16x16x32_bf16 v[36:39], a[84:87], v[84:87], v[36:39]
ds_read_b64_tr_b16 a[22:23], v245 offset:14336
v_mfma_f32_16x16x32_bf16 v[40:43], a[88:91], v[84:87], v[40:43]
ds_read_b64_tr_b16 a[24:25], v246 offset:12288
v_mfma_f32_16x16x32_bf16 v[44:47], a[92:95], v[84:87], v[44:47]
ds_read_b64_tr_b16 a[26:27], v246 offset:14336
s_waitcnt vmcnt(9)
v_mfma_f32_16x16x32_bf16 v[128:131], v[184:187], v[88:91], v[128:131]
ds_read_b128 v[176:179], v250 offset:768
v_mfma_f32_16x16x32_bf16 v[32:35], a[96:99], v[88:91], v[32:35]
s_mov_b64 exec, s[70:71]
buffer_load_dwordx4 v[120:123], v229, s[44:47], s59 offen offset:2048 sc1
s_mov_b64 exec, -1
ds_read_b64_tr_b16 a[28:29], v247 offset:12288
v_mfma_f32_16x16x32_bf16 v[36:39], a[100:103], v[88:91], v[36:39]
ds_read_b64_tr_b16 a[30:31], v247 offset:14336
v_mfma_f32_16x16x32_bf16 v[40:43], a[104:107], v[88:91], v[40:43]
ds_read_b64_tr_b16 a[32:33], v244 offset:16384
v_mfma_f32_16x16x32_bf16 v[44:47], a[108:111], v[88:91], v[44:47]
ds_read_b64_tr_b16 a[34:35], v244 offset:18432
s_waitcnt vmcnt(9) lgkmcnt(15)
v_mfma_f32_16x16x32_bf16 v[128:131], v[188:191], v[92:95], v[128:131]
ds_read_b128 v[180:183], v250 offset:832
v_mfma_f32_16x16x32_bf16 v[32:35], a[112:115], v[92:95], v[32:35]
s_mov_b64 exec, s[70:71]
buffer_load_dwordx4 v[124:127], v229, s[44:47], s59 offen offset:3072 sc1
s_mov_b64 exec, -1
ds_read_b64_tr_b16 a[36:37], v245 offset:16384
v_mfma_f32_16x16x32_bf16 v[36:39], a[116:119], v[92:95], v[36:39]
ds_read_b64_tr_b16 a[38:39], v245 offset:18432
v_mfma_f32_16x16x32_bf16 v[40:43], a[120:123], v[92:95], v[40:43]
ds_read_b64_tr_b16 a[40:41], v246 offset:16384
v_mfma_f32_16x16x32_bf16 v[44:47], a[124:127], v[92:95], v[44:47]
ds_read_b64_tr_b16 a[42:43], v246 offset:18432
s_cmp_eq_u32 s63, 0
s_cbranch_scc1 nohf_19
s_cmp_eq_u32 s63, 2
s_cbranch_scc1 hz_20
s_waitcnt vmcnt(5)
v_xor_b32 v5, v145, v9
v_bitop3_b32 v5, v5, v147, v9 bitop3:0xf6
v_bitop3_b32 v5, v5, v149, v9 bitop3:0xf6
v_bitop3_b32 v5, v5, v151, v9 bitop3:0xf6
v_cmp_ne_u32 vcc, 0, v5
s_cbranch_vccz go_22
retry_23:
s_sub_u32 s56, s56, 1
s_cbranch_scc1 L_end
s_sleep 1
buffer_load_dwordx4 v[144:147], v2, s[44:47], s32 offen sc1
buffer_load_dwordx4 v[148:151], v2, s[44:47], s32 offen offset:1024 sc1
s_waitcnt vmcnt(0)
v_xor_b32 v5, v145, v9
v_bitop3_b32 v5, v5, v147, v9 bitop3:0xf6
v_bitop3_b32 v5, v5, v149, v9 bitop3:0xf6
v_bitop3_b32 v5, v5, v151, v9 bitop3:0xf6
v_cmp_ne_u32 vcc, 0, v5
s_cbranch_vccnz retry_23
go_22:
s_branch hw_21
hz_20:
v_mov_b32 v144, 0
v_mov_b32 v146, 0
v_mov_b32 v148, 0
v_mov_b32 v150, 0
hw_21:
ds_write2_b32 v234, v144, v146 offset0:0 offset1:1
ds_write2_b32 v234, v148, v150 offset0:128 offset1:129
s_mov_b64 exec, s[64:65]
ds_read_b128 v[96:99], v232 offset:0
ds_read_b128 v[100:103], v232 offset:128
ds_read_b128 v[104:107], v232 offset:256
ds_read_b128 v[108:111], v232 offset:384
s_mov_b64 exec, s[66:67]
ds_read_b128 v[112:115], v233 offset:512
ds_read_b128 v[116:119], v233 offset:640
ds_read_b128 v[120:123], v233 offset:768
ds_read_b128 v[124:127], v233 offset:896
s_mov_b64 exec, -1
s_waitcnt lgkmcnt(0)
nohf_19:
s_waitcnt vmcnt(9)
v_mfma_f32_16x16x32_bf16 v[128:131], v[160:163], v[96:99], v[128:131]
ds_read_b128 v[184:187], v250 offset:896
v_mfma_f32_16x16x32_bf16 v[32:35], a[128:131], v[96:99], v[32:35]
s_mov_b32 s60, 524288
buffer_load_dword v251, v235, s[28:31], s60 offen offset:384
s_add_u32 m0, s86, 61440
s_add_u32 s3, s3, 88064
buffer_load_dwordx4 v60, s[24:27], s3 offen offset:0 lds
s_add_u32 m0, m0, 3968
ds_read_b64_tr_b16 a[44:45], v244 offset:20480
v_mfma_f32_16x16x32_bf16 v[36:39], a[132:135], v[96:99], v[36:39]
ds_read_b64_tr_b16 a[46:47], v244 offset:22528
v_mfma_f32_16x16x32_bf16 v[40:43], a[136:139], v[96:99], v[40:43]
ds_read_b64_tr_b16 a[48:49], v245 offset:20480
v_mfma_f32_16x16x32_bf16 v[44:47], a[140:143], v[96:99], v[44:47]
ds_read_b64_tr_b16 a[50:51], v245 offset:22528
s_waitcnt vmcnt(10)
v_mfma_f32_16x16x32_bf16 v[128:131], v[164:167], v[100:103], v[128:131]
ds_read_b128 v[188:191], v250 offset:960
v_mfma_f32_16x16x32_bf16 v[32:35], a[144:147], v[100:103], v[32:35]
buffer_load_dwordx4 v60, s[24:27], s3 offen offset:128 lds
s_add_u32 m0, m0, 4224
ds_read_b64_tr_b16 a[52:53], v246 offset:20480
v_mfma_f32_16x16x32_bf16 v[36:39], a[148:151], v[100:103], v[36:39]
ds_read_b64_tr_b16 a[54:55], v246 offset:22528
v_mfma_f32_16x16x32_bf16 v[40:43], a[152:155], v[100:103], v[40:43]
ds_read_b64_tr_b16 a[56:57], v247 offset:20480
v_mfma_f32_16x16x32_bf16 v[44:47], a[156:159], v[100:103], v[44:47]
ds_read_b64_tr_b16 a[58:59], v247 offset:22528
s_waitcnt vmcnt(10) lgkmcnt(15)
v_mfma_f32_16x16x32_bf16 v[128:131], v[168:171], v[104:107], v[128:131]
v_mfma_f32_16x16x32_bf16 v[32:35], a[160:163], v[104:107], v[32:35]
buffer_load_dwordx4 v61, s[24:27], s3 offen offset:0 lds
ds_read_b64_tr_b16 a[60:61], v244 offset:24576
v_mfma_f32_16x16x32_bf16 v[36:39], a[164:167], v[104:107], v[36:39]
ds_read_b64_tr_b16 a[62:63], v244 offset:26624
v_mfma_f32_16x16x32_bf16 v[40:43], a[168:171], v[104:107], v[40:43]
ds_read_b64_tr_b16 a[64:65], v245 offset:24576
v_mfma_f32_16x16x32_bf16 v[44:47], a[172:175], v[104:107], v[44:47]
ds_read_b64_tr_b16 a[66:67], v245 offset:26624
s_waitcnt vmcnt(8)
v_mfma_f32_16x16x32_bf16 v[128:131], v[172:175], v[108:111], v[128:131]
v_mfma_f32_16x16x32_bf16 v[32:35], a[176:179], v[108:111], v[32:35]
s_add_u32 m0, s86, 73728
s_add_u32 s3, s3, 88064
s_cmp_eq_u32 s3, 1409024
s_cselect_b32 s3, 0, s3
buffer_load_dwordx4 v60, s[24:27], s3 offen offset:0 lds
s_add_u32 m0, m0, 3968
ds_read_b64_tr_b16 a[68:69], v246 offset:24576
v_mfma_f32_16x16x32_bf16 v[36:39], a[180:183], v[108:111], v[36:39]
ds_read_b64_tr_b16 a[70:71], v246 offset:26624
v_mfma_f32_16x16x32_bf16 v[40:43], a[184:187], v[108:111], v[40:43]
ds_read_b64_tr_b16 a[72:73], v247 offset:24576
v_mfma_f32_16x16x32_bf16 v[44:47], a[188:191], v[108:111], v[44:47]
ds_read_b64_tr_b16 a[74:75], v247 offset:26624
s_waitcnt vmcnt(8)
v_mfma_f32_16x16x32_bf16 v[128:131], v[176:179], v[112:115], v[128:131]
v_mfma_f32_16x16x32_bf16 v[32:35], a[192:195], v[112:115], v[32:35]
buffer_load_dwordx4 v60, s[24:27], s3 offen offset:128 lds
s_add_u32 m0, m0, 4224
ds_read_b64_tr_b16 a[76:77], v244 offset:28672
v_mfma_f32_16x16x32_bf16 v[36:39], a[196:199], v[112:115], v[36:39]
ds_read_b64_tr_b16 a[78:79], v244 offset:30720
v_mfma_f32_16x16x32_bf16 v[40:43], a[200:203], v[112:115], v[40:43]
ds_read_b64_tr_b16 a[80:81], v245 offset:28672
v_mfma_f32_16x16x32_bf16 v[44:47], a[204:207], v[112:115], v[44:47]
ds_read_b64_tr_b16 a[82:83], v245 offset:30720
s_waitcnt vmcnt(8) lgkmcnt(15)
v_mfma_f32_16x16x32_bf16 v[128:131], v[180:183], v[116:119], v[128:131]
v_mfma_f32_16x16x32_bf16 v[32:35], a[208:211], v[116:119], v[32:35]
buffer_load_dwordx4 v61, s[24:27], s3 offen offset:0 lds
ds_read_b64_tr_b16 a[84:85], v246 offset:28672
v_mfma_f32_16x16x32_bf16 v[36:39], a[212:215], v[116:119], v[36:39]
ds_read_b64_tr_b16 a[86:87], v246 offset:30720
v_mfma_f32_16x16x32_bf16 v[40:43], a[216:219], v[116:119], v[40:43]
ds_read_b64_tr_b16 a[88:89], v236 offset:0
v_mfma_f32_16x16x32_bf16 v[44:47], a[220:223], v[116:119], v[44:47]
ds_read_b64_tr_b16 a[90:91], v236 offset:2048
s_waitcnt vmcnt(8)
v_mfma_f32_16x16x32_bf16 v[128:131], v[184:187], v[120:123], v[128:131]
v_mfma_f32_16x16x32_bf16 v[32:35], a[224:227], v[120:123], v[32:35]
s_add_u32 m0, s86, 86016
s_add_u32 s3, s3, 88064
buffer_load_dwordx4 v60, s[24:27], s3 offen offset:0 lds
s_add_u32 m0, m0, 3968
ds_read_b64_tr_b16 a[92:93], v237 offset:0
v_mfma_f32_16x16x32_bf16 v[36:39], a[228:231], v[120:123], v[36:39]
ds_read_b64_tr_b16 a[94:95], v237 offset:2048
v_mfma_f32_16x16x32_bf16 v[40:43], a[232:235], v[120:123], v[40:43]
ds_read_b64_tr_b16 a[96:97], v238 offset:0
v_mfma_f32_16x16x32_bf16 v[44:47], a[236:239], v[120:123], v[44:47]
ds_read_b64_tr_b16 a[98:99], v238 offset:2048
s_waitcnt vmcnt(8)
v_mfma_f32_16x16x32_bf16 v[128:131], v[188:191], v[124:127], v[128:131]
v_mfma_f32_16x16x32_bf16 v[32:35], a[240:243], v[124:127], v[32:35]
buffer_load_dwordx4 v60, s[24:27], s3 offen offset:128 lds
s_add_u32 m0, m0, 4224
ds_read_b64_tr_b16 a[100:101], v239 offset:0
v_mfma_f32_16x16x32_bf16 v[36:39], a[244:247], v[124:127], v[36:39]
ds_read_b64_tr_b16 a[102:103], v239 offset:2048
v_mfma_f32_16x16x32_bf16 v[40:43], a[248:251], v[124:127], v[40:43]
ds_read_b64_tr_b16 a[104:105], v236 offset:4096
v_mfma_f32_16x16x32_bf16 v[44:47], a[252:255], v[124:127], v[44:47]
ds_read_b64_tr_b16 a[106:107], v236 offset:6144
v_add_f32 v204, v128, v129
v_add_f32 v204, v204, v248
v_pk_add_f32 v[144:145], v[32:33], v[204:205] op_sel:[0,0] op_sel_hi:[1,0] neg_lo:[0,1] neg_hi:[0,1]
v_pk_add_f32 v[146:147], v[34:35], v[204:205] op_sel:[0,0] op_sel_hi:[1,0] neg_lo:[0,1] neg_hi:[0,1]
v_pk_add_f32 v[148:149], v[36:37], v[204:205] op_sel:[0,0] op_sel_hi:[1,0] neg_lo:[0,1] neg_hi:[0,1]
v_pk_add_f32 v[150:151], v[38:39], v[204:205] op_sel:[0,0] op_sel_hi:[1,0] neg_lo:[0,1] neg_hi:[0,1]
v_pk_add_f32 v[152:153], v[40:41], v[204:205] op_sel:[0,0] op_sel_hi:[1,0] neg_lo:[0,1] neg_hi:[0,1]
v_pk_add_f32 v[154:155], v[42:43], v[204:205] op_sel:[0,0] op_sel_hi:[1,0] neg_lo:[0,1] neg_hi:[0,1]
v_pk_add_f32 v[156:157], v[44:45], v[204:205] op_sel:[0,0] op_sel_hi:[1,0] neg_lo:[0,1] neg_hi:[0,1]
v_pk_add_f32 v[158:159], v[46:47], v[204:205] op_sel:[0,0] op_sel_hi:[1,0] neg_lo:[0,1] neg_hi:[0,1]
v_cvt_pk_bf16_f32 v64, v144, v145
v_cvt_pk_bf16_f32 v65, v146, v147
v_cvt_pk_bf16_f32 v66, v148, v149
v_cvt_pk_bf16_f32 v67, v150, v151
v_cvt_pk_bf16_f32 v68, v152, v153
v_cvt_pk_bf16_f32 v69, v154, v155
v_cvt_pk_bf16_f32 v70, v156, v157
v_cvt_pk_bf16_f32 v71, v158, v159
s_add_u32 s57, s62, 2097152
buffer_store_dwordx4 v[64:67], v12, s[44:47], s57 offen
buffer_store_dwordx4 v[68:71], v12, s[44:47], s57 offen offset:1024
s_waitcnt lgkmcnt(0)
s_barrier
v_pk_mul_f32 v[224:225], v[144:145], v[144:145]
v_pk_fma_f32 v[224:225], v[146:147], v[146:147], v[224:225]
v_pk_fma_f32 v[224:225], v[148:149], v[148:149], v[224:225]
v_pk_fma_f32 v[224:225], v[150:151], v[150:151], v[224:225]
v_pk_fma_f32 v[224:225], v[152:153], v[152:153], v[224:225]
v_pk_fma_f32 v[224:225], v[154:155], v[154:155], v[224:225]
v_pk_fma_f32 v[224:225], v[156:157], v[156:157], v[224:225]
v_pk_fma_f32 v[224:225], v[158:159], v[158:159], v[224:225]
v_add_f32 v204, v224, v225
v_mov_b32 v206, v204
s_nop 1
v_permlane32_swap_b32 v204, v206
v_add_f32 v204, v204, v206
v_mov_b32 v206, v204
s_nop 1
v_permlane16_swap_b32 v204, v206
v_add_f32 v204, v204, v206
v_mov_b32 v205, v9
s_add_u32 s38, s38, -2048
buffer_load_dwordx4 v61, s[24:27], s3 offen offset:0 lds
s_add_u32 m0, s86, 98304
s_add_u32 s3, s3, 88064
s_cmp_eq_u32 s3, 1409024
s_cselect_b32 s3, 0, s3
buffer_load_dwordx4 v60, s[24:27], s3 offen offset:0 lds
s_add_u32 m0, m0, 3968
s_nop 0
buffer_load_dwordx4 v60, s[24:27], s3 offen offset:128 lds
s_add_u32 m0, m0, 4224
s_nop 0
buffer_load_dwordx4 v61, s[24:27], s3 offen offset:0 lds
ds_read_b64_tr_b16 a[108:109], v237 offset:4096
ds_read_b64_tr_b16 a[110:111], v237 offset:6144
ds_read_b64_tr_b16 a[112:113], v238 offset:4096
ds_read_b64_tr_b16 a[114:115], v238 offset:6144
ds_read_b64_tr_b16 a[116:117], v239 offset:4096
ds_read_b64_tr_b16 a[118:119], v239 offset:6144
ds_read_b64_tr_b16 a[120:121], v236 offset:8192
ds_read_b64_tr_b16 a[122:123], v236 offset:10240
ds_read_b64_tr_b16 a[124:125], v237 offset:8192
ds_read_b64_tr_b16 a[126:127], v237 offset:10240
ds_read_b64_tr_b16 a[128:129], v238 offset:8192
ds_read_b64_tr_b16 a[130:131], v238 offset:10240
ds_read_b64_tr_b16 a[132:133], v236 offset:12288
ds_read_b64_tr_b16 a[134:135], v236 offset:14336
ds_read_b64_tr_b16 a[136:137], v237 offset:12288
ds_read_b64_tr_b16 a[138:139], v237 offset:14336
ds_read_b64_tr_b16 a[140:141], v238 offset:12288
ds_read_b64_tr_b16 a[142:143], v238 offset:14336
ds_read_b64_tr_b16 a[144:145], v239 offset:12288
ds_read_b64_tr_b16 a[146:147], v239 offset:14336
s_waitcnt vmcnt(4)
s_mov_b64 exec, 0xffff
buffer_store_dwordx2 v[204:205], v12, s[44:47], s38 offen
s_mov_b64 exec, -1
s_add_u32 m0, s86, 110592
s_add_u32 s3, s3, 88064
buffer_load_dwordx4 v60, s[24:27], s3 offen offset:0 lds
s_add_u32 m0, m0, 3968
s_nop 0
buffer_load_dwordx4 v60, s[24:27], s3 offen offset:128 lds
s_add_u32 m0, m0, 4224
ds_read_b64_tr_b16 a[148:149], v236 offset:16384
ds_read_b64_tr_b16 a[150:151], v236 offset:18432
ds_read_b64_tr_b16 a[152:153], v237 offset:16384
ds_read_b64_tr_b16 a[154:155], v237 offset:18432
ds_read_b64_tr_b16 a[156:157], v238 offset:16384
ds_read_b64_tr_b16 a[158:159], v238 offset:18432
ds_read_b64_tr_b16 a[160:161], v239 offset:16384
ds_read_b64_tr_b16 a[162:163], v239 offset:18432
ds_read_b64_tr_b16 a[164:165], v236 offset:20480
ds_read_b64_tr_b16 a[166:167], v236 offset:22528
ds_read_b64_tr_b16 a[168:169], v237 offset:20480
ds_read_b64_tr_b16 a[170:171], v237 offset:22528
ds_read_b64_tr_b16 a[172:173], v238 offset:20480
ds_read_b64_tr_b16 a[174:175], v238 offset:22528
ds_read_b64_tr_b16 a[176:177], v236 offset:24576
ds_read_b64_tr_b16 a[178:179], v236 offset:26624
ds_read_b64_tr_b16 a[180:181], v237 offset:24576
ds_read_b64_tr_b16 a[182:183], v237 offset:26624
s_mov_b32 s58, 2159616
buffer_load_dwordx4 v[200:203], v12, s[44:47], s58 offen sc1
buffer_load_dwordx4 v61, s[24:27], s3 offen offset:0 lds
s_add_u32 m0, s86, 122880
s_add_u32 s3, s3, 88064
s_cmp_eq_u32 s3, 1409024
s_cselect_b32 s3, 0, s3
buffer_load_dwordx4 v60, s[24:27], s3 offen offset:0 lds
s_add_u32 m0, m0, 3968
s_nop 0
buffer_load_dwordx4 v60, s[24:27], s3 offen offset:128 lds
s_add_u32 m0, m0, 4224
ds_read_b64_tr_b16 a[184:185], v238 offset:24576
ds_read_b64_tr_b16 a[186:187], v238 offset:26624
ds_read_b64_tr_b16 a[188:189], v239 offset:24576
ds_read_b64_tr_b16 a[190:191], v239 offset:26624
ds_read_b64_tr_b16 a[192:193], v236 offset:28672
ds_read_b64_tr_b16 a[194:195], v236 offset:30720
ds_read_b64_tr_b16 a[196:197], v237 offset:28672
ds_read_b64_tr_b16 a[198:199], v237 offset:30720
ds_read_b64_tr_b16 a[200:201], v238 offset:28672
ds_read_b64_tr_b16 a[202:203], v238 offset:30720
ds_read_b64_tr_b16 a[204:205], v239 offset:28672
ds_read_b64_tr_b16 a[206:207], v239 offset:30720
ds_read_b64_tr_b16 a[208:209], v236 offset:32768
ds_read_b64_tr_b16 a[210:211], v236 offset:34816
ds_read_b64_tr_b16 a[212:213], v237 offset:32768
ds_read_b64_tr_b16 a[214:215], v237 offset:34816
ds_read_b64_tr_b16 a[216:217], v238 offset:32768
ds_read_b64_tr_b16 a[218:219], v238 offset:34816
ds_read_b64_tr_b16 a[220:221], v236 offset:36864
ds_read_b64_tr_b16 a[222:223], v236 offset:38912
ds_read_b64_tr_b16 a[224:225], v237 offset:36864
ds_read_b64_tr_b16 a[226:227], v237 offset:38912
ds_read_b64_tr_b16 a[228:229], v238 offset:36864
ds_read_b64_tr_b16 a[230:231], v238 offset:38912
ds_read_b64_tr_b16 a[232:233], v239 offset:36864
ds_read_b64_tr_b16 a[234:235], v239 offset:38912
ds_read_b64_tr_b16 a[236:237], v236 offset:40960
ds_read_b64_tr_b16 a[238:239], v236 offset:43008
ds_read_b64_tr_b16 a[240:241], v237 offset:40960
ds_read_b64_tr_b16 a[242:243], v237 offset:43008
ds_read_b64_tr_b16 a[244:245], v238 offset:40960
ds_read_b64_tr_b16 a[246:247], v238 offset:43008
ds_read_b64_tr_b16 a[248:249], v239 offset:40960
ds_read_b64_tr_b16 a[250:251], v239 offset:43008
ds_read_b64_tr_b16 a[252:253], v236 offset:45056
ds_read_b64_tr_b16 a[254:255], v236 offset:47104
s_waitcnt vmcnt(3)
v_xor_b32 v5, v201, v9
v_bitop3_b32 v5, v5, v203, v9 bitop3:0xf6
v_cmp_ne_u32 vcc, 0, v5
s_cbranch_vccz go_24
retry_25:
s_sub_u32 s56, s56, 1
s_cbranch_scc1 L_end
buffer_load_dwordx4 v[200:203], v12, s[44:47], s58 offen sc1
s_waitcnt vmcnt(0)
v_xor_b32 v5, v201, v9
v_bitop3_b32 v5, v5, v203, v9 bitop3:0xf6
v_cmp_ne_u32 vcc, 0, v5
s_cbranch_vccnz retry_25
go_24:
v_add_u32 v7, 2097152, v12
s_add_u32 s59, s62, 2048
s_and_b32 s59, s59, 0x3fff
buffer_load_dwordx4 v[72:75], v7, s[44:47], s59 offen offset:0 sc1
buffer_load_dwordx4 v[76:79], v7, s[44:47], s59 offen offset:1024 sc1
s_add_u32 s59, s59, 2048
s_and_b32 s59, s59, 0x3fff
buffer_load_dwordx4 v[80:83], v7, s[44:47], s59 offen offset:0 sc1
buffer_load_dwordx4 v[84:87], v7, s[44:47], s59 offen offset:1024 sc1
v_mfma_f32_16x16x32_bf16 v[128:131], a[0:3], v[64:67], 0
s_add_u32 s59, s59, 2048
s_and_b32 s59, s59, 0x3fff
buffer_load_dwordx4 v[88:91], v7, s[44:47], s59 offen offset:0 sc1
ds_read_b64_tr_b16 a[0:1], v237 offset:45056
v_mfma_f32_16x16x32_bf16 v[132:135], a[4:7], v[64:67], 0
ds_read_b64_tr_b16 a[2:3], v237 offset:47104
v_add_f32 v200, v200, v202
v_mfma_f32_16x16x32_bf16 v[136:139], a[8:11], v[64:67], 0
ds_read_b64_tr_b16 a[4:5], v238 offset:45056
ds_read_b64_tr_b16 a[6:7], v238 offset:47104
v_mfma_f32_16x16x32_bf16 v[140:143], a[12:15], v[64:67], 0
buffer_load_dwordx4 v61, s[24:27], s3 offen offset:0 lds
ds_read_b64_tr_b16 a[8:9], v236 offset:49152
v_mfma_f32_16x16x32_bf16 v[144:147], a[16:19], v[64:67], 0
ds_read_b64_tr_b16 a[10:11], v236 offset:51200
v_mov_b32 v202, v200
v_mfma_f32_16x16x32_bf16 v[148:151], a[20:23], v[64:67], 0
ds_read_b64_tr_b16 a[12:13], v237 offset:49152
v_mfma_f32_16x16x32_bf16 v[152:155], a[24:27], v[64:67], 0
ds_read_b64_tr_b16 a[14:15], v237 offset:51200
ds_read_b64_tr_b16 a[16:17], v238 offset:49152
v_mfma_f32_16x16x32_bf16 v[156:159], a[28:31], v[64:67], 0
s_add_u32 m0, s86, 135168
s_add_u32 s3, s3, 88064
buffer_load_dwordx4 v60, s[24:27], s3 offen offset:0 lds
s_add_u32 m0, m0, 3968
ds_read_b64_tr_b16 a[18:19], v238 offset:51200
v_mfma_f32_16x16x32_bf16 v[160:163], a[32:35], v[64:67], 0
ds_read_b64_tr_b16 a[20:21], v239 offset:49152
ds_read_b64_tr_b16 a[22:23], v239 offset:51200
v_mfma_f32_16x16x32_bf16 v[164:167], a[36:39], v[64:67], 0
ds_read_b64_tr_b16 a[24:25], v236 offset:53248
v_permlane32_swap_b32 v200, v202
v_mfma_f32_16x16x32_bf16 v[168:171], a[40:43], v[64:67], 0
s_waitcnt vmcnt(7) lgkmcnt(7)
s_barrier
v_mfma_f32_16x16x32_bf16 v[128:131], a[44:47], v[68:71], v[128:131]
buffer_load_dwordx4 v[92:95], v7, s[44:47], s59 offen offset:1024 sc1
ds_read_b64_tr_b16 a[26:27], v236 offset:55296
v_mfma_f32_16x16x32_bf16 v[132:135], a[48:51], v[68:71], v[132:135]
ds_read_b64_tr_b16 a[28:29], v237 offset:53248
ds_read_b64_tr_b16 a[30:31], v237 offset:55296
v_mfma_f32_16x16x32_bf16 v[136:139], a[52:55], v[68:71], v[136:139]
ds_read_b64_tr_b16 a[32:33], v238 offset:53248
ds_read_b64_tr_b16 a[34:35], v238 offset:55296
v_mfma_f32_16x16x32_bf16 v[140:143], a[56:59], v[68:71], v[140:143]
buffer_load_dwordx4 v60, s[24:27], s3 offen offset:128 lds
s_add_u32 m0, m0, 4224
ds_read_b64_tr_b16 a[36:37], v239 offset:53248
v_mfma_f32_16x16x32_bf16 v[144:147], a[60:63], v[68:71], v[144:147]
ds_read_b64_tr_b16 a[38:39], v239 offset:55296
ds_read_b64_tr_b16 a[40:41], v236 offset:57344
v_mfma_f32_16x16x32_bf16 v[148:151], a[64:67], v[68:71], v[148:151]
ds_read_b64_tr_b16 a[42:43], v236 offset:59392
v_mfma_f32_16x16x32_bf16 v[152:155], a[68:71], v[68:71], v[152:155]
ds_read_b64_tr_b16 a[44:45], v237 offset:57344
v_add_f32 v200, v200, v202
v_mfma_f32_16x16x32_bf16 v[156:159], a[72:75], v[68:71], v[156:159]
buffer_load_dwordx4 v61, s[24:27], s3 offen offset:0 lds
ds_read_b64_tr_b16 a[46:47], v237 offset:59392
v_mfma_f32_16x16x32_bf16 v[160:163], a[76:79], v[68:71], v[160:163]
ds_read_b64_tr_b16 a[48:49], v238 offset:57344
ds_read_b64_tr_b16 a[50:51], v238 offset:59392
v_mfma_f32_16x16x32_bf16 v[164:167], a[80:83], v[68:71], v[164:167]
ds_read_b64_tr_b16 a[52:53], v240 offset:0
ds_read_b64_tr_b16 a[54:55], v240 offset:2048
v_mfma_f32_16x16x32_bf16 v[168:171], a[84:87], v[68:71], v[168:171]
ds_read_b64_tr_b16 a[56:57], v241 offset:0
s_waitcnt vmcnt(9)
v_mfma_f32_16x16x32_bf16 v[128:131], a[88:91], v[72:75], v[128:131]
s_add_u32 s59, s59, 2048
s_and_b32 s59, s59, 0x3fff
buffer_load_dwordx4 v[96:99], v7, s[44:47], s59 offen offset:0 sc1
ds_read_b64_tr_b16 a[58:59], v241 offset:2048
v_mfma_f32_16x16x32_bf16 v[132:135], a[92:95], v[72:75], v[132:135]
ds_read_b64_tr_b16 a[60:61], v242 offset:0
ds_read_b64_tr_b16 a[62:63], v242 offset:2048
v_mfma_f32_16x16x32_bf16 v[136:139], a[96:99], v[72:75], v[136:139]
ds_read_b64_tr_b16 a[64:65], v243 offset:0
v_mov_b32 v202, v200
v_mfma_f32_16x16x32_bf16 v[140:143], a[100:103], v[72:75], v[140:143]
s_add_u32 m0, s86, 0
s_add_u32 s3, s3, 88064
s_cmp_eq_u32 s3, 1409024
s_cselect_b32 s3, 0, s3
buffer_load_dwordx4 v60, s[24:27], s3 offen offset:0 lds
s_add_u32 m0, m0, 3968
ds_read_b64_tr_b16 a[66:67], v243 offset:2048
v_mfma_f32_16x16x32_bf16 v[144:147], a[104:107], v[72:75], v[144:147]
ds_read_b64_tr_b16 a[68:69], v240 offset:4096
ds_read_b64_tr_b16 a[70:71], v240 offset:6144
v_mfma_f32_16x16x32_bf16 v[148:151], a[108:111], v[72:75], v[148:151]
ds_read_b64_tr_b16 a[72:73], v241 offset:4096
v_mfma_f32_16x16x32_bf16 v[152:155], a[112:115], v[72:75], v[152:155]
ds_read_b64_tr_b16 a[74:75], v241 offset:6144
ds_read_b64_tr_b16 a[76:77], v242 offset:4096
v_mfma_f32_16x16x32_bf16 v[156:159], a[116:119], v[72:75], v[156:159]
buffer_load_dwordx4 v60, s[24:27], s3 offen offset:128 lds
s_add_u32 m0, m0, 4224
ds_read_b64_tr_b16 a[78:79], v242 offset:6144
v_mfma_f32_16x16x32_bf16 v[160:163], a[120:123], v[72:75], v[160:163]
ds_read_b64_tr_b16 a[80:81], v243 offset:4096
ds_read_b64_tr_b16 a[82:83], v243 offset:6144
v_mfma_f32_16x16x32_bf16 v[164:167], a[124:127], v[72:75], v[164:167]
ds_read_b64_tr_b16 a[84:85], v240 offset:8192
v_permlane16_swap_b32 v200, v202
v_mfma_f32_16x16x32_bf16 v[168:171], a[128:131], v[72:75], v[168:171]
s_waitcnt lgkmcnt(7)
s_barrier
s_waitcnt vmcnt(11)
v_mfma_f32_16x16x32_bf16 v[128:131], a[132:135], v[76:79], v[128:131]
buffer_load_dwordx4 v[100:103], v7, s[44:47], s59 offen offset:1024 sc1
ds_read_b64_tr_b16 a[86:87], v240 offset:10240
v_mfma_f32_16x16x32_bf16 v[132:135], a[136:139], v[76:79], v[132:135]
ds_read_b64_tr_b16 a[88:89], v241 offset:8192
ds_read_b64_tr_b16 a[90:91], v241 offset:10240
v_mfma_f32_16x16x32_bf16 v[136:139], a[140:143], v[76:79], v[136:139]
ds_read_b64_tr_b16 a[92:93], v242 offset:8192
v_add_f32 v200, v200, v202
v_mfma_f32_16x16x32_bf16 v[140:143], a[144:147], v[76:79], v[140:143]
buffer_load_dwordx4 v61, s[24:27], s3 offen offset:0 lds
ds_read_b64_tr_b16 a[94:95], v242 offset:10240
v_mfma_f32_16x16x32_bf16 v[144:147], a[148:151], v[76:79], v[144:147]
ds_read_b64_tr_b16 a[96:97], v240 offset:12288
ds_read_b64_tr_b16 a[98:99], v240 offset:14336
v_mfma_f32_16x16x32_bf16 v[148:151], a[152:155], v[76:79], v[148:151]
ds_read_b64_tr_b16 a[100:101], v241 offset:12288
v_mfma_f32_16x16x32_bf16 v[152:155], a[156:159], v[76:79], v[152:155]
ds_read_b64_tr_b16 a[102:103], v241 offset:14336
ds_read_b64_tr_b16 a[104:105], v242 offset:12288
v_mfma_f32_16x16x32_bf16 v[156:159], a[160:163], v[76:79], v[156:159]
s_add_u32 m0, s86, 12288
s_add_u32 s3, s3, 88064
buffer_load_dwordx4 v60, s[24:27], s3 offen offset:0 lds
s_add_u32 m0, m0, 3968
ds_read_b64_tr_b16 a[106:107], v242 offset:14336
v_mfma_f32_16x16x32_bf16 v[160:163], a[164:167], v[76:79], v[160:163]
ds_read_b64_tr_b16 a[108:109], v243 offset:12288
ds_read_b64_tr_b16 a[110:111], v243 offset:14336
v_mfma_f32_16x16x32_bf16 v[164:167], a[168:171], v[76:79], v[164:167]
ds_read_b64_tr_b16 a[112:113], v240 offset:16384
v_mov_b32 v201, 0x3727c5ac
v_mfma_f32_16x16x32_bf16 v[168:171], a[172:175], v[76:79], v[168:171]
ds_read_b64_tr_b16 a[114:115], v240 offset:18432
s_waitcnt vmcnt(13)
v_mfma_f32_16x16x32_bf16 v[128:131], a[176:179], v[80:83], v[128:131]
s_mov_b32 s60, 1048576
buffer_load_dword v251, v235, s[28:31], s60 offen offset:384
s_add_u32 s59, s59, 2048
s_and_b32 s59, s59, 0x3fff
buffer_load_dwordx4 v[104:107], v7, s[44:47], s59 offen offset:0 sc1
ds_read_b64_tr_b16 a[116:117], v241 offset:16384
v_mfma_f32_16x16x32_bf16 v[132:135], a[180:183], v[80:83], v[132:135]
ds_read_b64_tr_b16 a[118:119], v241 offset:18432
ds_read_b64_tr_b16 a[120:121], v242 offset:16384
v_mfma_f32_16x16x32_bf16 v[136:139], a[184:187], v[80:83], v[136:139]
ds_read_b64_tr_b16 a[122:123], v242 offset:18432
ds_read_b64_tr_b16 a[124:125], v243 offset:16384
v_mfma_f32_16x16x32_bf16 v[140:143], a[188:191], v[80:83], v[140:143]
buffer_load_dwordx4 v60, s[24:27], s3 offen offset:128 lds
s_add_u32 m0, m0, 4224
ds_read_b64_tr_b16 a[126:127], v243 offset:18432
v_mfma_f32_16x16x32_bf16 v[144:147], a[192:195], v[80:83], v[144:147]
ds_read_b64_tr_b16 a[128:129], v240 offset:20480
ds_read_b64_tr_b16 a[130:131], v240 offset:22528
v_mfma_f32_16x16x32_bf16 v[148:151], a[196:199], v[80:83], v[148:151]
ds_read_b64_tr_b16 a[132:133], v241 offset:20480
v_mfma_f32_16x16x32_bf16 v[152:155], a[200:203], v[80:83], v[152:155]
ds_read_b64_tr_b16 a[134:135], v241 offset:22528
ds_read_b64_tr_b16 a[136:137], v242 offset:20480
v_mfma_f32_16x16x32_bf16 v[156:159], a[204:207], v[80:83], v[156:159]
buffer_load_dwordx4 v61, s[24:27], s3 offen offset:0 lds
v_readlane_b32 s3, v13, 0
ds_read_b64_tr_b16 a[138:139], v242 offset:22528
v_mfma_f32_16x16x32_bf16 v[160:163], a[208:211], v[80:83], v[160:163]
ds_read_b64_tr_b16 a[140:141], v240 offset:24576
v_fmac_f32 v201, s91, v200
v_mfma_f32_16x16x32_bf16 v[164:167], a[212:215], v[80:83], v[164:167]
ds_read_b64_tr_b16 a[142:143], v240 offset:26624
ds_read_b64_tr_b16 a[144:145], v241 offset:24576
v_mfma_f32_16x16x32_bf16 v[168:171], a[216:219], v[80:83], v[168:171]
ds_read_b64_tr_b16 a[146:147], v241 offset:26624
s_waitcnt vmcnt(16)
v_mfma_f32_16x16x32_bf16 v[128:131], a[220:223], v[84:87], v[128:131]
buffer_load_dwordx4 v[108:111], v7, s[44:47], s59 offen offset:1024 sc1
ds_read_b64_tr_b16 a[148:149], v242 offset:24576
v_mfma_f32_16x16x32_bf16 v[132:135], a[224:227], v[84:87], v[132:135]
ds_read_b64_tr_b16 a[150:151], v242 offset:26624
ds_read_b64_tr_b16 a[152:153], v243 offset:24576
v_mfma_f32_16x16x32_bf16 v[136:139], a[228:231], v[84:87], v[136:139]
ds_read_b64_tr_b16 a[154:155], v243 offset:26624
ds_read_b64_tr_b16 a[156:157], v240 offset:28672
v_mfma_f32_16x16x32_bf16 v[140:143], a[232:235], v[84:87], v[140:143]
s_add_u32 m0, s90, 24576
s_nop 0
buffer_load_dwordx4 v48, s[28:31], s3 offen offset:0 lds
ds_read_b64_tr_b16 a[158:159], v240 offset:30720
v_mfma_f32_16x16x32_bf16 v[144:147], a[236:239], v[84:87], v[144:147]
ds_read_b64_tr_b16 a[160:161], v241 offset:28672
v_rsq_f32 v223, v201
v_mfma_f32_16x16x32_bf16 v[148:151], a[240:243], v[84:87], v[148:151]
ds_read_b64_tr_b16 a[162:163], v241 offset:30720
v_mfma_f32_16x16x32_bf16 v[152:155], a[244:247], v[84:87], v[152:155]
ds_read_b64_tr_b16 a[164:165], v242 offset:28672
ds_read_b64_tr_b16 a[166:167], v242 offset:30720
v_mfma_f32_16x16x32_bf16 v[156:159], a[248:251], v[84:87], v[156:159]
buffer_load_dwordx4 v49, s[28:31], s3 offen offset:1024 lds
ds_read_b64_tr_b16 a[168:169], v243 offset:28672
v_mfma_f32_16x16x32_bf16 v[160:163], a[252:255], v[84:87], v[160:163]
ds_read_b64_tr_b16 a[170:171], v243 offset:30720
ds_read_b64_tr_b16 a[172:173], v240 offset:32768
v_mfma_f32_16x16x32_bf16 v[164:167], a[0:3], v[84:87], v[164:167]
ds_read_b64_tr_b16 a[174:175], v240 offset:34816
v_mul_f32 v222, v201, v223
v_mfma_f32_16x16x32_bf16 v[168:171], a[4:7], v[84:87], v[168:171]
s_waitcnt vmcnt(13)
s_waitcnt vmcnt(12) lgkmcnt(7)
s_barrier
v_mfma_f32_16x16x32_bf16 v[128:131], a[8:11], v[88:91], v[128:131]
s_add_u32 s59, s59, 2048
s_and_b32 s59, s59, 0x3fff
buffer_load_dwordx4 v[112:115], v7, s[44:47], s59 offen offset:0 sc1
ds_read_b64_tr_b16 a[176:177], v241 offset:32768
v_mfma_f32_16x16x32_bf16 v[132:135], a[12:15], v[88:91], v[132:135]
ds_read_b64_tr_b16 a[178:179], v241 offset:34816
ds_read_b64_tr_b16 a[180:181], v242 offset:32768
v_mfma_f32_16x16x32_bf16 v[136:139], a[16:19], v[88:91], v[136:139]
ds_read_b64_tr_b16 a[182:183], v242 offset:34816
ds_read_b64_tr_b16 a[184:185], v240 offset:36864
v_mfma_f32_16x16x32_bf16 v[140:143], a[20:23], v[88:91], v[140:143]
buffer_load_dwordx4 v50, s[28:31], s3 offen offset:2048 lds
ds_read_b64_tr_b16 a[186:187], v240 offset:38912
v_mfma_f32_16x16x32_bf16 v[144:147], a[24:27], v[88:91], v[144:147]
ds_read_b64_tr_b16 a[188:189], v241 offset:36864
ds_read_b64_tr_b16 a[190:191], v241 offset:38912
v_mfma_f32_16x16x32_bf16 v[148:151], a[28:31], v[88:91], v[148:151]
ds_read_b64_tr_b16 a[192:193], v242 offset:36864
v_mfma_f32_16x16x32_bf16 v[152:155], a[32:35], v[88:91], v[152:155]
ds_read_b64_tr_b16 a[194:195], v242 offset:38912
ds_read_b64_tr_b16 a[196:197], v243 offset:36864
v_mfma_f32_16x16x32_bf16 v[156:159], a[36:39], v[88:91], v[156:159]
buffer_load_dwordx4 v51, s[28:31], s3 offen offset:3072 lds
v_readlane_b32 s3, v13, 1
ds_read_b64_tr_b16 a[198:199], v243 offset:38912
v_mfma_f32_16x16x32_bf16 v[160:163], a[40:43], v[88:91], v[160:163]
ds_read_b64_tr_b16 a[200:201], v240 offset:40960
v_mul_f32 v221, 0xc0135761, v223
v_mfma_f32_16x16x32_bf16 v[164:167], a[44:47], v[88:91], v[164:167]
ds_read_b64_tr_b16 a[202:203], v240 offset:43008
ds_read_b64_tr_b16 a[204:205], v241 offset:40960
v_mfma_f32_16x16x32_bf16 v[168:171], a[48:51], v[88:91], v[168:171]
ds_read_b64_tr_b16 a[206:207], v241 offset:43008
v_mfma_f32_16x16x32_bf16 v[128:131], a[52:55], v[92:95], v[128:131]
buffer_load_dwordx4 v[116:119], v7, s[44:47], s59 offen offset:1024 sc1
ds_read_b64_tr_b16 a[208:209], v242 offset:40960
v_mfma_f32_16x16x32_bf16 v[132:135], a[56:59], v[92:95], v[132:135]
ds_read_b64_tr_b16 a[210:211], v242 offset:43008
ds_read_b64_tr_b16 a[212:213], v243 offset:40960
v_mfma_f32_16x16x32_bf16 v[136:139], a[60:63], v[92:95], v[136:139]
ds_read_b64_tr_b16 a[214:215], v243 offset:43008
ds_read_b64_tr_b16 a[216:217], v240 offset:45056
v_mfma_f32_16x16x32_bf16 v[140:143], a[64:67], v[92:95], v[140:143]
s_add_u32 m0, s90, 40960
s_nop 0
buffer_load_dwordx4 v48, s[28:31], s3 offen offset:0 lds
ds_read_b64_tr_b16 a[218:219], v240 offset:47104
v_mfma_f32_16x16x32_bf16 v[144:147], a[68:71], v[92:95], v[144:147]
ds_read_b64_tr_b16 a[220:221], v241 offset:45056
v_mul_f32 v220, v223, v223
v_mfma_f32_16x16x32_bf16 v[148:151], a[72:75], v[92:95], v[148:151]
ds_read_b64_tr_b16 a[222:223], v241 offset:47104
v_mfma_f32_16x16x32_bf16 v[152:155], a[76:79], v[92:95], v[152:155]
ds_read_b64_tr_b16 a[224:225], v242 offset:45056
ds_read_b64_tr_b16 a[226:227], v242 offset:47104
v_mfma_f32_16x16x32_bf16 v[156:159], a[80:83], v[92:95], v[156:159]
buffer_load_dwordx4 v49, s[28:31], s3 offen offset:1024 lds
ds_read_b64_tr_b16 a[228:229], v240 offset:49152
v_mfma_f32_16x16x32_bf16 v[160:163], a[84:87], v[92:95], v[160:163]
ds_read_b64_tr_b16 a[230:231], v240 offset:51200
ds_read_b64_tr_b16 a[232:233], v241 offset:49152
v_mfma_f32_16x16x32_bf16 v[164:167], a[88:91], v[92:95], v[164:167]
ds_read_b64_tr_b16 a[234:235], v241 offset:51200
ds_read_b64_tr_b16 a[236:237], v242 offset:49152
v_mfma_f32_16x16x32_bf16 v[168:171], a[92:95], v[92:95], v[168:171]
ds_read_b64_tr_b16 a[238:239], v242 offset:51200
v_mfma_f32_16x16x32_bf16 v[128:131], a[96:99], v[96:99], v[128:131]
s_add_u32 s59, s59, 2048
s_and_b32 s59, s59, 0x3fff
buffer_load_dwordx4 v[120:123], v7, s[44:47], s59 offen offset:0 sc1
ds_read_b64_tr_b16 a[240:241], v243 offset:49152
v_mfma_f32_16x16x32_bf16 v[132:135], a[100:103], v[96:99], v[132:135]
ds_read_b64_tr_b16 a[242:243], v243 offset:51200
ds_read_b64_tr_b16 a[244:245], v240 offset:53248
v_mfma_f32_16x16x32_bf16 v[136:139], a[104:107], v[96:99], v[136:139]
ds_read_b64_tr_b16 a[246:247], v240 offset:55296
v_mul_f32 v220, v220, v223
v_mfma_f32_16x16x32_bf16 v[140:143], a[108:111], v[96:99], v[140:143]
buffer_load_dwordx4 v50, s[28:31], s3 offen offset:2048 lds
ds_read_b64_tr_b16 a[248:249], v241 offset:53248
v_mfma_f32_16x16x32_bf16 v[144:147], a[112:115], v[96:99], v[144:147]
ds_read_b64_tr_b16 a[250:251], v241 offset:55296
ds_read_b64_tr_b16 a[252:253], v242 offset:53248
v_mfma_f32_16x16x32_bf16 v[148:151], a[116:119], v[96:99], v[148:151]
ds_read_b64_tr_b16 a[254:255], v242 offset:55296
v_mfma_f32_16x16x32_bf16 v[152:155], a[120:123], v[96:99], v[152:155]
ds_read_b64_tr_b16 a[0:1], v243 offset:53248
ds_read_b64_tr_b16 a[2:3], v243 offset:55296
v_mfma_f32_16x16x32_bf16 v[156:159], a[124:127], v[96:99], v[156:159]
buffer_load_dwordx4 v51, s[28:31], s3 offen offset:3072 lds
v_readlane_b32 s3, v13, 2
ds_read_b64_tr_b16 a[4:5], v240 offset:57344
v_mfma_f32_16x16x32_bf16 v[160:163], a[128:131], v[96:99], v[160:163]
ds_read_b64_tr_b16 a[6:7], v240 offset:59392
ds_read_b64_tr_b16 a[8:9], v241 offset:57344
v_mfma_f32_16x16x32_bf16 v[164:167], a[132:135], v[96:99], v[164:167]
ds_read_b64_tr_b16 a[10:11], v241 offset:59392
v_mul_f32 v220, 0xbdd2d3e8, v220
v_mfma_f32_16x16x32_bf16 v[168:171], a[136:139], v[96:99], v[168:171]
s_waitcnt vmcnt(12)
s_waitcnt lgkmcnt(7)
s_barrier
v_mfma_f32_16x16x32_bf16 v[128:131], a[140:143], v[100:103], v[128:131]
buffer_load_dword v251, v235, s[28:31], 0 offen offset:384
buffer_load_dwordx4 v[124:127], v7, s[44:47], s59 offen offset:1024 sc1
ds_read_b64_tr_b16 a[12:13], v242 offset:57344
v_mfma_f32_16x16x32_bf16 v[132:135], a[144:147], v[100:103], v[132:135]
ds_read_b64_tr_b16 a[14:15], v242 offset:59392
ds_read_b64_tr_b16 a[16:17], v244 offset:0
v_mfma_f32_16x16x32_bf16 v[136:139], a[148:151], v[100:103], v[136:139]
ds_read_b64_tr_b16 a[18:19], v244 offset:2048
ds_read_b64_tr_b16 a[20:21], v245 offset:0
v_mfma_f32_16x16x32_bf16 v[140:143], a[152:155], v[100:103], v[140:143]
s_add_u32 m0, s90, 57344
s_nop 0
buffer_load_dwordx4 v48, s[28:31], s3 offen offset:0 lds
ds_read_b64_tr_b16 a[22:23], v245 offset:2048
v_mfma_f32_16x16x32_bf16 v[144:147], a[156:159], v[100:103], v[144:147]
ds_read_b64_tr_b16 a[24:25], v246 offset:0
ds_read_b64_tr_b16 a[26:27], v246 offset:2048
v_mfma_f32_16x16x32_bf16 v[148:151], a[160:163], v[100:103], v[148:151]
ds_read_b64_tr_b16 a[28:29], v247 offset:0
v_mfma_f32_16x16x32_bf16 v[152:155], a[164:167], v[100:103], v[152:155]
ds_read_b64_tr_b16 a[30:31], v247 offset:2048
ds_read_b64_tr_b16 a[32:33], v244 offset:4096
v_mfma_f32_16x16x32_bf16 v[156:159], a[168:171], v[100:103], v[156:159]
buffer_load_dwordx4 v49, s[28:31], s3 offen offset:1024 lds
ds_read_b64_tr_b16 a[34:35], v244 offset:6144
v_mfma_f32_16x16x32_bf16 v[160:163], a[172:175], v[100:103], v[160:163]
ds_read_b64_tr_b16 a[36:37], v245 offset:4096
ds_read_b64_tr_b16 a[38:39], v245 offset:6144
v_mfma_f32_16x16x32_bf16 v[164:167], a[176:179], v[100:103], v[164:167]
ds_read_b64_tr_b16 a[40:41], v246 offset:4096
v_mfma_f32_16x16x32_bf16 v[168:171], a[180:183], v[100:103], v[168:171]
ds_read_b64_tr_b16 a[42:43], v246 offset:6144
v_mfma_f32_16x16x32_bf16 v[128:131], a[184:187], v[104:107], v[128:131]
buffer_load_dwordx4 v50, s[28:31], s3 offen offset:2048 lds
ds_read_b64_tr_b16 a[44:45], v247 offset:4096
v_mfma_f32_16x16x32_bf16 v[132:135], a[188:191], v[104:107], v[132:135]
ds_read_b64_tr_b16 a[46:47], v247 offset:6144
ds_read_b64_tr_b16 a[48:49], v244 offset:8192
v_mfma_f32_16x16x32_bf16 v[136:139], a[192:195], v[104:107], v[136:139]
ds_read_b64_tr_b16 a[50:51], v244 offset:10240
ds_read_b64_tr_b16 a[52:53], v245 offset:8192
v_mfma_f32_16x16x32_bf16 v[140:143], a[196:199], v[104:107], v[140:143]
buffer_load_dwordx4 v51, s[28:31], s3 offen offset:3072 lds
v_readlane_b32 s3, v13, 3
ds_read_b64_tr_b16 a[54:55], v245 offset:10240
v_mfma_f32_16x16x32_bf16 v[144:147], a[200:203], v[104:107], v[144:147]
ds_read_b64_tr_b16 a[56:57], v246 offset:8192
ds_read_b64_tr_b16 a[58:59], v246 offset:10240
v_mfma_f32_16x16x32_bf16 v[148:151], a[204:207], v[104:107], v[148:151]
ds_read_b64_tr_b16 a[60:61], v244 offset:12288
v_mfma_f32_16x16x32_bf16 v[152:155], a[208:211], v[104:107], v[152:155]
ds_read_b64_tr_b16 a[62:63], v244 offset:14336
ds_read_b64_tr_b16 a[64:65], v245 offset:12288
v_mfma_f32_16x16x32_bf16 v[156:159], a[212:215], v[104:107], v[156:159]
s_add_u32 m0, s90, 73728
s_nop 0
buffer_load_dwordx4 v48, s[28:31], s3 offen offset:0 lds
ds_read_b64_tr_b16 a[66:67], v245 offset:14336
v_mfma_f32_16x16x32_bf16 v[160:163], a[216:219], v[104:107], v[160:163]
ds_read_b64_tr_b16 a[68:69], v246 offset:12288
ds_read_b64_tr_b16 a[70:71], v246 offset:14336
v_mfma_f32_16x16x32_bf16 v[164:167], a[220:223], v[104:107], v[164:167]
ds_read_b64_tr_b16 a[72:73], v247 offset:12288
v_mfma_f32_16x16x32_bf16 v[168:171], a[224:227], v[104:107], v[168:171]
ds_read_b64_tr_b16 a[74:75], v247 offset:14336
s_waitcnt vmcnt(18)
v_mfma_f32_16x16x32_bf16 v[128:131], a[228:231], v[108:111], v[128:131]
buffer_load_dwordx4 v49, s[28:31], s3 offen offset:1024 lds
ds_read_b64_tr_b16 a[76:77], v244 offset:16384
v_mfma_f32_16x16x32_bf16 v[132:135], a[232:235], v[108:111], v[132:135]
ds_read_b64_tr_b16 a[78:79], v244 offset:18432
ds_read_b64_tr_b16 a[80:81], v245 offset:16384
v_mfma_f32_16x16x32_bf16 v[136:139], a[236:239], v[108:111], v[136:139]
ds_read_b64_tr_b16 a[82:83], v245 offset:18432
ds_read_b64_tr_b16 a[84:85], v246 offset:16384
v_mfma_f32_16x16x32_bf16 v[140:143], a[240:243], v[108:111], v[140:143]
buffer_load_dwordx4 v50, s[28:31], s3 offen offset:2048 lds
ds_read_b64_tr_b16 a[86:87], v246 offset:18432
v_mfma_f32_16x16x32_bf16 v[144:147], a[244:247], v[108:111], v[144:147]
ds_read_b64_tr_b16 a[88:89], v247 offset:16384
ds_read_b64_tr_b16 a[90:91], v247 offset:18432
v_mfma_f32_16x16x32_bf16 v[148:151], a[248:251], v[108:111], v[148:151]
ds_read_b64_tr_b16 a[92:93], v244 offset:20480
s_waitcnt lgkmcnt(15)
v_mfma_f32_16x16x32_bf16 v[152:155], a[252:255], v[108:111], v[152:155]
ds_read_b64_tr_b16 a[94:95], v244 offset:22528
ds_read_b64_tr_b16 a[96:97], v245 offset:20480
v_mfma_f32_16x16x32_bf16 v[156:159], a[0:3], v[108:111], v[156:159]
buffer_load_dwordx4 v51, s[28:31], s3 offen offset:3072 lds
v_readlane_b32 s3, v13, 4
ds_read_b64_tr_b16 a[98:99], v245 offset:22528
v_mfma_f32_16x16x32_bf16 v[160:163], a[4:7], v[108:111], v[160:163]
ds_read_b64_tr_b16 a[100:101], v246 offset:20480
ds_read_b64_tr_b16 a[102:103], v246 offset:22528
v_mfma_f32_16x16x32_bf16 v[164:167], a[8:11], v[108:111], v[164:167]
ds_read_b64_tr_b16 a[104:105], v236 offset:0
v_mfma_f32_16x16x32_bf16 v[168:171], a[12:15], v[108:111], v[168:171]
s_waitcnt vmcnt(12) lgkmcnt(7)
s_barrier
v_mfma_f32_16x16x32_bf16 v[128:131], a[16:19], v[112:115], v[128:131]
s_add_u32 m0, s90, 90112
s_nop 0
buffer_load_dwordx4 v48, s[28:31], s3 offen offset:0 lds
ds_read_b64_tr_b16 a[106:107], v236 offset:2048
v_mfma_f32_16x16x32_bf16 v[132:135], a[20:23], v[112:115], v[132:135]
ds_read_b64_tr_b16 a[108:109], v237 offset:0
ds_read_b64_tr_b16 a[110:111], v237 offset:2048
v_mfma_f32_16x16x32_bf16 v[136:139], a[24:27], v[112:115], v[136:139]
ds_read_b64_tr_b16 a[112:113], v238 offset:0
v_mfma_f32_16x16x32_bf16 v[140:143], a[28:31], v[112:115], v[140:143]
buffer_load_dwordx4 v49, s[28:31], s3 offen offset:1024 lds
ds_read_b64_tr_b16 a[114:115], v238 offset:2048
v_mfma_f32_16x16x32_bf16 v[144:147], a[32:35], v[112:115], v[144:147]
ds_read_b64_tr_b16 a[116:117], v239 offset:0
ds_read_b64_tr_b16 a[118:119], v239 offset:2048
v_mfma_f32_16x16x32_bf16 v[148:151], a[36:39], v[112:115], v[148:151]
ds_read_b64_tr_b16 a[120:121], v236 offset:4096
v_mfma_f32_16x16x32_bf16 v[152:155], a[40:43], v[112:115], v[152:155]
ds_read_b64_tr_b16 a[122:123], v236 offset:6144
ds_read_b64_tr_b16 a[124:125], v237 offset:4096
v_mfma_f32_16x16x32_bf16 v[156:159], a[44:47], v[112:115], v[156:159]
buffer_load_dwordx4 v50, s[28:31], s3 offen offset:2048 lds
ds_read_b64_tr_b16 a[126:127], v237 offset:6144
v_mfma_f32_16x16x32_bf16 v[160:163], a[48:51], v[112:115], v[160:163]
ds_read_b64_tr_b16 a[128:129], v238 offset:4096
ds_read_b64_tr_b16 a[130:131], v238 offset:6144
v_mfma_f32_16x16x32_bf16 v[164:167], a[52:55], v[112:115], v[164:167]
ds_read_b64_tr_b16 a[132:133], v239 offset:4096
ds_read_b64_tr_b16 a[134:135], v239 offset:6144
v_mfma_f32_16x16x32_bf16 v[168:171], a[56:59], v[112:115], v[168:171]
ds_read_b64_tr_b16 a[136:137], v236 offset:8192
v_mfma_f32_16x16x32_bf16 v[128:131], a[60:63], v[116:119], v[128:131]
buffer_load_dwordx4 v51, s[28:31], s3 offen offset:3072 lds
v_readlane_b32 s3, v13, 5
ds_read_b64_tr_b16 a[138:139], v236 offset:10240
v_mfma_f32_16x16x32_bf16 v[132:135], a[64:67], v[116:119], v[132:135]
ds_read_b64_tr_b16 a[140:141], v237 offset:8192
ds_read_b64_tr_b16 a[142:143], v237 offset:10240
v_mfma_f32_16x16x32_bf16 v[136:139], a[68:71], v[116:119], v[136:139]
ds_read_b64_tr_b16 a[144:145], v238 offset:8192
ds_read_b64_tr_b16 a[146:147], v238 offset:10240
v_mfma_f32_16x16x32_bf16 v[140:143], a[72:75], v[116:119], v[140:143]
s_add_u32 m0, s90, 106496
s_nop 0
buffer_load_dwordx4 v48, s[28:31], s3 offen offset:0 lds
ds_read_b64_tr_b16 a[148:149], v236 offset:12288
v_mfma_f32_16x16x32_bf16 v[144:147], a[76:79], v[116:119], v[144:147]
ds_read_b64_tr_b16 a[150:151], v236 offset:14336
ds_read_b64_tr_b16 a[152:153], v237 offset:12288
v_mfma_f32_16x16x32_bf16 v[148:151], a[80:83], v[116:119], v[148:151]
s_waitcnt vmcnt(13)
s_add_u32 s57, s61, 2295808
s_mov_b64 exec, 1
buffer_store_dwordx2 v[8:9], v10, s[44:47], s57 offen
s_mov_b64 exec, -1
ds_read_b64_tr_b16 a[154:155], v237 offset:14336
s_waitcnt lgkmcnt(15)
v_mfma_f32_16x16x32_bf16 v[152:155], a[84:87], v[116:119], v[152:155]
ds_read_b64_tr_b16 a[156:157], v238 offset:12288
ds_read_b64_tr_b16 a[158:159], v238 offset:14336
v_mfma_f32_16x16x32_bf16 v[156:159], a[88:91], v[116:119], v[156:159]
buffer_load_dwordx4 v49, s[28:31], s3 offen offset:1024 lds
ds_read_b64_tr_b16 a[160:161], v239 offset:12288
v_mfma_f32_16x16x32_bf16 v[160:163], a[92:95], v[116:119], v[160:163]
ds_read_b64_tr_b16 a[162:163], v239 offset:14336
ds_read_b64_tr_b16 a[164:165], v236 offset:16384
v_mfma_f32_16x16x32_bf16 v[164:167], a[96:99], v[116:119], v[164:167]
ds_read_b64_tr_b16 a[166:167], v236 offset:18432
ds_read_b64_tr_b16 a[168:169], v237 offset:16384
v_mfma_f32_16x16x32_bf16 v[168:171], a[100:103], v[116:119], v[168:171]
ds_read_b64_tr_b16 a[170:171], v237 offset:18432
s_waitcnt lgkmcnt(15)
v_mfma_f32_16x16x32_bf16 v[128:131], a[104:107], v[120:123], v[128:131]
buffer_load_dwordx4 v50, s[28:31], s3 offen offset:2048 lds
ds_read_b64_tr_b16 a[172:173], v238 offset:16384
v_mfma_f32_16x16x32_bf16 v[132:135], a[108:111], v[120:123], v[132:135]
ds_read_b64_tr_b16 a[174:175], v238 offset:18432
ds_read_b64_tr_b16 a[176:177], v239 offset:16384
v_mfma_f32_16x16x32_bf16 v[136:139], a[112:115], v[120:123], v[136:139]
ds_read_b64_tr_b16 a[178:179], v239 offset:18432
ds_read_b64_tr_b16 a[180:181], v236 offset:20480
v_mfma_f32_16x16x32_bf16 v[140:143], a[116:119], v[120:123], v[140:143]
buffer_load_dwordx4 v51, s[28:31], s3 offen offset:3072 lds
v_readlane_b32 s3, v13, 6
ds_read_b64_tr_b16 a[182:183], v236 offset:22528
v_mfma_f32_16x16x32_bf16 v[144:147], a[120:123], v[120:123], v[144:147]
ds_read_b64_tr_b16 a[184:185], v237 offset:20480
ds_read_b64_tr_b16 a[186:187], v237 offset:22528
v_mfma_f32_16x16x32_bf16 v[148:151], a[124:127], v[120:123], v[148:151]
ds_read_b64_tr_b16 a[188:189], v238 offset:20480
s_waitcnt lgkmcnt(15)
v_mfma_f32_16x16x32_bf16 v[152:155], a[128:131], v[120:123], v[152:155]
ds_read_b64_tr_b16 a[190:191], v238 offset:22528
ds_read_b64_tr_b16 a[192:193], v236 offset:24576
v_mfma_f32_16x16x32_bf16 v[156:159], a[132:135], v[120:123], v[156:159]
ds_read_b64_tr_b16 a[194:195], v236 offset:26624
v_mfma_f32_16x16x32_bf16 v[160:163], a[136:139], v[120:123], v[160:163]
ds_read_b64_tr_b16 a[196:197], v237 offset:24576
v_mfma_f32_16x16x32_bf16 v[164:167], a[140:143], v[120:123], v[164:167]
ds_read_b64_tr_b16 a[198:199], v237 offset:26624
v_mfma_f32_16x16x32_bf16 v[168:171], a[144:147], v[120:123], v[168:171]
s_waitcnt vmcnt(12) lgkmcnt(7)
s_barrier
v_mfma_f32_16x16x32_bf16 v[128:131], a[148:151], v[124:127], v[128:131]
s_add_u32 m0, s90, 122880
s_nop 0
buffer_load_dwordx4 v48, s[28:31], s3 offen offset:0 lds
ds_read_b64_tr_b16 a[200:201], v238 offset:24576
v_mfma_f32_16x16x32_bf16 v[132:135], a[152:155], v[124:127], v[132:135]
ds_read_b64_tr_b16 a[202:203], v238 offset:26624
v_mfma_f32_16x16x32_bf16 v[136:139], a[156:159], v[124:127], v[136:139]
ds_read_b64_tr_b16 a[204:205], v239 offset:24576
v_mfma_f32_16x16x32_bf16 v[140:143], a[160:163], v[124:127], v[140:143]
buffer_load_dwordx4 v49, s[28:31], s3 offen offset:1024 lds
ds_read_b64_tr_b16 a[206:207], v239 offset:26624
v_mfma_f32_16x16x32_bf16 v[144:147], a[164:167], v[124:127], v[144:147]
ds_read_b64_tr_b16 a[208:209], v236 offset:28672
v_mfma_f32_16x16x32_bf16 v[148:151], a[168:171], v[124:127], v[148:151]
ds_read_b64_tr_b16 a[210:211], v236 offset:30720
s_waitcnt lgkmcnt(10)
v_mfma_f32_16x16x32_bf16 v[152:155], a[172:175], v[124:127], v[152:155]
ds_read_b64_tr_b16 a[212:213], v237 offset:28672
v_mfma_f32_16x16x32_bf16 v[156:159], a[176:179], v[124:127], v[156:159]
buffer_load_dwordx4 v50, s[28:31], s3 offen offset:2048 lds
ds_read_b64_tr_b16 a[214:215], v237 offset:30720
v_mfma_f32_16x16x32_bf16 v[160:163], a[180:183], v[124:127], v[160:163]
ds_read_b64_tr_b16 a[216:217], v238 offset:28672
v_mfma_f32_16x16x32_bf16 v[164:167], a[184:187], v[124:127], v[164:167]
ds_read_b64_tr_b16 a[218:219], v238 offset:30720
v_mfma_f32_16x16x32_bf16 v[168:171], a[188:191], v[124:127], v[168:171]
ds_read_b64_tr_b16 a[220:221], v239 offset:28672
s_waitcnt vmcnt(12)
s_waitcnt lgkmcnt(0)
s_barrier
s_mov_b32 s58, 2295808
s_mov_b64 exec, s[100:101]
buffer_load_dwordx2 v[200:201], v11, s[44:47], s58 offen sc1
s_mov_b64 exec, -1
v_pk_mul_f32 v[172:173], v[160:161], v[160:161]
v_pk_mul_f32 v[174:175], v[162:163], v[162:163]
v_pk_mul_f32 v[176:177], v[164:165], v[164:165]
v_pk_mul_f32 v[178:179], v[166:167], v[166:167]
v_pk_fma_f32 v[172:173], v[172:173], v[220:221], v[220:221] op_sel:[0,0,1] op_sel_hi:[1,0,1]
v_pk_fma_f32 v[174:175], v[174:175], v[220:221], v[220:221] op_sel:[0,0,1] op_sel_hi:[1,0,1]
v_pk_fma_f32 v[176:177], v[176:177], v[220:221], v[220:221] op_sel:[0,0,1] op_sel_hi:[1,0,1]
v_pk_fma_f32 v[178:179], v[178:179], v[220:221], v[220:221] op_sel:[0,0,1] op_sel_hi:[1,0,1]
v_pk_mul_f32 v[172:173], v[172:173], v[160:161]
v_pk_mul_f32 v[174:175], v[174:175], v[162:163]
v_pk_mul_f32 v[176:177], v[176:177], v[164:165]
v_pk_mul_f32 v[178:179], v[178:179], v[166:167]
v_exp_f32 v172, v172
v_exp_f32 v173, v173
v_exp_f32 v174, v174
v_exp_f32 v175, v175
v_exp_f32 v176, v176
v_exp_f32 v177, v177
v_exp_f32 v178, v178
v_exp_f32 v179, v179
buffer_load_dwordx4 v51, s[28:31], s3 offen offset:3072 lds
v_readlane_b32 s3, v13, 7
v_pk_fma_f32 v[172:173], v[172:173], v[222:223], v[222:223] op_sel:[0,0,0] op_sel_hi:[1,0,0]
v_pk_fma_f32 v[174:175], v[174:175], v[222:223], v[222:223] op_sel:[0,0,0] op_sel_hi:[1,0,0]
v_pk_fma_f32 v[176:177], v[176:177], v[222:223], v[222:223] op_sel:[0,0,0] op_sel_hi:[1,0,0]
v_pk_fma_f32 v[178:179], v[178:179], v[222:223], v[222:223] op_sel:[0,0,0] op_sel_hi:[1,0,0]
v_rcp_f32 v172, v172
v_rcp_f32 v173, v173
v_rcp_f32 v174, v174
v_rcp_f32 v175, v175
v_rcp_f32 v176, v176
v_rcp_f32 v177, v177
v_rcp_f32 v178, v178
v_rcp_f32 v179, v179
v_pk_mul_f32 v[172:173], v[172:173], v[160:161]
v_pk_mul_f32 v[174:175], v[174:175], v[162:163]
v_pk_mul_f32 v[176:177], v[176:177], v[164:165]
v_pk_mul_f32 v[178:179], v[178:179], v[166:167]
v_cvt_pk_bf16_f32 v80, v172, v173
v_cvt_pk_bf16_f32 v81, v174, v175
v_cvt_pk_bf16_f32 v82, v176, v177
v_cvt_pk_bf16_f32 v83, v178, v179
s_add_u32 m0, s90, 139264
s_nop 0
buffer_load_dwordx4 v48, s[28:31], s3 offen offset:0 lds
buffer_store_dwordx4 v[80:83], v12, s[44:47], s36 offen offset:0 sc1
v_pk_mul_f32 v[180:181], v[128:129], v[128:129]
v_pk_mul_f32 v[182:183], v[130:131], v[130:131]
v_pk_mul_f32 v[184:185], v[132:133], v[132:133]
v_pk_mul_f32 v[186:187], v[134:135], v[134:135]
v_pk_fma_f32 v[180:181], v[180:181], v[220:221], v[220:221] op_sel:[0,0,1] op_sel_hi:[1,0,1]
v_pk_fma_f32 v[182:183], v[182:183], v[220:221], v[220:221] op_sel:[0,0,1] op_sel_hi:[1,0,1]
v_pk_fma_f32 v[184:185], v[184:185], v[220:221], v[220:221] op_sel:[0,0,1] op_sel_hi:[1,0,1]
v_pk_fma_f32 v[186:187], v[186:187], v[220:221], v[220:221] op_sel:[0,0,1] op_sel_hi:[1,0,1]
v_pk_mul_f32 v[180:181], v[180:181], v[128:129]
v_pk_mul_f32 v[182:183], v[182:183], v[130:131]
v_pk_mul_f32 v[184:185], v[184:185], v[132:133]
v_pk_mul_f32 v[186:187], v[186:187], v[134:135]
v_exp_f32 v180, v180
v_exp_f32 v181, v181
v_exp_f32 v182, v182
v_exp_f32 v183, v183
v_exp_f32 v184, v184
v_exp_f32 v185, v185
v_exp_f32 v186, v186
v_exp_f32 v187, v187
buffer_load_dwordx4 v49, s[28:31], s3 offen offset:1024 lds
v_pk_fma_f32 v[180:181], v[180:181], v[222:223], v[222:223] op_sel:[0,0,0] op_sel_hi:[1,0,0]
v_pk_fma_f32 v[182:183], v[182:183], v[222:223], v[222:223] op_sel:[0,0,0] op_sel_hi:[1,0,0]
v_pk_fma_f32 v[184:185], v[184:185], v[222:223], v[222:223] op_sel:[0,0,0] op_sel_hi:[1,0,0]
v_pk_fma_f32 v[186:187], v[186:187], v[222:223], v[222:223] op_sel:[0,0,0] op_sel_hi:[1,0,0]
v_rcp_f32 v180, v180
v_rcp_f32 v181, v181
v_rcp_f32 v182, v182
v_rcp_f32 v183, v183
v_rcp_f32 v184, v184
v_rcp_f32 v185, v185
v_rcp_f32 v186, v186
v_rcp_f32 v187, v187
v_pk_mul_f32 v[180:181], v[180:181], v[128:129]
v_pk_mul_f32 v[182:183], v[182:183], v[130:131]
v_pk_mul_f32 v[184:185], v[184:185], v[132:133]
v_pk_mul_f32 v[186:187], v[186:187], v[134:135]
v_cvt_pk_bf16_f32 v64, v180, v181
v_cvt_pk_bf16_f32 v65, v182, v183
v_cvt_pk_bf16_f32 v66, v184, v185
v_cvt_pk_bf16_f32 v67, v186, v187
buffer_load_dwordx4 v50, s[28:31], s3 offen offset:2048 lds
s_add_u32 s36, s62, 2141184
buffer_store_dwordx4 v[64:67], v12, s[44:47], s36 offen offset:0
v_pk_mul_f32 v[172:173], v[136:137], v[136:137]
v_pk_mul_f32 v[174:175], v[138:139], v[138:139]
v_pk_mul_f32 v[176:177], v[140:141], v[140:141]
v_pk_mul_f32 v[178:179], v[142:143], v[142:143]
v_pk_fma_f32 v[172:173], v[172:173], v[220:221], v[220:221] op_sel:[0,0,1] op_sel_hi:[1,0,1]
v_pk_fma_f32 v[174:175], v[174:175], v[220:221], v[220:221] op_sel:[0,0,1] op_sel_hi:[1,0,1]
v_pk_fma_f32 v[176:177], v[176:177], v[220:221], v[220:221] op_sel:[0,0,1] op_sel_hi:[1,0,1]
v_pk_fma_f32 v[178:179], v[178:179], v[220:221], v[220:221] op_sel:[0,0,1] op_sel_hi:[1,0,1]
v_pk_mul_f32 v[172:173], v[172:173], v[136:137]
v_pk_mul_f32 v[174:175], v[174:175], v[138:139]
v_pk_mul_f32 v[176:177], v[176:177], v[140:141]
v_pk_mul_f32 v[178:179], v[178:179], v[142:143]
v_exp_f32 v172, v172
v_exp_f32 v173, v173
v_exp_f32 v174, v174
v_exp_f32 v175, v175
v_exp_f32 v176, v176
v_exp_f32 v177, v177
v_exp_f32 v178, v178
v_exp_f32 v179, v179
buffer_load_dwordx4 v51, s[28:31], s3 offen offset:3072 lds
v_readlane_b32 s3, v13, 8
v_pk_fma_f32 v[172:173], v[172:173], v[222:223], v[222:223] op_sel:[0,0,0] op_sel_hi:[1,0,0]
v_pk_fma_f32 v[174:175], v[174:175], v[222:223], v[222:223] op_sel:[0,0,0] op_sel_hi:[1,0,0]
v_pk_fma_f32 v[176:177], v[176:177], v[222:223], v[222:223] op_sel:[0,0,0] op_sel_hi:[1,0,0]
v_pk_fma_f32 v[178:179], v[178:179], v[222:223], v[222:223] op_sel:[0,0,0] op_sel_hi:[1,0,0]
v_rcp_f32 v172, v172
v_rcp_f32 v173, v173
v_rcp_f32 v174, v174
v_rcp_f32 v175, v175
v_rcp_f32 v176, v176
v_rcp_f32 v177, v177
v_rcp_f32 v178, v178
v_rcp_f32 v179, v179
v_pk_mul_f32 v[172:173], v[172:173], v[136:137]
v_pk_mul_f32 v[174:175], v[174:175], v[138:139]
v_pk_mul_f32 v[176:177], v[176:177], v[140:141]
v_pk_mul_f32 v[178:179], v[178:179], v[142:143]
v_cvt_pk_bf16_f32 v68, v172, v173
v_cvt_pk_bf16_f32 v69, v174, v175
v_cvt_pk_bf16_f32 v70, v176, v177
v_cvt_pk_bf16_f32 v71, v178, v179
s_add_u32 m0, s90, 0
s_nop 0
buffer_load_dwordx4 v48, s[28:31], s3 offen offset:0 lds
buffer_store_dwordx4 v[68:71], v12, s[44:47], s36 offen offset:1024
v_pk_mul_f32 v[180:181], v[144:145], v[144:145]
v_pk_mul_f32 v[182:183], v[146:147], v[146:147]
v_pk_mul_f32 v[184:185], v[148:149], v[148:149]
v_pk_mul_f32 v[186:187], v[150:151], v[150:151]
v_pk_fma_f32 v[180:181], v[180:181], v[220:221], v[220:221] op_sel:[0,0,1] op_sel_hi:[1,0,1]
v_pk_fma_f32 v[182:183], v[182:183], v[220:221], v[220:221] op_sel:[0,0,1] op_sel_hi:[1,0,1]
v_pk_fma_f32 v[184:185], v[184:185], v[220:221], v[220:221] op_sel:[0,0,1] op_sel_hi:[1,0,1]
v_pk_fma_f32 v[186:187], v[186:187], v[220:221], v[220:221] op_sel:[0,0,1] op_sel_hi:[1,0,1]
v_pk_mul_f32 v[180:181], v[180:181], v[144:145]
v_pk_mul_f32 v[182:183], v[182:183], v[146:147]
v_pk_mul_f32 v[184:185], v[184:185], v[148:149]
v_pk_mul_f32 v[186:187], v[186:187], v[150:151]
v_exp_f32 v180, v180
v_exp_f32 v181, v181
v_exp_f32 v182, v182
v_exp_f32 v183, v183
v_exp_f32 v184, v184
v_exp_f32 v185, v185
v_exp_f32 v186, v186
v_exp_f32 v187, v187
buffer_load_dwordx4 v49, s[28:31], s3 offen offset:1024 lds
v_pk_fma_f32 v[180:181], v[180:181], v[222:223], v[222:223] op_sel:[0,0,0] op_sel_hi:[1,0,0]
v_pk_fma_f32 v[182:183], v[182:183], v[222:223], v[222:223] op_sel:[0,0,0] op_sel_hi:[1,0,0]
v_pk_fma_f32 v[184:185], v[184:185], v[222:223], v[222:223] op_sel:[0,0,0] op_sel_hi:[1,0,0]
v_pk_fma_f32 v[186:187], v[186:187], v[222:223], v[222:223] op_sel:[0,0,0] op_sel_hi:[1,0,0]
v_rcp_f32 v180, v180
v_rcp_f32 v181, v181
v_rcp_f32 v182, v182
v_rcp_f32 v183, v183
v_rcp_f32 v184, v184
v_rcp_f32 v185, v185
v_rcp_f32 v186, v186
v_rcp_f32 v187, v187
v_pk_mul_f32 v[180:181], v[180:181], v[144:145]
v_pk_mul_f32 v[182:183], v[182:183], v[146:147]
v_pk_mul_f32 v[184:185], v[184:185], v[148:149]
v_pk_mul_f32 v[186:187], v[186:187], v[150:151]
v_cvt_pk_bf16_f32 v72, v180, v181
v_cvt_pk_bf16_f32 v73, v182, v183
v_cvt_pk_bf16_f32 v74, v184, v185
v_cvt_pk_bf16_f32 v75, v186, v187
buffer_load_dwordx4 v50, s[28:31], s3 offen offset:2048 lds
s_add_u32 s36, s62, 2097152
s_mov_b64 exec, s[100:101]
s_waitcnt vmcnt(11)
v_cmp_ne_u32 vcc, v201, v9
s_cbranch_vccz go_26
retry_27:
s_sub_u32 s56, s56, 1
s_cbranch_scc1 L_end
buffer_load_dwordx2 v[200:201], v11, s[44:47], s58 offen sc1
s_waitcnt vmcnt(0)
v_cmp_ne_u32 vcc, v201, v9
s_cbranch_vccnz retry_27
go_26:
s_mov_b64 exec, -1
buffer_store_dwordx4 v[72:75], v12, s[44:47], s36 offen offset:0
v_pk_mul_f32 v[172:173], v[152:153], v[152:153]
v_pk_mul_f32 v[174:175], v[154:155], v[154:155]
v_pk_mul_f32 v[176:177], v[156:157], v[156:157]
v_pk_mul_f32 v[178:179], v[158:159], v[158:159]
v_pk_fma_f32 v[172:173], v[172:173], v[220:221], v[220:221] op_sel:[0,0,1] op_sel_hi:[1,0,1]
v_pk_fma_f32 v[174:175], v[174:175], v[220:221], v[220:221] op_sel:[0,0,1] op_sel_hi:[1,0,1]
v_pk_fma_f32 v[176:177], v[176:177], v[220:221], v[220:221] op_sel:[0,0,1] op_sel_hi:[1,0,1]
v_pk_fma_f32 v[178:179], v[178:179], v[220:221], v[220:221] op_sel:[0,0,1] op_sel_hi:[1,0,1]
v_pk_mul_f32 v[172:173], v[172:173], v[152:153]
v_pk_mul_f32 v[174:175], v[174:175], v[154:155]
v_pk_mul_f32 v[176:177], v[176:177], v[156:157]
v_pk_mul_f32 v[178:179], v[178:179], v[158:159]
v_exp_f32 v172, v172
v_exp_f32 v173, v173
v_exp_f32 v174, v174
v_exp_f32 v175, v175
v_exp_f32 v176, v176
v_exp_f32 v177, v177
v_exp_f32 v178, v178
v_exp_f32 v179, v179
buffer_load_dwordx4 v51, s[28:31], s3 offen offset:3072 lds
v_readlane_b32 s3, v13, 9
v_pk_fma_f32 v[172:173], v[172:173], v[222:223], v[222:223] op_sel:[0,0,0] op_sel_hi:[1,0,0]
v_pk_fma_f32 v[174:175], v[174:175], v[222:223], v[222:223] op_sel:[0,0,0] op_sel_hi:[1,0,0]
v_pk_fma_f32 v[176:177], v[176:177], v[222:223], v[222:223] op_sel:[0,0,0] op_sel_hi:[1,0,0]
v_pk_fma_f32 v[178:179], v[178:179], v[222:223], v[222:223] op_sel:[0,0,0] op_sel_hi:[1,0,0]
v_rcp_f32 v172, v172
v_rcp_f32 v173, v173
v_rcp_f32 v174, v174
v_rcp_f32 v175, v175
v_rcp_f32 v176, v176
v_rcp_f32 v177, v177
v_rcp_f32 v178, v178
v_rcp_f32 v179, v179
v_pk_mul_f32 v[172:173], v[172:173], v[152:153]
v_pk_mul_f32 v[174:175], v[174:175], v[154:155]
v_pk_mul_f32 v[176:177], v[176:177], v[156:157]
v_pk_mul_f32 v[178:179], v[178:179], v[158:159]
v_cvt_pk_bf16_f32 v76, v172, v173
v_cvt_pk_bf16_f32 v77, v174, v175
v_cvt_pk_bf16_f32 v78, v176, v177
v_cvt_pk_bf16_f32 v79, v178, v179
buffer_store_dwordx4 v[76:79], v12, s[44:47], s36 offen offset:1024
v_pk_mul_f32 v[172:173], v[168:169], v[168:169]
v_pk_mul_f32 v[174:175], v[170:171], v[170:171]
v_pk_fma_f32 v[172:173], v[172:173], v[220:221], v[220:221] op_sel:[0,0,1] op_sel_hi:[1,0,1]
v_pk_fma_f32 v[174:175], v[174:175], v[220:221], v[220:221] op_sel:[0,0,1] op_sel_hi:[1,0,1]
v_pk_mul_f32 v[172:173], v[172:173], v[168:169]
v_pk_mul_f32 v[174:175], v[174:175], v[170:171]
v_exp_f32 v172, v172
v_exp_f32 v173, v173
v_exp_f32 v174, v174
v_exp_f32 v175, v175
v_pk_fma_f32 v[172:173], v[172:173], v[222:223], v[222:223] op_sel:[0,0,0] op_sel_hi:[1,0,0]
v_pk_fma_f32 v[174:175], v[174:175], v[222:223], v[222:223] op_sel:[0,0,0] op_sel_hi:[1,0,0]
v_rcp_f32 v172, v172
v_rcp_f32 v173, v173
v_rcp_f32 v174, v174
v_rcp_f32 v175, v175
v_pk_mul_f32 v[172:173], v[172:173], v[168:169]
v_pk_mul_f32 v[174:175], v[174:175], v[170:171]
v_cvt_pk_bf16_f32 v196, v172, v173
v_cvt_pk_bf16_f32 v197, v174, v175
s_cmp_ge_u32 s50, 6
s_cselect_b64 exec, 0, -1
buffer_store_dwordx2 v[196:197], v12, s[44:47], s37 offen
s_mov_b64 exec, -1
ds_read_b64_tr_b16 a[222:223], v239 offset:30720
ds_read_b64_tr_b16 a[224:225], v236 offset:32768
ds_read_b64_tr_b16 a[226:227], v236 offset:34816
ds_read_b64_tr_b16 a[228:229], v237 offset:32768
ds_read_b64_tr_b16 a[230:231], v237 offset:34816
ds_read_b64_tr_b16 a[232:233], v238 offset:32768
ds_read_b64_tr_b16 a[234:235], v238 offset:34816
ds_read_b64_tr_b16 a[236:237], v239 offset:32768
ds_read_b64_tr_b16 a[238:239], v239 offset:34816
ds_read_b64_tr_b16 a[240:241], v236 offset:36864
ds_read_b64_tr_b16 a[242:243], v236 offset:38912
ds_read_b64_tr_b16 a[244:245], v237 offset:36864
ds_read_b64_tr_b16 a[246:247], v237 offset:38912
ds_read_b64_tr_b16 a[248:249], v238 offset:36864
ds_read_b64_tr_b16 a[250:251], v238 offset:38912
ds_read_b64_tr_b16 a[252:253], v239 offset:36864
ds_read_b64_tr_b16 a[254:255], v239 offset:38912
ds_read_b64_tr_b16 a[0:1], v236 offset:40960
ds_read_b64_tr_b16 a[2:3], v236 offset:43008
ds_read_b64_tr_b16 a[4:5], v237 offset:40960
ds_read_b64_tr_b16 a[6:7], v237 offset:43008
ds_read_b64_tr_b16 a[8:9], v238 offset:40960
ds_read_b64_tr_b16 a[10:11], v238 offset:43008
ds_read_b64_tr_b16 a[12:13], v239 offset:40960
ds_read_b64_tr_b16 a[14:15], v239 offset:43008
ds_read_b64_tr_b16 a[16:17], v236 offset:45056
ds_read_b64_tr_b16 a[18:19], v236 offset:47104
ds_read_b64_tr_b16 a[20:21], v237 offset:45056
ds_read_b64_tr_b16 a[22:23], v237 offset:47104
ds_read_b64_tr_b16 a[24:25], v238 offset:45056
ds_read_b64_tr_b16 a[26:27], v238 offset:47104
ds_read_b64_tr_b16 a[28:29], v239 offset:45056
ds_read_b64_tr_b16 a[30:31], v239 offset:47104
ds_read_b64_tr_b16 a[32:33], v236 offset:49152
ds_read_b64_tr_b16 a[34:35], v236 offset:51200
ds_read_b64_tr_b16 a[36:37], v237 offset:49152
ds_read_b64_tr_b16 a[38:39], v237 offset:51200
ds_read_b64_tr_b16 a[40:41], v238 offset:49152
ds_read_b64_tr_b16 a[42:43], v238 offset:51200
ds_read_b64_tr_b16 a[44:45], v239 offset:49152
ds_read_b64_tr_b16 a[46:47], v239 offset:51200
ds_read_b64_tr_b16 a[48:49], v236 offset:53248
ds_read_b64_tr_b16 a[50:51], v236 offset:55296
ds_read_b64_tr_b16 a[52:53], v237 offset:53248
ds_read_b64_tr_b16 a[54:55], v237 offset:55296
ds_read_b64_tr_b16 a[56:57], v238 offset:53248
ds_read_b64_tr_b16 a[58:59], v238 offset:55296
ds_read_b64_tr_b16 a[60:61], v239 offset:53248
ds_read_b64_tr_b16 a[62:63], v239 offset:55296
ds_read_b64_tr_b16 a[64:65], v236 offset:57344
ds_read_b64_tr_b16 a[66:67], v236 offset:59392
ds_read_b64_tr_b16 a[68:69], v237 offset:57344
ds_read_b64_tr_b16 a[70:71], v237 offset:59392
ds_read_b64_tr_b16 a[72:73], v238 offset:57344
ds_read_b64_tr_b16 a[74:75], v238 offset:59392
ds_read_b64_tr_b16 a[76:77], v239 offset:57344
ds_read_b64_tr_b16 a[78:79], v239 offset:59392
ds_read_b64_tr_b16 a[80:81], v240 offset:0
ds_read_b64_tr_b16 a[82:83], v240 offset:2048
ds_read_b64_tr_b16 a[84:85], v241 offset:0
s_waitcnt vmcnt(0)
s_add_u32 s57, s61, 2362368
s_mov_b64 exec, 1
buffer_store_dwordx2 v[8:9], v10, s[44:47], s57 offen
s_mov_b64 exec, -1
s_waitcnt lgkmcnt(0)
s_barrier
s_add_u32 m0, s90, 24576
s_nop 0
buffer_load_dwordx4 v48, s[28:31], s3 offen offset:0 lds
buffer_load_dwordx4 v49, s[28:31], s3 offen offset:1024 lds
ds_read_b64_tr_b16 a[86:87], v241 offset:2048
ds_read_b64_tr_b16 a[88:89], v242 offset:0
ds_read_b64_tr_b16 a[90:91], v242 offset:2048
ds_read_b64_tr_b16 a[92:93], v243 offset:0
ds_read_b64_tr_b16 a[94:95], v243 offset:2048
ds_read_b64_tr_b16 a[96:97], v240 offset:4096
ds_read_b64_tr_b16 a[98:99], v240 offset:6144
ds_read_b64_tr_b16 a[100:101], v241 offset:4096
ds_read_b64_tr_b16 a[102:103], v241 offset:6144
ds_read_b64_tr_b16 a[104:105], v242 offset:4096
ds_read_b64_tr_b16 a[106:107], v242 offset:6144
ds_read_b64_tr_b16 a[108:109], v243 offset:4096
ds_read_b64_tr_b16 a[110:111], v243 offset:6144
ds_read_b64_tr_b16 a[112:113], v240 offset:8192
ds_read_b64_tr_b16 a[114:115], v240 offset:10240
ds_read_b64_tr_b16 a[116:117], v241 offset:8192
ds_read_b64_tr_b16 a[118:119], v241 offset:10240
ds_read_b64_tr_b16 a[120:121], v242 offset:8192
s_mov_b32 s58, 2362368
s_mov_b64 exec, s[100:101]
buffer_load_dwordx2 v[200:201], v11, s[44:47], s58 offen sc1
s_mov_b64 exec, -1
buffer_load_dwordx4 v50, s[28:31], s3 offen offset:2048 lds
buffer_load_dwordx4 v51, s[28:31], s3 offen offset:3072 lds
v_readlane_b32 s3, v13, 10
s_add_u32 m0, s90, 40960
s_nop 3
buffer_load_dwordx4 v48, s[28:31], s3 offen offset:0 lds
ds_read_b64_tr_b16 a[122:123], v242 offset:10240
ds_read_b64_tr_b16 a[124:125], v243 offset:8192
ds_read_b64_tr_b16 a[126:127], v243 offset:10240
ds_read_b64_tr_b16 a[128:129], v240 offset:12288
ds_read_b64_tr_b16 a[130:131], v240 offset:14336
ds_read_b64_tr_b16 a[132:133], v241 offset:12288
ds_read_b64_tr_b16 a[134:135], v241 offset:14336
ds_read_b64_tr_b16 a[136:137], v242 offset:12288
ds_read_b64_tr_b16 a[138:139], v242 offset:14336
ds_read_b64_tr_b16 a[140:141], v243 offset:12288
ds_read_b64_tr_b16 a[142:143], v243 offset:14336
ds_read_b64_tr_b16 a[144:145], v240 offset:16384
ds_read_b64_tr_b16 a[146:147], v240 offset:18432
ds_read_b64_tr_b16 a[148:149], v241 offset:16384
ds_read_b64_tr_b16 a[150:151], v241 offset:18432
ds_read_b64_tr_b16 a[152:153], v242 offset:16384
ds_read_b64_tr_b16 a[154:155], v242 offset:18432
ds_read_b64_tr_b16 a[156:157], v243 offset:16384
ds_read_b64_tr_b16 a[158:159], v243 offset:18432
ds_read_b64_tr_b16 a[160:161], v240 offset:20480
ds_read_b64_tr_b16 a[162:163], v240 offset:22528
ds_read_b64_tr_b16 a[164:165], v241 offset:20480
ds_read_b64_tr_b16 a[166:167], v241 offset:22528
ds_read_b64_tr_b16 a[168:169], v242 offset:20480
ds_read_b64_tr_b16 a[170:171], v242 offset:22528
ds_read_b64_tr_b16 a[172:173], v243 offset:20480
ds_read_b64_tr_b16 a[174:175], v243 offset:22528
ds_read_b64_tr_b16 a[176:177], v240 offset:24576
ds_read_b64_tr_b16 a[178:179], v240 offset:26624
ds_read_b64_tr_b16 a[180:181], v241 offset:24576
ds_read_b64_tr_b16 a[182:183], v241 offset:26624
ds_read_b64_tr_b16 a[184:185], v242 offset:24576
ds_read_b64_tr_b16 a[186:187], v242 offset:26624
ds_read_b64_tr_b16 a[188:189], v243 offset:24576
ds_read_b64_tr_b16 a[190:191], v243 offset:26624
s_mov_b64 exec, s[100:101]
s_waitcnt vmcnt(3)
v_cmp_ne_u32 vcc, v201, v9
s_cbranch_vccz go_28
retry_29:
s_sub_u32 s56, s56, 1
s_cbranch_scc1 L_end
buffer_load_dwordx2 v[200:201], v11, s[44:47], s58 offen sc1
s_waitcnt vmcnt(0)
v_cmp_ne_u32 vcc, v201, v9
s_cbranch_vccnz retry_29
go_28:
s_mov_b64 exec, -1
v_add_u32 v6, 2141184, v12
v_add_u32 v7, 2097152, v12
s_mov_b32 s59, s62
s_add_u32 s59, s59, 2048
s_and_b32 s59, s59, 0x3fff
buffer_load_dwordx4 v[84:87], v6, s[44:47], s59 offen offset:0 sc1
buffer_load_dwordx4 v[88:91], v6, s[44:47], s59 offen offset:1024 sc1
buffer_load_dwordx4 v[92:95], v7, s[44:47], s59 offen offset:0 sc1
buffer_load_dwordx4 v[96:99], v7, s[44:47], s59 offen offset:1024 sc1
s_lshr_b32 s58, s59, 1
s_bitset1_b32 s58, 14
buffer_load_dwordx4 v[100:103], v7, s[44:47], s58 offen offset:0 sc1
s_add_u32 s59, s59, 2048
s_and_b32 s59, s59, 0x3fff
buffer_load_dwordx4 v[104:107], v6, s[44:47], s59 offen offset:0 sc1
v_mfma_f32_16x16x32_bf16 v[32:35], a[192:195], v[64:67], v[32:35]
buffer_load_dwordx4 v[108:111], v6, s[44:47], s59 offen offset:1024 sc1
ds_read_b64_tr_b16 a[192:193], v240 offset:28672
v_mfma_f32_16x16x32_bf16 v[36:39], a[196:199], v[64:67], v[36:39]
ds_read_b64_tr_b16 a[194:195], v240 offset:30720
v_mfma_f32_16x16x32_bf16 v[40:43], a[200:203], v[64:67], v[40:43]
buffer_load_dwordx4 v49, s[28:31], s3 offen offset:1024 lds
ds_read_b64_tr_b16 a[196:197], v241 offset:28672
v_mfma_f32_16x16x32_bf16 v[44:47], a[204:207], v[64:67], v[44:47]
ds_read_b64_tr_b16 a[198:199], v241 offset:30720
v_mfma_f32_16x16x32_bf16 v[32:35], a[208:211], v[68:71], v[32:35]
buffer_load_dwordx4 v[112:115], v7, s[44:47], s59 offen offset:0 sc1
ds_read_b64_tr_b16 a[200:201], v242 offset:28672
v_mfma_f32_16x16x32_bf16 v[36:39], a[212:215], v[68:71], v[36:39]
ds_read_b64_tr_b16 a[202:203], v242 offset:30720
ds_read_b64_tr_b16 a[204:205], v243 offset:28672
v_mfma_f32_16x16x32_bf16 v[40:43], a[216:219], v[68:71], v[40:43]
buffer_load_dwordx4 v50, s[28:31], s3 offen offset:2048 lds
ds_read_b64_tr_b16 a[206:207], v243 offset:30720
v_mfma_f32_16x16x32_bf16 v[44:47], a[220:223], v[68:71], v[44:47]
s_waitcnt vmcnt(10) lgkmcnt(7)
s_barrier
v_mfma_f32_16x16x32_bf16 v[32:35], a[224:227], v[72:75], v[32:35]
ds_read_b64_tr_b16 a[208:209], v240 offset:32768
v_mfma_f32_16x16x32_bf16 v[36:39], a[228:231], v[72:75], v[36:39]
ds_read_b64_tr_b16 a[210:211], v240 offset:34816
ds_read_b64_tr_b16 a[212:213], v241 offset:32768
v_mfma_f32_16x16x32_bf16 v[40:43], a[232:235], v[72:75], v[40:43]
buffer_load_dwordx4 v51, s[28:31], s3 offen offset:3072 lds
ds_read_b64_tr_b16 a[214:215], v241 offset:34816
v_mfma_f32_16x16x32_bf16 v[44:47], a[236:239], v[72:75], v[44:47]
ds_read_b64_tr_b16 a[216:217], v242 offset:32768
ds_read_b64_tr_b16 a[218:219], v242 offset:34816
v_mfma_f32_16x16x32_bf16 v[32:35], a[240:243], v[76:79], v[32:35]
ds_read_b64_tr_b16 a[220:221], v243 offset:32768
v_mfma_f32_16x16x32_bf16 v[36:39], a[244:247], v[76:79], v[36:39]
ds_read_b64_tr_b16 a[222:223], v243 offset:34816
ds_read_b64_tr_b16 a[224:225], v240 offset:36864
v_mfma_f32_16x16x32_bf16 v[40:43], a[248:251], v[76:79], v[40:43]
ds_read_b64_tr_b16 a[226:227], v240 offset:38912
ds_read_b64_tr_b16 a[228:229], v241 offset:36864
v_mfma_f32_16x16x32_bf16 v[44:47], a[252:255], v[76:79], v[44:47]
ds_read_b64_tr_b16 a[230:231], v241 offset:38912
v_mfma_f32_16x16x32_bf16 v[32:35], a[0:3], v[80:83], v[32:35]
ds_read_b64_tr_b16 a[232:233], v242 offset:36864
v_mfma_f32_16x16x32_bf16 v[36:39], a[4:7], v[80:83], v[36:39]
ds_read_b64_tr_b16 a[234:235], v242 offset:38912
ds_read_b64_tr_b16 a[236:237], v243 offset:36864
v_mfma_f32_16x16x32_bf16 v[40:43], a[8:11], v[80:83], v[40:43]
ds_read_b64_tr_b16 a[238:239], v243 offset:38912
ds_read_b64_tr_b16 a[240:241], v240 offset:40960
v_mfma_f32_16x16x32_bf16 v[44:47], a[12:15], v[80:83], v[44:47]
ds_read_b64_tr_b16 a[242:243], v240 offset:43008
s_waitcnt vmcnt(10)
v_mfma_f32_16x16x32_bf16 v[32:35], a[16:19], v[84:87], v[32:35]
buffer_load_dwordx4 v[116:119], v7, s[44:47], s59 offen offset:1024 sc1
ds_read_b64_tr_b16 a[244:245], v241 offset:40960
v_mfma_f32_16x16x32_bf16 v[36:39], a[20:23], v[84:87], v[36:39]
ds_read_b64_tr_b16 a[246:247], v241 offset:43008
ds_read_b64_tr_b16 a[248:249], v242 offset:40960
v_mfma_f32_16x16x32_bf16 v[40:43], a[24:27], v[84:87], v[40:43]
ds_read_b64_tr_b16 a[250:251], v242 offset:43008
v_mfma_f32_16x16x32_bf16 v[44:47], a[28:31], v[84:87], v[44:47]
ds_read_b64_tr_b16 a[252:253], v243 offset:40960
s_waitcnt vmcnt(10)
v_mfma_f32_16x16x32_bf16 v[32:35], a[32:35], v[88:91], v[32:35]
s_lshr_b32 s58, s59, 1
s_bitset1_b32 s58, 14
buffer_load_dwordx4 v[120:123], v7, s[44:47], s58 offen offset:0 sc1
ds_read_b64_tr_b16 a[254:255], v243 offset:43008
v_mfma_f32_16x16x32_bf16 v[36:39], a[36:39], v[88:91], v[36:39]
ds_read_b64_tr_b16 a[0:1], v240 offset:45056
ds_read_b64_tr_b16 a[2:3], v240 offset:47104
v_mfma_f32_16x16x32_bf16 v[40:43], a[40:43], v[88:91], v[40:43]
ds_read_b64_tr_b16 a[4:5], v241 offset:45056
ds_read_b64_tr_b16 a[6:7], v241 offset:47104
v_mfma_f32_16x16x32_bf16 v[44:47], a[44:47], v[88:91], v[44:47]
ds_read_b64_tr_b16 a[8:9], v242 offset:45056
s_waitcnt vmcnt(10)
v_mfma_f32_16x16x32_bf16 v[32:35], a[48:51], v[92:95], v[32:35]
s_add_u32 s59, s59, 2048
s_and_b32 s59, s59, 0x3fff
buffer_load_dwordx4 v[124:127], v6, s[44:47], s59 offen offset:0 sc1
ds_read_b64_tr_b16 a[10:11], v242 offset:47104
v_mfma_f32_16x16x32_bf16 v[36:39], a[52:55], v[92:95], v[36:39]
ds_read_b64_tr_b16 a[12:13], v243 offset:45056
ds_read_b64_tr_b16 a[14:15], v243 offset:47104
v_mfma_f32_16x16x32_bf16 v[40:43], a[56:59], v[92:95], v[40:43]
ds_read_b64_tr_b16 a[16:17], v240 offset:49152
v_mfma_f32_16x16x32_bf16 v[44:47], a[60:63], v[92:95], v[44:47]
ds_read_b64_tr_b16 a[18:19], v240 offset:51200
s_waitcnt vmcnt(10)
v_mfma_f32_16x16x32_bf16 v[32:35], a[64:67], v[96:99], v[32:35]
buffer_load_dwordx4 v[128:131], v6, s[44:47], s59 offen offset:1024 sc1
ds_read_b64_tr_b16 a[20:21], v241 offset:49152
v_mfma_f32_16x16x32_bf16 v[36:39], a[68:71], v[96:99], v[36:39]
ds_read_b64_tr_b16 a[22:23], v241 offset:51200
ds_read_b64_tr_b16 a[24:25], v242 offset:49152
v_mfma_f32_16x16x32_bf16 v[40:43], a[72:75], v[96:99], v[40:43]
ds_read_b64_tr_b16 a[26:27], v242 offset:51200
ds_read_b64_tr_b16 a[28:29], v243 offset:49152
v_mfma_f32_16x16x32_bf16 v[44:47], a[76:79], v[96:99], v[44:47]
ds_read_b64_tr_b16 a[30:31], v243 offset:51200
s_waitcnt vmcnt(10)
v_mfma_f32_16x16x32_bf16 v[32:35], a[80:83], v[100:103], v[32:35]
buffer_load_dwordx4 v[132:135], v7, s[44:47], s59 offen offset:0 sc1
ds_read_b64_tr_b16 a[32:33], v240 offset:53248
v_mfma_f32_16x16x32_bf16 v[36:39], a[84:87], v[100:103], v[36:39]
ds_read_b64_tr_b16 a[34:35], v240 offset:55296
ds_read_b64_tr_b16 a[36:37], v241 offset:53248
v_mfma_f32_16x16x32_bf16 v[40:43], a[88:91], v[100:103], v[40:43]
ds_read_b64_tr_b16 a[38:39], v241 offset:55296
v_mfma_f32_16x16x32_bf16 v[44:47], a[92:95], v[100:103], v[44:47]
ds_read_b64_tr_b16 a[40:41], v242 offset:53248
s_waitcnt vmcnt(10)
v_mfma_f32_16x16x32_bf16 v[32:35], a[96:99], v[104:107], v[32:35]
buffer_load_dwordx4 v[136:139], v7, s[44:47], s59 offen offset:1024 sc1
ds_read_b64_tr_b16 a[42:43], v242 offset:55296
v_mfma_f32_16x16x32_bf16 v[36:39], a[100:103], v[104:107], v[36:39]
ds_read_b64_tr_b16 a[44:45], v243 offset:53248
ds_read_b64_tr_b16 a[46:47], v243 offset:55296
v_mfma_f32_16x16x32_bf16 v[40:43], a[104:107], v[104:107], v[40:43]
ds_read_b64_tr_b16 a[48:49], v240 offset:57344
ds_read_b64_tr_b16 a[50:51], v240 offset:59392
v_mfma_f32_16x16x32_bf16 v[44:47], a[108:111], v[104:107], v[44:47]
s_waitcnt lgkmcnt(7)
s_barrier
s_waitcnt vmcnt(10)
v_mfma_f32_16x16x32_bf16 v[32:35], a[112:115], v[108:111], v[32:35]
s_lshr_b32 s58, s59, 1
s_bitset1_b32 s58, 14
buffer_load_dwordx4 v[140:143], v7, s[44:47], s58 offen offset:0 sc1
ds_read_b64_tr_b16 a[52:53], v241 offset:57344
v_mfma_f32_16x16x32_bf16 v[36:39], a[116:119], v[108:111], v[36:39]
ds_read_b64_tr_b16 a[54:55], v241 offset:59392
ds_read_b64_tr_b16 a[56:57], v242 offset:57344
v_mfma_f32_16x16x32_bf16 v[40:43], a[120:123], v[108:111], v[40:43]
ds_read_b64_tr_b16 a[58:59], v242 offset:59392
v_mfma_f32_16x16x32_bf16 v[44:47], a[124:127], v[108:111], v[44:47]
ds_read_b64_tr_b16 a[60:61], v243 offset:57344
s_waitcnt vmcnt(9)
v_mfma_f32_16x16x32_bf16 v[32:35], a[128:131], v[112:115], v[32:35]
s_add_u32 s59, s59, 2048
s_and_b32 s59, s59, 0x3fff
buffer_load_dwordx4 v[144:147], v6, s[44:47], s59 offen offset:0 sc1
ds_read_b64_tr_b16 a[62:63], v243 offset:59392
v_mfma_f32_16x16x32_bf16 v[36:39], a[132:135], v[112:115], v[36:39]
ds_read_b64_tr_b16 a[64:65], v244 offset:0
ds_read_b64_tr_b16 a[66:67], v244 offset:2048
v_mfma_f32_16x16x32_bf16 v[40:43], a[136:139], v[112:115], v[40:43]
ds_read_b64_tr_b16 a[68:69], v245 offset:0
ds_read_b64_tr_b16 a[70:71], v245 offset:2048
v_mfma_f32_16x16x32_bf16 v[44:47], a[140:143], v[112:115], v[44:47]
ds_read_b64_tr_b16 a[72:73], v246 offset:0
s_waitcnt vmcnt(7)
v_mfma_f32_16x16x32_bf16 v[32:35], a[144:147], v[116:119], v[32:35]
buffer_load_dwordx4 v[148:151], v6, s[44:47], s59 offen offset:1024 sc1
ds_read_b64_tr_b16 a[74:75], v246 offset:2048
v_mfma_f32_16x16x32_bf16 v[36:39], a[148:151], v[116:119], v[36:39]
ds_read_b64_tr_b16 a[76:77], v247 offset:0
ds_read_b64_tr_b16 a[78:79], v247 offset:2048
v_mfma_f32_16x16x32_bf16 v[40:43], a[152:155], v[116:119], v[40:43]
ds_read_b64_tr_b16 a[80:81], v244 offset:4096
v_mfma_f32_16x16x32_bf16 v[44:47], a[156:159], v[116:119], v[44:47]
ds_read_b64_tr_b16 a[82:83], v244 offset:6144
s_waitcnt vmcnt(7)
v_mfma_f32_16x16x32_bf16 v[32:35], a[160:163], v[120:123], v[32:35]
buffer_load_dwordx4 v[152:155], v7, s[44:47], s59 offen offset:0 sc1
ds_read_b64_tr_b16 a[84:85], v245 offset:4096
v_mfma_f32_16x16x32_bf16 v[36:39], a[164:167], v[120:123], v[36:39]
ds_read_b64_tr_b16 a[86:87], v245 offset:6144
ds_read_b64_tr_b16 a[88:89], v246 offset:4096
v_mfma_f32_16x16x32_bf16 v[40:43], a[168:171], v[120:123], v[40:43]
ds_read_b64_tr_b16 a[90:91], v246 offset:6144
ds_read_b64_tr_b16 a[92:93], v247 offset:4096
v_mfma_f32_16x16x32_bf16 v[44:47], a[172:175], v[120:123], v[44:47]
ds_read_b64_tr_b16 a[94:95], v247 offset:6144
s_waitcnt vmcnt(7)
v_mfma_f32_16x16x32_bf16 v[32:35], a[176:179], v[124:127], v[32:35]
buffer_load_dwordx4 v[156:159], v7, s[44:47], s59 offen offset:1024 sc1
ds_read_b64_tr_b16 a[96:97], v244 offset:8192
v_mfma_f32_16x16x32_bf16 v[36:39], a[180:183], v[124:127], v[36:39]
ds_read_b64_tr_b16 a[98:99], v244 offset:10240
ds_read_b64_tr_b16 a[100:101], v245 offset:8192
v_mfma_f32_16x16x32_bf16 v[40:43], a[184:187], v[124:127], v[40:43]
ds_read_b64_tr_b16 a[102:103], v245 offset:10240
ds_read_b64_tr_b16 a[104:105], v246 offset:8192
v_mfma_f32_16x16x32_bf16 v[44:47], a[188:191], v[124:127], v[44:47]
ds_read_b64_tr_b16 a[106:107], v246 offset:10240
s_waitcnt vmcnt(7)
v_mfma_f32_16x16x32_bf16 v[32:35], a[192:195], v[128:131], v[32:35]
s_lshr_b32 s58, s59, 1
s_bitset1_b32 s58, 14
buffer_load_dwordx4 v[160:163], v7, s[44:47], s58 offen offset:0 sc1
ds_read_b64_tr_b16 a[108:109], v247 offset:8192
v_mfma_f32_16x16x32_bf16 v[36:39], a[196:199], v[128:131], v[36:39]
ds_read_b64_tr_b16 a[110:111], v247 offset:10240
ds_read_b64_tr_b16 a[112:113], v244 offset:12288
v_mfma_f32_16x16x32_bf16 v[40:43], a[200:203], v[128:131], v[40:43]
ds_read_b64_tr_b16 a[114:115], v244 offset:14336
v_mfma_f32_16x16x32_bf16 v[44:47], a[204:207], v[128:131], v[44:47]
ds_read_b64_tr_b16 a[116:117], v245 offset:12288
s_waitcnt vmcnt(7)
v_mfma_f32_16x16x32_bf16 v[32:35], a[208:211], v[132:135], v[32:35]
s_add_u32 s59, s59, 2048
s_and_b32 s59, s59, 0x3fff
buffer_load_dwordx4 v[164:167], v6, s[44:47], s59 offen offset:0 sc1
ds_read_b64_tr_b16 a[118:119], v245 offset:14336
v_mfma_f32_16x16x32_bf16 v[36:39], a[212:215], v[132:135], v[36:39]
ds_read_b64_tr_b16 a[120:121], v246 offset:12288
ds_read_b64_tr_b16 a[122:123], v246 offset:14336
v_mfma_f32_16x16x32_bf16 v[40:43], a[216:219], v[132:135], v[40:43]
ds_read_b64_tr_b16 a[124:125], v247 offset:12288
ds_read_b64_tr_b16 a[126:127], v247 offset:14336
v_mfma_f32_16x16x32_bf16 v[44:47], a[220:223], v[132:135], v[44:47]
ds_read_b64_tr_b16 a[128:129], v244 offset:16384
s_waitcnt vmcnt(7)
v_mfma_f32_16x16x32_bf16 v[32:35], a[224:227], v[136:139], v[32:35]
buffer_load_dwordx4 v[168:171], v6, s[44:47], s59 offen offset:1024 sc1
ds_read_b64_tr_b16 a[130:131], v244 offset:18432
v_mfma_f32_16x16x32_bf16 v[36:39], a[228:231], v[136:139], v[36:39]
ds_read_b64_tr_b16 a[132:133], v245 offset:16384
ds_read_b64_tr_b16 a[134:135], v245 offset:18432
v_mfma_f32_16x16x32_bf16 v[40:43], a[232:235], v[136:139], v[40:43]
ds_read_b64_tr_b16 a[136:137], v246 offset:16384
ds_read_b64_tr_b16 a[138:139], v246 offset:18432
v_mfma_f32_16x16x32_bf16 v[44:47], a[236:239], v[136:139], v[44:47]
ds_read_b64_tr_b16 a[140:141], v247 offset:16384
s_waitcnt vmcnt(7)
v_mfma_f32_16x16x32_bf16 v[32:35], a[240:243], v[140:143], v[32:35]
buffer_load_dwordx4 v[172:175], v7, s[44:47], s59 offen offset:0 sc1
ds_read_b64_tr_b16 a[142:143], v247 offset:18432
v_mfma_f32_16x16x32_bf16 v[36:39], a[244:247], v[140:143], v[36:39]
ds_read_b64_tr_b16 a[144:145], v244 offset:20480
ds_read_b64_tr_b16 a[146:147], v244 offset:22528
v_mfma_f32_16x16x32_bf16 v[40:43], a[248:251], v[140:143], v[40:43]
ds_read_b64_tr_b16 a[148:149], v245 offset:20480
v_mfma_f32_16x16x32_bf16 v[44:47], a[252:255], v[140:143], v[44:47]
ds_read_b64_tr_b16 a[150:151], v245 offset:22528
s_waitcnt vmcnt(7)
v_mfma_f32_16x16x32_bf16 v[32:35], a[0:3], v[144:147], v[32:35]
buffer_load_dwordx4 v[176:179], v7, s[44:47], s59 offen offset:1024 sc1
ds_read_b64_tr_b16 a[152:153], v246 offset:20480
v_mfma_f32_16x16x32_bf16 v[36:39], a[4:7], v[144:147], v[36:39]
ds_read_b64_tr_b16 a[154:155], v246 offset:22528
ds_read_b64_tr_b16 a[156:157], v247 offset:20480
v_mfma_f32_16x16x32_bf16 v[40:43], a[8:11], v[144:147], v[40:43]
ds_read_b64_tr_b16 a[158:159], v247 offset:22528
ds_read_b64_tr_b16 a[160:161], v244 offset:24576
v_mfma_f32_16x16x32_bf16 v[44:47], a[12:15], v[144:147], v[44:47]
s_waitcnt lgkmcnt(7)
s_barrier
s_waitcnt vmcnt(7)
v_mfma_f32_16x16x32_bf16 v[32:35], a[16:19], v[148:151], v[32:35]
s_lshr_b32 s58, s59, 1
s_bitset1_b32 s58, 14
buffer_load_dwordx4 v[180:183], v7, s[44:47], s58 offen offset:0 sc1
ds_read_b64_tr_b16 a[162:163], v244 offset:26624
v_mfma_f32_16x16x32_bf16 v[36:39], a[20:23], v[148:151], v[36:39]
ds_read_b64_tr_b16 a[164:165], v245 offset:24576
ds_read_b64_tr_b16 a[166:167], v245 offset:26624
v_mfma_f32_16x16x32_bf16 v[40:43], a[24:27], v[148:151], v[40:43]
ds_read_b64_tr_b16 a[168:169], v246 offset:24576
v_mfma_f32_16x16x32_bf16 v[44:47], a[28:31], v[148:151], v[44:47]
ds_read_b64_tr_b16 a[170:171], v246 offset:26624
s_waitcnt vmcnt(7)
v_mfma_f32_16x16x32_bf16 v[32:35], a[32:35], v[152:155], v[32:35]
s_add_u32 s59, s59, 2048
s_and_b32 s59, s59, 0x3fff
buffer_load_dwordx4 v[184:187], v6, s[44:47], s59 offen offset:0 sc1
ds_read_b64_tr_b16 a[172:173], v247 offset:24576
v_mfma_f32_16x16x32_bf16 v[36:39], a[36:39], v[152:155], v[36:39]
ds_read_b64_tr_b16 a[174:175], v247 offset:26624
ds_read_b64_tr_b16 a[176:177], v244 offset:28672
v_mfma_f32_16x16x32_bf16 v[40:43], a[40:43], v[152:155], v[40:43]
ds_read_b64_tr_b16 a[178:179], v244 offset:30720
ds_read_b64_tr_b16 a[180:181], v245 offset:28672
v_mfma_f32_16x16x32_bf16 v[44:47], a[44:47], v[152:155], v[44:47]
ds_read_b64_tr_b16 a[182:183], v245 offset:30720
s_waitcnt vmcnt(7)
v_mfma_f32_16x16x32_bf16 v[32:35], a[48:51], v[156:159], v[32:35]
buffer_load_dwordx4 v[188:191], v6, s[44:47], s59 offen offset:1024 sc1
ds_read_b64_tr_b16 a[184:185], v246 offset:28672
v_mfma_f32_16x16x32_bf16 v[36:39], a[52:55], v[156:159], v[36:39]
ds_read_b64_tr_b16 a[186:187], v246 offset:30720
ds_read_b64_tr_b16 a[188:189], v247 offset:28672
v_mfma_f32_16x16x32_bf16 v[40:43], a[56:59], v[156:159], v[40:43]
ds_read_b64_tr_b16 a[190:191], v247 offset:30720
ds_read_b64_tr_b16 a[192:193], v236 offset:0
v_mfma_f32_16x16x32_bf16 v[44:47], a[60:63], v[156:159], v[44:47]
ds_read_b64_tr_b16 a[194:195], v236 offset:2048
s_waitcnt vmcnt(7)
v_mfma_f32_16x16x32_bf16 v[32:35], a[64:67], v[160:163], v[32:35]
buffer_load_dwordx4 v[64:67], v7, s[44:47], s59 offen offset:0 sc1
ds_read_b64_tr_b16 a[196:197], v237 offset:0
v_mfma_f32_16x16x32_bf16 v[36:39], a[68:71], v[160:163], v[36:39]
ds_read_b64_tr_b16 a[198:199], v237 offset:2048
ds_read_b64_tr_b16 a[200:201], v238 offset:0
v_mfma_f32_16x16x32_bf16 v[40:43], a[72:75], v[160:163], v[40:43]
ds_read_b64_tr_b16 a[202:203], v238 offset:2048
v_mfma_f32_16x16x32_bf16 v[44:47], a[76:79], v[160:163], v[44:47]
ds_read_b64_tr_b16 a[204:205], v239 offset:0
s_waitcnt vmcnt(7)
v_mfma_f32_16x16x32_bf16 v[32:35], a[80:83], v[164:167], v[32:35]
buffer_load_dwordx4 v[68:71], v7, s[44:47], s59 offen offset:1024 sc1
ds_read_b64_tr_b16 a[206:207], v239 offset:2048
v_mfma_f32_16x16x32_bf16 v[36:39], a[84:87], v[164:167], v[36:39]
ds_read_b64_tr_b16 a[208:209], v236 offset:4096
ds_read_b64_tr_b16 a[210:211], v236 offset:6144
v_mfma_f32_16x16x32_bf16 v[40:43], a[88:91], v[164:167], v[40:43]
ds_read_b64_tr_b16 a[212:213], v237 offset:4096
ds_read_b64_tr_b16 a[214:215], v237 offset:6144
v_mfma_f32_16x16x32_bf16 v[44:47], a[92:95], v[164:167], v[44:47]
ds_read_b64_tr_b16 a[216:217], v238 offset:4096
s_waitcnt vmcnt(7)
v_mfma_f32_16x16x32_bf16 v[32:35], a[96:99], v[168:171], v[32:35]
s_lshr_b32 s58, s59, 1
s_bitset1_b32 s58, 14
buffer_load_dwordx4 v[72:75], v7, s[44:47], s58 offen offset:0 sc1
ds_read_b64_tr_b16 a[218:219], v238 offset:6144
v_mfma_f32_16x16x32_bf16 v[36:39], a[100:103], v[168:171], v[36:39]
ds_read_b64_tr_b16 a[220:221], v239 offset:4096
ds_read_b64_tr_b16 a[222:223], v239 offset:6144
v_mfma_f32_16x16x32_bf16 v[40:43], a[104:107], v[168:171], v[40:43]
ds_read_b64_tr_b16 a[224:225], v236 offset:8192
ds_read_b64_tr_b16 a[226:227], v236 offset:10240
v_mfma_f32_16x16x32_bf16 v[44:47], a[108:111], v[168:171], v[44:47]
ds_read_b64_tr_b16 a[228:229], v237 offset:8192
s_waitcnt vmcnt(7)
v_mfma_f32_16x16x32_bf16 v[32:35], a[112:115], v[172:175], v[32:35]
s_add_u32 s59, s59, 2048
s_and_b32 s59, s59, 0x3fff
buffer_load_dwordx4 v[76:79], v6, s[44:47], s59 offen offset:0 sc1
ds_read_b64_tr_b16 a[230:231], v237 offset:10240
v_mfma_f32_16x16x32_bf16 v[36:39], a[116:119], v[172:175], v[36:39]
ds_read_b64_tr_b16 a[232:233], v238 offset:8192
ds_read_b64_tr_b16 a[234:235], v238 offset:10240
v_mfma_f32_16x16x32_bf16 v[40:43], a[120:123], v[172:175], v[40:43]
ds_read_b64_tr_b16 a[236:237], v239 offset:8192
v_mfma_f32_16x16x32_bf16 v[44:47], a[124:127], v[172:175], v[44:47]
ds_read_b64_tr_b16 a[238:239], v239 offset:10240
s_waitcnt vmcnt(7)
v_mfma_f32_16x16x32_bf16 v[32:35], a[128:131], v[176:179], v[32:35]
buffer_load_dwordx4 v[80:83], v6, s[44:47], s59 offen offset:1024 sc1
ds_read_b64_tr_b16 a[240:241], v236 offset:12288
v_mfma_f32_16x16x32_bf16 v[36:39], a[132:135], v[176:179], v[36:39]
ds_read_b64_tr_b16 a[242:243], v236 offset:14336
ds_read_b64_tr_b16 a[244:245], v237 offset:12288
v_mfma_f32_16x16x32_bf16 v[40:43], a[136:139], v[176:179], v[40:43]
ds_read_b64_tr_b16 a[246:247], v237 offset:14336
ds_read_b64_tr_b16 a[248:249], v238 offset:12288
v_mfma_f32_16x16x32_bf16 v[44:47], a[140:143], v[176:179], v[44:47]
ds_read_b64_tr_b16 a[250:251], v238 offset:14336
s_waitcnt vmcnt(7) lgkmcnt(15)
v_mfma_f32_16x16x32_bf16 v[32:35], a[144:147], v[180:183], v[32:35]
buffer_load_dwordx4 v[84:87], v7, s[44:47], s59 offen offset:0 sc1
ds_read_b64_tr_b16 a[252:253], v239 offset:12288
v_mfma_f32_16x16x32_bf16 v[36:39], a[148:151], v[180:183], v[36:39]
ds_read_b64_tr_b16 a[254:255], v239 offset:14336
ds_read_b64_tr_b16 a[0:1], v236 offset:24576
v_mfma_f32_16x16x32_bf16 v[40:43], a[152:155], v[180:183], v[40:43]
ds_read_b64_tr_b16 a[2:3], v236 offset:26624
ds_read_b64_tr_b16 a[4:5], v237 offset:24576
v_mfma_f32_16x16x32_bf16 v[44:47], a[156:159], v[180:183], v[44:47]
ds_read_b64_tr_b16 a[6:7], v237 offset:26624
s_waitcnt vmcnt(7)
v_mfma_f32_16x16x32_bf16 v[32:35], a[160:163], v[184:187], v[32:35]
buffer_load_dwordx4 v[88:91], v7, s[44:47], s59 offen offset:1024 sc1
ds_read_b64_tr_b16 a[8:9], v238 offset:24576
v_mfma_f32_16x16x32_bf16 v[36:39], a[164:167], v[184:187], v[36:39]
ds_read_b64_tr_b16 a[10:11], v238 offset:26624
ds_read_b64_tr_b16 a[12:13], v239 offset:24576
v_mfma_f32_16x16x32_bf16 v[40:43], a[168:171], v[184:187], v[40:43]
ds_read_b64_tr_b16 a[14:15], v239 offset:26624
v_mfma_f32_16x16x32_bf16 v[44:47], a[172:175], v[184:187], v[44:47]
ds_read_b64_tr_b16 a[16:17], v236 offset:28672
s_waitcnt vmcnt(7)
v_mfma_f32_16x16x32_bf16 v[32:35], a[176:179], v[188:191], v[32:35]
s_lshr_b32 s58, s59, 1
s_bitset1_b32 s58, 14
buffer_load_dwordx4 v[92:95], v7, s[44:47], s58 offen offset:0 sc1
ds_read_b64_tr_b16 a[18:19], v236 offset:30720
v_mfma_f32_16x16x32_bf16 v[36:39], a[180:183], v[188:191], v[36:39]
ds_read_b64_tr_b16 a[20:21], v237 offset:28672
ds_read_b64_tr_b16 a[22:23], v237 offset:30720
v_mfma_f32_16x16x32_bf16 v[40:43], a[184:187], v[188:191], v[40:43]
ds_read_b64_tr_b16 a[24:25], v238 offset:28672
ds_read_b64_tr_b16 a[26:27], v238 offset:30720
v_mfma_f32_16x16x32_bf16 v[44:47], a[188:191], v[188:191], v[44:47]
ds_read_b64_tr_b16 a[28:29], v239 offset:28672
s_waitcnt vmcnt(7)
v_mfma_f32_16x16x32_bf16 v[32:35], a[192:195], v[64:67], v[32:35]
s_mov_b32 s58, 40960
buffer_load_dwordx4 v[96:99], v7, s[44:47], s58 offen offset:0 sc1
ds_read_b64_tr_b16 a[30:31], v239 offset:30720
v_mfma_f32_16x16x32_bf16 v[36:39], a[196:199], v[64:67], v[36:39]
ds_read_b64_tr_b16 a[32:33], v236 offset:32768
ds_read_b64_tr_b16 a[34:35], v236 offset:34816
v_mfma_f32_16x16x32_bf16 v[40:43], a[200:203], v[64:67], v[40:43]
ds_read_b64_tr_b16 a[36:37], v237 offset:32768
ds_read_b64_tr_b16 a[38:39], v237 offset:34816
v_mfma_f32_16x16x32_bf16 v[44:47], a[204:207], v[64:67], v[44:47]
ds_read_b64_tr_b16 a[40:41], v238 offset:32768
s_waitcnt vmcnt(7) lgkmcnt(15)
v_mfma_f32_16x16x32_bf16 v[32:35], a[208:211], v[68:71], v[32:35]
buffer_load_dwordx4 v[100:103], v7, s[44:47], s58 offen offset:1024 sc1
ds_read_b64_tr_b16 a[42:43], v238 offset:34816
v_mfma_f32_16x16x32_bf16 v[36:39], a[212:215], v[68:71], v[36:39]
ds_read_b64_tr_b16 a[44:45], v239 offset:32768
ds_read_b64_tr_b16 a[46:47], v239 offset:34816
v_mfma_f32_16x16x32_bf16 v[40:43], a[216:219], v[68:71], v[40:43]
ds_read_b64_tr_b16 a[48:49], v236 offset:36864
v_mfma_f32_16x16x32_bf16 v[44:47], a[220:223], v[68:71], v[44:47]
ds_read_b64_tr_b16 a[50:51], v236 offset:38912
s_waitcnt vmcnt(7)
v_mfma_f32_16x16x32_bf16 v[32:35], a[224:227], v[72:75], v[32:35]
buffer_load_dwordx4 v[104:107], v7, s[44:47], s58 offen offset:2048 sc1
ds_read_b64_tr_b16 a[52:53], v237 offset:36864
v_mfma_f32_16x16x32_bf16 v[36:39], a[228:231], v[72:75], v[36:39]
ds_read_b64_tr_b16 a[54:55], v237 offset:38912
ds_read_b64_tr_b16 a[56:57], v238 offset:36864
v_mfma_f32_16x16x32_bf16 v[40:43], a[232:235], v[72:75], v[40:43]
ds_read_b64_tr_b16 a[58:59], v238 offset:38912
ds_read_b64_tr_b16 a[60:61], v239 offset:36864
v_mfma_f32_16x16x32_bf16 v[44:47], a[236:239], v[72:75], v[44:47]
ds_read_b64_tr_b16 a[62:63], v239 offset:38912
s_waitcnt vmcnt(7)
v_mfma_f32_16x16x32_bf16 v[32:35], a[240:243], v[76:79], v[32:35]
ds_read_b64_tr_b16 a[64:65], v236 offset:40960
v_mfma_f32_16x16x32_bf16 v[36:39], a[244:247], v[76:79], v[36:39]
ds_read_b64_tr_b16 a[66:67], v236 offset:43008
ds_read_b64_tr_b16 a[68:69], v237 offset:40960
v_mfma_f32_16x16x32_bf16 v[40:43], a[248:251], v[76:79], v[40:43]
ds_read_b64_tr_b16 a[70:71], v237 offset:43008
ds_read_b64_tr_b16 a[72:73], v238 offset:40960
v_mfma_f32_16x16x32_bf16 v[44:47], a[252:255], v[76:79], v[44:47]
ds_read_b64_tr_b16 a[74:75], v238 offset:43008
s_waitcnt vmcnt(6) lgkmcnt(15)
v_mfma_f32_16x16x32_bf16 v[32:35], a[0:3], v[80:83], v[32:35]
ds_read_b64_tr_b16 a[76:77], v239 offset:40960
v_mfma_f32_16x16x32_bf16 v[36:39], a[4:7], v[80:83], v[36:39]
ds_read_b64_tr_b16 a[78:79], v239 offset:43008
ds_read_b64_tr_b16 a[80:81], v236 offset:45056
v_mfma_f32_16x16x32_bf16 v[40:43], a[8:11], v[80:83], v[40:43]
ds_read_b64_tr_b16 a[82:83], v236 offset:47104
ds_read_b64_tr_b16 a[84:85], v237 offset:45056
v_mfma_f32_16x16x32_bf16 v[44:47], a[12:15], v[80:83], v[44:47]
ds_read_b64_tr_b16 a[86:87], v237 offset:47104
s_waitcnt vmcnt(5)
v_mfma_f32_16x16x32_bf16 v[32:35], a[16:19], v[84:87], v[32:35]
ds_read_b64_tr_b16 a[88:89], v238 offset:45056
v_mfma_f32_16x16x32_bf16 v[36:39], a[20:23], v[84:87], v[36:39]
ds_read_b64_tr_b16 a[90:91], v238 offset:47104
ds_read_b64_tr_b16 a[92:93], v239 offset:45056
v_mfma_f32_16x16x32_bf16 v[40:43], a[24:27], v[84:87], v[40:43]
ds_read_b64_tr_b16 a[94:95], v239 offset:47104
ds_read_b64_tr_b16 a[96:97], v236 offset:49152
v_mfma_f32_16x16x32_bf16 v[44:47], a[28:31], v[84:87], v[44:47]
ds_read_b64_tr_b16 a[98:99], v236 offset:51200
s_waitcnt vmcnt(4) lgkmcnt(15)
v_mfma_f32_16x16x32_bf16 v[32:35], a[32:35], v[88:91], v[32:35]
ds_read_b64_tr_b16 a[100:101], v237 offset:49152
v_mfma_f32_16x16x32_bf16 v[36:39], a[36:39], v[88:91], v[36:39]
ds_read_b64_tr_b16 a[102:103], v237 offset:51200
ds_read_b64_tr_b16 a[104:105], v238 offset:49152
v_mfma_f32_16x16x32_bf16 v[40:43], a[40:43], v[88:91], v[40:43]
ds_read_b64_tr_b16 a[106:107], v238 offset:51200
v_mfma_f32_16x16x32_bf16 v[44:47], a[44:47], v[88:91], v[44:47]
ds_read_b64_tr_b16 a[108:109], v239 offset:49152
s_waitcnt vmcnt(3)
v_mfma_f32_16x16x32_bf16 v[32:35], a[48:51], v[92:95], v[32:35]
ds_read_b64_tr_b16 a[110:111], v239 offset:51200
v_mfma_f32_16x16x32_bf16 v[36:39], a[52:55], v[92:95], v[36:39]
v_mfma_f32_16x16x32_bf16 v[40:43], a[56:59], v[92:95], v[40:43]
v_mfma_f32_16x16x32_bf16 v[44:47], a[60:63], v[92:95], v[44:47]
ds_read_b128 v[200:203], v14 offset:768
ds_read_b128 v[204:207], v14 offset:832
ds_read_b128 v[208:211], v14 offset:896
ds_read_b128 v[212:215], v14 offset:960
s_waitcnt vmcnt(2) lgkmcnt(15)
v_mfma_f32_16x16x32_bf16 v[32:35], a[64:67], v[96:99], v[32:35]
v_mfma_f32_16x16x32_bf16 v[36:39], a[68:71], v[96:99], v[36:39]
v_mfma_f32_16x16x32_bf16 v[40:43], a[72:75], v[96:99], v[40:43]
v_mfma_f32_16x16x32_bf16 v[44:47], a[76:79], v[96:99], v[44:47]
s_waitcnt vmcnt(1) lgkmcnt(12)
v_mfma_f32_16x16x32_bf16 v[32:35], a[80:83], v[100:103], v[32:35]
s_mul_i32 s57, s52, 2304
s_add_u32 s57, s57, 65536
v_mfma_f32_16x16x32_bf16 v[36:39], a[84:87], v[100:103], v[36:39]
v_mul_u32_u24 v5, 144, v4
v_lshl_add_u32 v5, v3, 3, v5
v_mfma_f32_16x16x32_bf16 v[40:43], a[88:91], v[100:103], v[40:43]
v_add_u32 v5, s57, v5
v_lshrrev_b32 v252, 3, v1
v_mfma_f32_16x16x32_bf16 v[44:47], a[92:95], v[100:103], v[44:47]
v_mul_u32_u24 v8, 144, v252
v_and_b32 v6, 7, v1
s_waitcnt vmcnt(0) lgkmcnt(4)
v_mfma_f32_16x16x32_bf16 v[32:35], a[96:99], v[104:107], v[32:35]
v_lshlrev_b32 v6, 4, v6
v_add3_u32 v8, v8, v6, s57
v_mfma_f32_16x16x32_bf16 v[36:39], a[100:103], v[104:107], v[36:39]
v_lshl_add_u32 v252, v252, 10, v6
v_mfma_f32_16x16x32_bf16 v[40:43], a[104:107], v[104:107], v[40:43]
v_mfma_f32_16x16x32_bf16 v[44:47], a[108:111], v[104:107], v[44:47]
s_waitcnt lgkmcnt(0)
s_nop 0
v_pk_fma_f32 v[16:17], v[32:33], v[200:201], v[16:17]
v_pk_fma_f32 v[18:19], v[34:35], v[202:203], v[18:19]
s_nop 0
v_pk_fma_f32 v[20:21], v[36:37], v[204:205], v[20:21]
v_pk_fma_f32 v[22:23], v[38:39], v[206:207], v[22:23]
v_pk_fma_f32 v[24:25], v[40:41], v[208:209], v[24:25]
v_pk_fma_f32 v[26:27], v[42:43], v[210:211], v[26:27]
v_pk_fma_f32 v[28:29], v[44:45], v[212:213], v[28:29]
v_pk_fma_f32 v[30:31], v[46:47], v[214:215], v[30:31]
v_cvt_pk_bf16_f32 v192, v16, v17
v_cvt_pk_bf16_f32 v193, v18, v19
v_cvt_pk_bf16_f32 v194, v20, v21
v_cvt_pk_bf16_f32 v195, v22, v23
v_cvt_pk_bf16_f32 v196, v24, v25
v_cvt_pk_bf16_f32 v197, v26, v27
v_cvt_pk_bf16_f32 v198, v28, v29
v_cvt_pk_bf16_f32 v199, v30, v31
ds_write2_b64 v5, v[192:193], v[194:195] offset0:0 offset1:4
ds_write2_b64 v5, v[196:197], v[198:199] offset0:8 offset1:12
ds_read_b128 v[64:67], v8
ds_read_b128 v[68:71], v8 offset:1152
s_add_u32 s57, s33, 8192
s_waitcnt lgkmcnt(1)
buffer_store_dwordx4 v[64:67], v252, s[40:43], s33 offen nt
s_waitcnt lgkmcnt(0)
buffer_store_dwordx4 v[68:71], v252, s[40:43], s57 offen nt
s_endpgm
L_slow:
s_add_u32 s57, s95, 2097152
s_add_u32 s58, s95, 2230272
buffer_store_dwordx4 v[224:227], v252, s[44:47], s57 offen sc1
buffer_store_dwordx4 v[228:231], v252, s[44:47], s58 offen sc1
v_mov_b32 v60, v44
v_mov_b32 v61, v45
buffer_load_dwordx4 v50, s[16:19], s3 offen offset:2048 lds
buffer_load_dwordx4 v51, s[16:19], s3 offen offset:3072 lds
s_add_u32 m0, s90, 49152
s_add_u32 s3, s87, 393216
s_and_b32 s3, s3, 0x7ffff
buffer_load_dwordx4 v48, s[16:19], s3 offen offset:0 lds
buffer_load_dwordx4 v49, s[16:19], s3 offen offset:1024 lds
ds_read_b64_tr_b16 a[0:1], v56 offset:0
ds_read_b64_tr_b16 a[2:3], v56 offset:512
ds_read_b64_tr_b16 a[4:5], v57 offset:0
ds_read_b64_tr_b16 a[6:7], v57 offset:512
ds_read_b64_tr_b16 a[8:9], v58 offset:0
ds_read_b64_tr_b16 a[10:11], v58 offset:512
ds_read_b64_tr_b16 a[12:13], v59 offset:0
ds_read_b64_tr_b16 a[14:15], v59 offset:512
ds_read_b64_tr_b16 a[16:17], v56 offset:4096
ds_read_b64_tr_b16 a[18:19], v56 offset:4608
ds_read_b64_tr_b16 a[20:21], v57 offset:4096
ds_read_b64_tr_b16 a[22:23], v57 offset:4608
ds_read_b64_tr_b16 a[24:25], v58 offset:4096
ds_read_b64_tr_b16 a[26:27], v58 offset:4608
ds_read_b64_tr_b16 a[28:29], v59 offset:4096
ds_read_b64_tr_b16 a[30:31], v59 offset:4608
ds_read_b64_tr_b16 a[32:33], v56 offset:8192
ds_read_b64_tr_b16 a[34:35], v56 offset:8704
ds_read_b64_tr_b16 a[36:37], v57 offset:8192
ds_read_b64_tr_b16 a[38:39], v57 offset:8704
ds_read_b64_tr_b16 a[40:41], v58 offset:8192
ds_read_b64_tr_b16 a[42:43], v58 offset:8704
ds_read_b64_tr_b16 a[44:45], v59 offset:8192
ds_read_b64_tr_b16 a[46:47], v59 offset:8704
ds_read_b64_tr_b16 a[48:49], v56 offset:12288
ds_read_b64_tr_b16 a[50:51], v56 offset:12800
ds_read_b64_tr_b16 a[52:53], v57 offset:12288
ds_read_b64_tr_b16 a[54:55], v57 offset:12800
ds_read_b64_tr_b16 a[56:57], v58 offset:12288
ds_read_b64_tr_b16 a[58:59], v58 offset:12800
s_waitcnt vmcnt(4)
s_add_u32 s57, s61, 2162688
s_mov_b64 exec, 1
buffer_store_dwordx2 v[32:33], v10, s[44:47], s57 offen sc1
s_mov_b64 exec, -1
buffer_load_dwordx4 v50, s[16:19], s3 offen offset:2048 lds
buffer_load_dwordx4 v51, s[16:19], s3 offen offset:3072 lds
ds_read_b64_tr_b16 a[60:61], v59 offset:12288
ds_read_b64_tr_b16 a[62:63], v59 offset:12800
ds_read_b64_tr_b16 a[64:65], v56 offset:16384
ds_read_b64_tr_b16 a[66:67], v56 offset:16896
ds_read_b64_tr_b16 a[68:69], v57 offset:16384
ds_read_b64_tr_b16 a[70:71], v57 offset:16896
ds_read_b64_tr_b16 a[72:73], v58 offset:16384
ds_read_b64_tr_b16 a[74:75], v58 offset:16896
ds_read_b64_tr_b16 a[76:77], v59 offset:16384
ds_read_b64_tr_b16 a[78:79], v59 offset:16896
ds_read_b64_tr_b16 a[80:81], v56 offset:20480
ds_read_b64_tr_b16 a[82:83], v56 offset:20992
s_mov_b32 s58, 2162688
s_mov_b32 exec_hi, 0
buffer_load_dwordx2 v[200:201], v11, s[44:47], s58 offen sc1
s_mov_b64 exec, -1
s_add_u32 m0, s90, 65536
s_add_u32 s3, s89, 0
buffer_load_dwordx4 v48, s[20:23], s3 offen offset:0 lds
buffer_load_dwordx4 v49, s[20:23], s3 offen offset:1024 lds
buffer_load_dwordx4 v50, s[20:23], s3 offen offset:2048 lds
v_cvt_pk_bf16_f32 v41, v40, v42
v_lshrrev_b32 v5, 4, v0
v_lshlrev_b32 v5, 6, v5
v_lshlrev_b32 v43, 16, v41
v_sub_f32 v40, v40, v43
v_bfe_u32 v6, v0, 1, 2
v_lshl_add_u32 v5, v6, 4, v5
v_and_b32 v43, s94, v41
v_sub_f32 v42, v42, v43
v_and_b32 v6, 8, v0
v_add_u32 v5, v5, v6
v_and_b32 v6, 1, v0
v_lshl_add_u32 v5, v6, 2, v5
v_cvt_pk_bf16_f32 v40, v40, v42
v_add_u32 v5, 160256, v5
ds_write_b32 v5, v41
ds_write_b32 v5, v40 offset:1024
v_and_b32 v6, 1, v4
v_lshlrev_b32 v6, 10, v6
v_lshl_add_u32 v6, v3, 4, v6
s_cmp_eq_u32 s52, 0
s_cselect_b32 s57, 256, 0
s_add_u32 s59, s57, 160256
s_sub_u32 s57, 160256, s57
v_add_u32 v249, s59, v6
v_add_u32 v250, s57, v6
v_and_b32 v5, 1, v3
v_lshlrev_b32 v5, 5, v5
v_lshrrev_b32 v6, 1, v3
v_lshl_add_u32 v5, v6, 4, v5
v_lshl_add_u32 v252, v4, 10, v5
ds_read_b64_tr_b16 a[84:85], v57 offset:20480
ds_read_b64_tr_b16 a[86:87], v57 offset:20992
ds_read_b64_tr_b16 a[88:89], v58 offset:20480
ds_read_b64_tr_b16 a[90:91], v58 offset:20992
ds_read_b64_tr_b16 a[92:93], v59 offset:20480
ds_read_b64_tr_b16 a[94:95], v59 offset:20992
ds_read_b64_tr_b16 a[96:97], v56 offset:24576
ds_read_b64_tr_b16 a[98:99], v56 offset:25088
ds_read_b64_tr_b16 a[100:101], v57 offset:24576
ds_read_b64_tr_b16 a[102:103], v57 offset:25088
ds_read_b64_tr_b16 a[104:105], v58 offset:24576
ds_read_b64_tr_b16 a[106:107], v58 offset:25088
ds_read_b64_tr_b16 a[108:109], v59 offset:24576
ds_read_b64_tr_b16 a[110:111], v59 offset:25088
ds_read_b64_tr_b16 a[112:113], v56 offset:28672
ds_read_b64_tr_b16 a[114:115], v56 offset:29184
ds_read_b64_tr_b16 a[116:117], v57 offset:28672
ds_read_b64_tr_b16 a[118:119], v57 offset:29184
ds_read_b64_tr_b16 a[120:121], v58 offset:28672
ds_read_b64_tr_b16 a[122:123], v58 offset:29184
ds_read_b64_tr_b16 a[124:125], v59 offset:28672
ds_read_b64_tr_b16 a[126:127], v59 offset:29184
ds_read_b64_tr_b16 a[128:129], v56 offset:32768
ds_read_b64_tr_b16 a[130:131], v56 offset:33280
ds_read_b64_tr_b16 a[132:133], v57 offset:32768
ds_read_b64_tr_b16 a[134:135], v57 offset:33280
ds_read_b64_tr_b16 a[136:137], v58 offset:32768
ds_read_b64_tr_b16 a[138:139], v58 offset:33280
ds_read_b64_tr_b16 a[140:141], v59 offset:32768
ds_read_b64_tr_b16 a[142:143], v59 offset:33280
s_mov_b32 exec_hi, 0
s_waitcnt vmcnt(3)
v_cmp_ne_u32 vcc, v201, v9
s_cbranch_vccz go_30
retry_31:
s_sub_u32 s56, s56, 1
s_cbranch_scc1 L_end
buffer_load_dwordx2 v[200:201], v11, s[44:47], s58 offen sc1
s_waitcnt vmcnt(0)
v_cmp_ne_u32 vcc, v201, v9
s_cbranch_vccnz retry_31
go_30:
s_mov_b64 exec, -1
s_mov_b32 s59, 2097152
buffer_load_dwordx4 v[64:67], v12, s[44:47], s59 offen offset:0 sc1
ds_read_b64_tr_b16 a[144:145], v56 offset:36864
ds_read_b64_tr_b16 a[146:147], v56 offset:37376
buffer_load_dwordx4 v[68:71], v12, s[44:47], s59 offen offset:1024 sc1
ds_read_b64_tr_b16 a[148:149], v57 offset:36864
ds_read_b64_tr_b16 a[150:151], v57 offset:37376
buffer_load_dwordx4 v[72:75], v12, s[44:47], s59 offen offset:2048 sc1
ds_read_b64_tr_b16 a[152:153], v58 offset:36864
ds_read_b64_tr_b16 a[154:155], v58 offset:37376
buffer_load_dwordx4 v[76:79], v12, s[44:47], s59 offen offset:3072 sc1
ds_read_b64_tr_b16 a[156:157], v59 offset:36864
ds_read_b64_tr_b16 a[158:159], v59 offset:37376
s_mov_b32 s59, 2101248
buffer_load_dwordx4 v[80:83], v12, s[44:47], s59 offen offset:0 sc1
ds_read_b64_tr_b16 a[160:161], v56 offset:40960
ds_read_b64_tr_b16 a[162:163], v56 offset:41472
buffer_load_dwordx4 v[84:87], v12, s[44:47], s59 offen offset:1024 sc1
ds_read_b64_tr_b16 a[164:165], v57 offset:40960
ds_read_b64_tr_b16 a[166:167], v57 offset:41472
s_waitcnt vmcnt(5) lgkmcnt(15)
v_mfma_f32_16x16x32_bf16 v[128:131], a[0:3], v[64:67], 0
buffer_load_dwordx4 v[88:91], v12, s[44:47], s59 offen offset:2048 sc1
ds_read_b64_tr_b16 a[168:169], v58 offset:40960
v_mfma_f32_16x16x32_bf16 v[132:135], a[4:7], v[64:67], 0
ds_read_b64_tr_b16 a[170:171], v58 offset:41472
v_mfma_f32_16x16x32_bf16 v[136:139], a[8:11], v[64:67], 0
buffer_load_dwordx4 v[92:95], v12, s[44:47], s59 offen offset:3072 sc1
ds_read_b64_tr_b16 a[172:173], v59 offset:40960
v_mfma_f32_16x16x32_bf16 v[140:143], a[12:15], v[64:67], 0
ds_read_b64_tr_b16 a[174:175], v59 offset:41472
s_waitcnt vmcnt(6)
v_mfma_f32_16x16x32_bf16 v[128:131], a[16:19], v[68:71], v[128:131]
s_mov_b32 s59, 2105344
buffer_load_dwordx4 v[96:99], v12, s[44:47], s59 offen offset:0 sc1
ds_read_b64_tr_b16 a[176:177], v56 offset:45056
v_mfma_f32_16x16x32_bf16 v[132:135], a[20:23], v[68:71], v[132:135]
ds_read_b64_tr_b16 a[178:179], v56 offset:45568
v_mfma_f32_16x16x32_bf16 v[136:139], a[24:27], v[68:71], v[136:139]
buffer_load_dwordx4 v[100:103], v12, s[44:47], s59 offen offset:1024 sc1
ds_read_b64_tr_b16 a[180:181], v57 offset:45056
v_mfma_f32_16x16x32_bf16 v[140:143], a[28:31], v[68:71], v[140:143]
s_waitcnt lgkmcnt(7)
s_barrier
s_waitcnt vmcnt(7)
v_mfma_f32_16x16x32_bf16 v[128:131], a[32:35], v[72:75], v[128:131]
buffer_load_dwordx4 v[104:107], v12, s[44:47], s59 offen offset:2048 sc1
ds_read_b64_tr_b16 a[182:183], v57 offset:45568
v_mfma_f32_16x16x32_bf16 v[132:135], a[36:39], v[72:75], v[132:135]
ds_read_b64_tr_b16 a[184:185], v58 offset:45056
ds_read_b64 v[18:19], v254 offset:0
v_mfma_f32_16x16x32_bf16 v[136:139], a[40:43], v[72:75], v[136:139]
ds_read_b64_tr_b16 a[186:187], v58 offset:45568
ds_read_b64 v[22:23], v254 offset:32
v_mfma_f32_16x16x32_bf16 v[140:143], a[44:47], v[72:75], v[140:143]
ds_read_b64_tr_b16 a[188:189], v59 offset:45056
s_waitcnt vmcnt(7)
v_mfma_f32_16x16x32_bf16 v[128:131], a[48:51], v[76:79], v[128:131]
buffer_load_dwordx4 v[108:111], v12, s[44:47], s59 offen offset:3072 sc1
ds_read_b64_tr_b16 a[190:191], v59 offset:45568
v_mfma_f32_16x16x32_bf16 v[132:135], a[52:55], v[76:79], v[132:135]
ds_read_b64_tr_b16 a[192:193], v56 offset:49152
ds_read_b64 v[26:27], v254 offset:64
v_mfma_f32_16x16x32_bf16 v[136:139], a[56:59], v[76:79], v[136:139]
ds_read_b64_tr_b16 a[194:195], v56 offset:49664
ds_read_b64 v[30:31], v254 offset:96
v_mfma_f32_16x16x32_bf16 v[140:143], a[60:63], v[76:79], v[140:143]
ds_read_b64_tr_b16 a[196:197], v57 offset:49152
s_waitcnt vmcnt(7)
v_mfma_f32_16x16x32_bf16 v[128:131], a[64:67], v[80:83], v[128:131]
s_mov_b32 s59, 2109440
buffer_load_dwordx4 v[112:115], v12, s[44:47], s59 offen offset:0 sc1
ds_read_b64_tr_b16 a[198:199], v57 offset:49664
v_mfma_f32_16x16x32_bf16 v[132:135], a[68:71], v[80:83], v[132:135]
ds_read_b64_tr_b16 a[200:201], v58 offset:49152
ds_read_b128 v[144:147], v14 offset:0
v_mfma_f32_16x16x32_bf16 v[136:139], a[72:75], v[80:83], v[136:139]
ds_read_b64_tr_b16 a[202:203], v58 offset:49664
ds_read_b128 v[148:151], v14 offset:64
v_mfma_f32_16x16x32_bf16 v[140:143], a[76:79], v[80:83], v[140:143]
ds_read_b64_tr_b16 a[204:205], v59 offset:49152
s_waitcnt vmcnt(7)
v_mfma_f32_16x16x32_bf16 v[128:131], a[80:83], v[84:87], v[128:131]
buffer_load_dwordx4 v[116:119], v12, s[44:47], s59 offen offset:1024 sc1
ds_read_b64_tr_b16 a[206:207], v59 offset:49664
v_mfma_f32_16x16x32_bf16 v[132:135], a[84:87], v[84:87], v[132:135]
ds_read_b64_tr_b16 a[208:209], v56 offset:53248
ds_read_b128 v[152:155], v14 offset:128
v_mfma_f32_16x16x32_bf16 v[136:139], a[88:91], v[84:87], v[136:139]
ds_read_b64_tr_b16 a[210:211], v56 offset:53760
ds_read_b128 v[156:159], v14 offset:192
v_mfma_f32_16x16x32_bf16 v[140:143], a[92:95], v[84:87], v[140:143]
ds_read_b64_tr_b16 a[212:213], v57 offset:53248
s_waitcnt vmcnt(7)
v_mfma_f32_16x16x32_bf16 v[128:131], a[96:99], v[88:91], v[128:131]
buffer_load_dwordx4 v[120:123], v12, s[44:47], s59 offen offset:2048 sc1
ds_read_b64_tr_b16 a[214:215], v57 offset:53760
v_mfma_f32_16x16x32_bf16 v[132:135], a[100:103], v[88:91], v[132:135]
ds_read_b64_tr_b16 a[216:217], v58 offset:53248
ds_read_b128 v[160:163], v14 offset:512
v_mfma_f32_16x16x32_bf16 v[136:139], a[104:107], v[88:91], v[136:139]
ds_read_b64_tr_b16 a[218:219], v58 offset:53760
ds_read_b128 v[164:167], v14 offset:576
v_mfma_f32_16x16x32_bf16 v[140:143], a[108:111], v[88:91], v[140:143]
ds_read_b64_tr_b16 a[220:221], v59 offset:53248
s_waitcnt vmcnt(7)
v_mfma_f32_16x16x32_bf16 v[128:131], a[112:115], v[92:95], v[128:131]
buffer_load_dwordx4 v[124:127], v12, s[44:47], s59 offen offset:3072 sc1
ds_read_b64_tr_b16 a[222:223], v59 offset:53760
v_mfma_f32_16x16x32_bf16 v[132:135], a[116:119], v[92:95], v[132:135]
ds_read_b64_tr_b16 a[224:225], v56 offset:57344
ds_read_b128 v[168:171], v14 offset:640
v_mfma_f32_16x16x32_bf16 v[136:139], a[120:123], v[92:95], v[136:139]
ds_read_b64_tr_b16 a[226:227], v56 offset:57856
ds_read_b128 v[172:175], v14 offset:704
v_mfma_f32_16x16x32_bf16 v[140:143], a[124:127], v[92:95], v[140:143]
ds_read_b64_tr_b16 a[228:229], v57 offset:57344
s_waitcnt vmcnt(7)
v_mfma_f32_16x16x32_bf16 v[128:131], a[128:131], v[96:99], v[128:131]
buffer_load_dword v251, v235, s[20:23], 0 offen offset:384
buffer_load_dwordx4 v51, s[20:23], s3 offen offset:3072 lds
ds_read_b64_tr_b16 a[230:231], v57 offset:57856
v_mfma_f32_16x16x32_bf16 v[132:135], a[132:135], v[96:99], v[132:135]
ds_read_b64_tr_b16 a[232:233], v58 offset:57344
s_waitcnt lgkmcnt(15)
v_lshlrev_b32 v16, 16, v18
v_mfma_f32_16x16x32_bf16 v[136:139], a[136:139], v[96:99], v[136:139]
ds_read_b64_tr_b16 a[234:235], v58 offset:57856
v_and_b32 v17, s94, v18
v_mfma_f32_16x16x32_bf16 v[140:143], a[140:143], v[96:99], v[140:143]
ds_read_b64_tr_b16 a[236:237], v59 offset:57344
s_waitcnt vmcnt(8)
v_mfma_f32_16x16x32_bf16 v[128:131], a[144:147], v[100:103], v[128:131]
s_add_u32 m0, s90, 81920
s_add_u32 s3, s89, 131072
buffer_load_dwordx4 v48, s[20:23], s3 offen offset:0 lds
ds_read_b64_tr_b16 a[238:239], v59 offset:57856
v_mfma_f32_16x16x32_bf16 v[132:135], a[148:151], v[100:103], v[132:135]
ds_read_b64_tr_b16 a[240:241], v56 offset:61440
v_lshlrev_b32 v18, 16, v19
v_mfma_f32_16x16x32_bf16 v[136:139], a[152:155], v[100:103], v[136:139]
ds_read_b64_tr_b16 a[242:243], v56 offset:61952
v_and_b32 v19, s94, v19
v_mfma_f32_16x16x32_bf16 v[140:143], a[156:159], v[100:103], v[140:143]
ds_read_b64_tr_b16 a[244:245], v57 offset:61440
s_waitcnt vmcnt(8)
v_mfma_f32_16x16x32_bf16 v[128:131], a[160:163], v[104:107], v[128:131]
buffer_load_dwordx4 v49, s[20:23], s3 offen offset:1024 lds
ds_read_b64_tr_b16 a[246:247], v57 offset:61952
v_mfma_f32_16x16x32_bf16 v[132:135], a[164:167], v[104:107], v[132:135]
ds_read_b64_tr_b16 a[248:249], v58 offset:61440
v_lshlrev_b32 v20, 16, v22
v_mfma_f32_16x16x32_bf16 v[136:139], a[168:171], v[104:107], v[136:139]
ds_read_b64_tr_b16 a[250:251], v58 offset:61952
v_and_b32 v21, s94, v22
v_mfma_f32_16x16x32_bf16 v[140:143], a[172:175], v[104:107], v[140:143]
ds_read_b64_tr_b16 a[252:253], v59 offset:61440
s_waitcnt vmcnt(8)
v_mfma_f32_16x16x32_bf16 v[128:131], a[176:179], v[108:111], v[128:131]
buffer_load_dwordx4 v50, s[20:23], s3 offen offset:2048 lds
ds_read_b64_tr_b16 a[254:255], v59 offset:61952
v_mfma_f32_16x16x32_bf16 v[132:135], a[180:183], v[108:111], v[132:135]
ds_read_b64_tr_b16 a[0:1], v236 offset:0
v_lshlrev_b32 v22, 16, v23
v_mfma_f32_16x16x32_bf16 v[136:139], a[184:187], v[108:111], v[136:139]
ds_read_b64_tr_b16 a[2:3], v236 offset:2048
v_and_b32 v23, s94, v23
v_mfma_f32_16x16x32_bf16 v[140:143], a[188:191], v[108:111], v[140:143]
ds_read_b64_tr_b16 a[4:5], v237 offset:0
s_waitcnt vmcnt(8)
v_mfma_f32_16x16x32_bf16 v[128:131], a[192:195], v[112:115], v[128:131]
buffer_load_dwordx4 v51, s[20:23], s3 offen offset:3072 lds
ds_read_b64_tr_b16 a[6:7], v237 offset:2048
v_mfma_f32_16x16x32_bf16 v[132:135], a[196:199], v[112:115], v[132:135]
ds_read_b64_tr_b16 a[8:9], v238 offset:0
v_lshlrev_b32 v24, 16, v26
v_mfma_f32_16x16x32_bf16 v[136:139], a[200:203], v[112:115], v[136:139]
ds_read_b64_tr_b16 a[10:11], v238 offset:2048
v_and_b32 v25, s94, v26
v_mfma_f32_16x16x32_bf16 v[140:143], a[204:207], v[112:115], v[140:143]
ds_read_b64_tr_b16 a[12:13], v239 offset:0
s_waitcnt vmcnt(8) lgkmcnt(15)
v_mfma_f32_16x16x32_bf16 v[128:131], a[208:211], v[116:119], v[128:131]
s_add_u32 m0, s90, 98304
s_add_u32 s3, s89, 262144
buffer_load_dwordx4 v48, s[20:23], s3 offen offset:0 lds
ds_read_b64_tr_b16 a[14:15], v239 offset:2048
v_mfma_f32_16x16x32_bf16 v[132:135], a[212:215], v[116:119], v[132:135]
ds_read_b64_tr_b16 a[16:17], v236 offset:4096
v_lshlrev_b32 v26, 16, v27
v_mfma_f32_16x16x32_bf16 v[136:139], a[216:219], v[116:119], v[136:139]
ds_read_b64_tr_b16 a[18:19], v236 offset:6144
v_and_b32 v27, s94, v27
v_mfma_f32_16x16x32_bf16 v[140:143], a[220:223], v[116:119], v[140:143]
ds_read_b64_tr_b16 a[20:21], v237 offset:4096
s_waitcnt vmcnt(8)
v_mfma_f32_16x16x32_bf16 v[128:131], a[224:227], v[120:123], v[128:131]
buffer_load_dwordx4 v49, s[20:23], s3 offen offset:1024 lds
ds_read_b64_tr_b16 a[22:23], v237 offset:6144
v_mfma_f32_16x16x32_bf16 v[132:135], a[228:231], v[120:123], v[132:135]
ds_read_b64_tr_b16 a[24:25], v238 offset:4096
v_lshlrev_b32 v28, 16, v30
v_mfma_f32_16x16x32_bf16 v[136:139], a[232:235], v[120:123], v[136:139]
ds_read_b64_tr_b16 a[26:27], v238 offset:6144
v_and_b32 v29, s94, v30
v_mfma_f32_16x16x32_bf16 v[140:143], a[236:239], v[120:123], v[140:143]
ds_read_b64_tr_b16 a[28:29], v239 offset:4096
s_waitcnt vmcnt(8) lgkmcnt(15)
v_mfma_f32_16x16x32_bf16 v[128:131], a[240:243], v[124:127], v[128:131]
buffer_load_dwordx4 v50, s[20:23], s3 offen offset:2048 lds
ds_read_b64_tr_b16 a[30:31], v239 offset:6144
v_mfma_f32_16x16x32_bf16 v[132:135], a[244:247], v[124:127], v[132:135]
ds_read_b64_tr_b16 a[32:33], v236 offset:8192
v_lshlrev_b32 v30, 16, v31
v_mfma_f32_16x16x32_bf16 v[136:139], a[248:251], v[124:127], v[136:139]
ds_read_b64_tr_b16 a[34:35], v236 offset:10240
v_and_b32 v31, s94, v31
v_mfma_f32_16x16x32_bf16 v[140:143], a[252:255], v[124:127], v[140:143]
ds_read_b64_tr_b16 a[36:37], v237 offset:8192
s_waitcnt lgkmcnt(0)
s_barrier
v_pk_fma_f32 v[16:17], v[128:129], v[144:145], v[16:17]
v_pk_fma_f32 v[18:19], v[130:131], v[146:147], v[18:19]
v_pk_fma_f32 v[20:21], v[132:133], v[148:149], v[20:21]
v_pk_fma_f32 v[22:23], v[134:135], v[150:151], v[22:23]
v_pk_fma_f32 v[24:25], v[136:137], v[152:153], v[24:25]
v_pk_fma_f32 v[26:27], v[138:139], v[154:155], v[26:27]
v_pk_fma_f32 v[28:29], v[140:141], v[156:157], v[28:29]
v_pk_fma_f32 v[30:31], v[142:143], v[158:159], v[30:31]
v_pk_add_f32 v[224:225], v[16:17], v[18:19]
v_pk_add_f32 v[224:225], v[224:225], v[20:21]
v_pk_add_f32 v[224:225], v[224:225], v[22:23]
v_pk_add_f32 v[224:225], v[224:225], v[24:25]
v_pk_add_f32 v[224:225], v[224:225], v[26:27]
v_pk_add_f32 v[224:225], v[224:225], v[28:29]
v_pk_add_f32 v[224:225], v[224:225], v[30:31]
v_add_f32 v204, v224, v225
v_pk_mul_f32 v[226:227], v[16:17], v[16:17]
v_pk_fma_f32 v[226:227], v[18:19], v[18:19], v[226:227]
v_pk_fma_f32 v[226:227], v[20:21], v[20:21], v[226:227]
v_pk_fma_f32 v[226:227], v[22:23], v[22:23], v[226:227]
v_pk_fma_f32 v[226:227], v[24:25], v[24:25], v[226:227]
v_pk_fma_f32 v[226:227], v[26:27], v[26:27], v[226:227]
v_pk_fma_f32 v[226:227], v[28:29], v[28:29], v[226:227]
v_pk_fma_f32 v[226:227], v[30:31], v[30:31], v[226:227]
v_add_f32 v205, v226, v227
v_pk_mul_f32 v[228:229], v[16:17], v[160:161]
v_pk_fma_f32 v[228:229], v[18:19], v[162:163], v[228:229]
v_pk_fma_f32 v[228:229], v[20:21], v[164:165], v[228:229]
v_pk_fma_f32 v[228:229], v[22:23], v[166:167], v[228:229]
v_pk_fma_f32 v[228:229], v[24:25], v[168:169], v[228:229]
v_pk_fma_f32 v[228:229], v[26:27], v[170:171], v[228:229]
v_pk_fma_f32 v[228:229], v[28:29], v[172:173], v[228:229]
v_pk_fma_f32 v[228:229], v[30:31], v[174:175], v[228:229]
v_add_f32 v206, v228, v229
v_mov_b32 v207, v9
s_lshr_b32 s57, s62, 3
s_add_u32 s57, s57, 2157568
s_mov_b32 s58, 2157568
v_mov_b32 v208, v204
v_mov_b32 v209, v205
v_mov_b32 v210, v206
v_permlane32_swap_b32 v204, v208
v_permlane32_swap_b32 v205, v209
v_permlane32_swap_b32 v206, v210
v_add_f32 v204, v204, v208
v_add_f32 v205, v205, v209
v_add_f32 v206, v206, v210
v_mov_b32 v208, v204
v_mov_b32 v209, v205
v_mov_b32 v210, v206
v_permlane16_swap_b32 v204, v208
v_permlane16_swap_b32 v205, v209
v_permlane16_swap_b32 v206, v210
v_add_f32 v204, v204, v208
v_add_f32 v205, v205, v209
v_add_f32 v206, v206, v210
s_mov_b64 exec, 0xffff
buffer_store_dwordx4 v[204:207], v12, s[44:47], s57 offen sc1
s_mov_b64 exec, -1
buffer_load_dwordx4 v51, s[20:23], s3 offen offset:3072 lds
s_add_u32 m0, s90, 114688
s_add_u32 s3, s89, 393216
buffer_load_dwordx4 v48, s[20:23], s3 offen offset:0 lds
ds_read_b64_tr_b16 a[38:39], v237 offset:10240
ds_read_b64_tr_b16 a[40:41], v238 offset:8192
ds_read_b64_tr_b16 a[42:43], v238 offset:10240
ds_read_b64_tr_b16 a[44:45], v239 offset:8192
ds_read_b64_tr_b16 a[46:47], v239 offset:10240
ds_read_b64_tr_b16 a[48:49], v236 offset:12288
ds_read_b64_tr_b16 a[50:51], v236 offset:14336
ds_read_b64_tr_b16 a[52:53], v237 offset:12288
ds_read_b64_tr_b16 a[54:55], v237 offset:14336
ds_read_b64_tr_b16 a[56:57], v238 offset:12288
ds_read_b64_tr_b16 a[58:59], v238 offset:14336
ds_read_b64_tr_b16 a[60:61], v239 offset:12288
ds_read_b64_tr_b16 a[62:63], v239 offset:14336
ds_read_b64_tr_b16 a[64:65], v236 offset:16384
ds_read_b64_tr_b16 a[66:67], v236 offset:18432
ds_read_b64_tr_b16 a[68:69], v237 offset:16384
buffer_load_dwordx4 v[212:215], v12, s[44:47], s58 offen sc1
buffer_load_dwordx4 v[216:219], v12, s[44:47], s58 offen offset:1024 sc1
buffer_load_dwordx4 v49, s[20:23], s3 offen offset:1024 lds
buffer_load_dwordx4 v50, s[20:23], s3 offen offset:2048 lds
buffer_load_dwordx4 v51, s[20:23], s3 offen offset:3072 lds
s_add_u32 m0, s86, 131072
s_mul_i32 s3, s50, 176128
buffer_load_dwordx4 v60, s[24:27], s3 offen offset:0 lds
s_add_u32 m0, m0, 3968
ds_read_b128 v[176:179], v14 offset:256
ds_read_b128 v[180:183], v14 offset:320
ds_read_b128 v[184:187], v14 offset:384
ds_read_b128 v[188:191], v14 offset:448
v_add_f32_dpp v200, v200, v200 row_ror:4 row_mask:0xf bank_mask:0xf
ds_read_b64_tr_b16 a[70:71], v237 offset:18432
ds_read_b64_tr_b16 a[72:73], v238 offset:16384
v_add_f32_dpp v200, v200, v200 row_ror:8 row_mask:0xf bank_mask:0xf
v_mov_b32 v201, v200
ds_read_b64_tr_b16 a[74:75], v238 offset:18432
ds_read_b64_tr_b16 a[76:77], v239 offset:16384
v_permlane16_swap_b32 v200, v201
v_add_f32 v200, v200, v201
v_mul_f32 v200, s91, v200
ds_read_b64_tr_b16 a[78:79], v239 offset:18432
v_readlane_b32 s93, v200, 1
v_readlane_b32 s92, v200, 2
ds_read_b64_tr_b16 a[80:81], v236 offset:20480
ds_read_b64_tr_b16 a[82:83], v236 offset:22528
ds_read_b64_tr_b16 a[84:85], v237 offset:20480
ds_read_b64_tr_b16 a[86:87], v237 offset:22528
ds_read_b64_tr_b16 a[88:89], v238 offset:20480
ds_read_b64_tr_b16 a[90:91], v238 offset:22528
ds_read_b64_tr_b16 a[92:93], v239 offset:20480
ds_read_b64_tr_b16 a[94:95], v239 offset:22528
ds_read_b64_tr_b16 a[96:97], v236 offset:24576
ds_read_b64_tr_b16 a[98:99], v236 offset:26624
ds_read_b64_tr_b16 a[100:101], v237 offset:24576
ds_read_b64_tr_b16 a[102:103], v237 offset:26624
s_waitcnt vmcnt(4)
v_xor_b32 v211, v215, v9
v_bitop3_b32 v211, v211, v219, v9 bitop3:0xf6
v_cmp_ne_u32 vcc, 0, v211
s_cbranch_vccz go_32
retry_33:
s_sub_u32 s56, s56, 1
s_cbranch_scc1 L_end
buffer_load_dwordx4 v[212:215], v12, s[44:47], s58 offen sc1
buffer_load_dwordx4 v[216:219], v12, s[44:47], s58 offen offset:1024 sc1
s_waitcnt vmcnt(0)
v_xor_b32 v211, v215, v9
v_bitop3_b32 v211, v211, v219, v9 bitop3:0xf6
v_cmp_ne_u32 vcc, 0, v211
s_cbranch_vccnz retry_33
go_32:
v_add_f32 v204, v212, v216
v_add_f32 v205, v213, v217
v_add_f32 v206, v214, v218
v_mov_b32 v208, v204
v_mov_b32 v209, v205
v_mov_b32 v210, v206
v_permlane32_swap_b32 v204, v208
v_permlane32_swap_b32 v205, v209
v_permlane32_swap_b32 v206, v210
v_add_f32 v204, v204, v208
v_add_f32 v205, v205, v209
v_add_f32 v206, v206, v210
v_mov_b32 v208, v204
v_mov_b32 v209, v205
v_mov_b32 v210, v206
v_permlane16_swap_b32 v204, v208
v_permlane16_swap_b32 v205, v209
v_permlane16_swap_b32 v206, v210
v_add_f32 v204, v204, v208
v_add_f32 v205, v205, v209
v_add_f32 v206, v206, v210
s_waitcnt lgkmcnt(0)
v_mov_b32 v208, 0x3727c5ac
v_mul_f32 v204, s91, v204
v_mul_f32 v206, s91, v206
v_fma_f32 v208, -v204, v204, v208
v_fma_f32 v208, v205, s91, v208
v_rsq_f32 v208, v208
v_fma_f32 v206, -v204, s92, v206
v_mul_f32_e64 v209, -v204, v208
v_fma_f32 v210, v206, v208, s93
v_pk_fma_f32 v[32:33], v[16:17], v[208:209], v[208:209] op_sel:[0,0,1] op_sel_hi:[1,0,1]
v_pk_fma_f32 v[34:35], v[18:19], v[208:209], v[208:209] op_sel:[0,0,1] op_sel_hi:[1,0,1]
v_pk_fma_f32 v[36:37], v[20:21], v[208:209], v[208:209] op_sel:[0,0,1] op_sel_hi:[1,0,1]
v_pk_fma_f32 v[38:39], v[22:23], v[208:209], v[208:209] op_sel:[0,0,1] op_sel_hi:[1,0,1]
v_pk_fma_f32 v[40:41], v[24:25], v[208:209], v[208:209] op_sel:[0,0,1] op_sel_hi:[1,0,1]
v_pk_fma_f32 v[42:43], v[26:27], v[208:209], v[208:209] op_sel:[0,0,1] op_sel_hi:[1,0,1]
v_pk_fma_f32 v[44:45], v[28:29], v[208:209], v[208:209] op_sel:[0,0,1] op_sel_hi:[1,0,1]
v_pk_fma_f32 v[46:47], v[30:31], v[208:209], v[208:209] op_sel:[0,0,1] op_sel_hi:[1,0,1]
v_pk_fma_f32 v[32:33], v[32:33], v[160:161], v[176:177]
v_pk_fma_f32 v[34:35], v[34:35], v[162:163], v[178:179]
v_pk_fma_f32 v[36:37], v[36:37], v[164:165], v[180:181]
v_pk_fma_f32 v[38:39], v[38:39], v[166:167], v[182:183]
v_pk_fma_f32 v[40:41], v[40:41], v[168:169], v[184:185]
v_pk_fma_f32 v[42:43], v[42:43], v[170:171], v[186:187]
v_pk_fma_f32 v[44:45], v[44:45], v[172:173], v[188:189]
v_pk_fma_f32 v[46:47], v[46:47], v[174:175], v[190:191]
v_pk_add_f32 v[144:145], v[32:33], v[210:211] op_sel:[0,0] op_sel_hi:[1,0] neg_lo:[0,1] neg_hi:[0,1]
v_pk_add_f32 v[146:147], v[34:35], v[210:211] op_sel:[0,0] op_sel_hi:[1,0] neg_lo:[0,1] neg_hi:[0,1]
v_pk_add_f32 v[148:149], v[36:37], v[210:211] op_sel:[0,0] op_sel_hi:[1,0] neg_lo:[0,1] neg_hi:[0,1]
v_pk_add_f32 v[150:151], v[38:39], v[210:211] op_sel:[0,0] op_sel_hi:[1,0] neg_lo:[0,1] neg_hi:[0,1]
v_pk_add_f32 v[152:153], v[40:41], v[210:211] op_sel:[0,0] op_sel_hi:[1,0] neg_lo:[0,1] neg_hi:[0,1]
v_pk_add_f32 v[154:155], v[42:43], v[210:211] op_sel:[0,0] op_sel_hi:[1,0] neg_lo:[0,1] neg_hi:[0,1]
v_pk_add_f32 v[156:157], v[44:45], v[210:211] op_sel:[0,0] op_sel_hi:[1,0] neg_lo:[0,1] neg_hi:[0,1]
v_pk_add_f32 v[158:159], v[46:47], v[210:211] op_sel:[0,0] op_sel_hi:[1,0] neg_lo:[0,1] neg_hi:[0,1]
v_cvt_pk_bf16_f32 v64, v144, v145
v_cvt_pk_bf16_f32 v65, v146, v147
v_cvt_pk_bf16_f32 v66, v148, v149
v_cvt_pk_bf16_f32 v67, v150, v151
v_cvt_pk_bf16_f32 v68, v152, v153
v_cvt_pk_bf16_f32 v69, v154, v155
v_cvt_pk_bf16_f32 v70, v156, v157
v_cvt_pk_bf16_f32 v71, v158, v159
s_add_u32 s57, s62, 2097152
buffer_store_dwordx4 v[64:67], v12, s[44:47], s57 offen sc1
buffer_store_dwordx4 v[68:71], v12, s[44:47], s57 offen offset:1024 sc1
v_mov_b32 v248, v210
v_pk_mul_f32 v[224:225], v[144:145], v[144:145]
v_pk_fma_f32 v[224:225], v[146:147], v[146:147], v[224:225]
v_pk_fma_f32 v[224:225], v[148:149], v[148:149], v[224:225]
v_pk_fma_f32 v[224:225], v[150:151], v[150:151], v[224:225]
v_pk_fma_f32 v[224:225], v[152:153], v[152:153], v[224:225]
v_pk_fma_f32 v[224:225], v[154:155], v[154:155], v[224:225]
v_pk_fma_f32 v[224:225], v[156:157], v[156:157], v[224:225]
v_pk_fma_f32 v[224:225], v[158:159], v[158:159], v[224:225]
v_add_f32 v204, v224, v225
v_mov_b32 v206, v204
s_nop 1
v_permlane32_swap_b32 v204, v206
v_add_f32 v204, v204, v206
v_mov_b32 v206, v204
s_nop 1
v_permlane16_swap_b32 v204, v206
v_add_f32 v204, v204, v206
v_mov_b32 v205, v9
buffer_load_dwordx4 v60, s[24:27], s3 offen offset:128 lds
s_add_u32 m0, m0, 4224
s_nop 0
buffer_load_dwordx4 v61, s[24:27], s3 offen offset:0 lds
s_add_u32 m0, s86, 143360
s_add_u32 s3, s3, 88064
buffer_load_dwordx4 v60, s[24:27], s3 offen offset:0 lds
s_add_u32 m0, m0, 3968
s_nop 0
buffer_load_dwordx4 v60, s[24:27], s3 offen offset:128 lds
s_add_u32 m0, m0, 4224
ds_read_b64_tr_b16 a[104:105], v238 offset:24576
ds_read_b64_tr_b16 a[106:107], v238 offset:26624
ds_read_b64_tr_b16 a[108:109], v239 offset:24576
ds_read_b64_tr_b16 a[110:111], v239 offset:26624
ds_read_b64_tr_b16 a[112:113], v236 offset:28672
ds_read_b64_tr_b16 a[114:115], v236 offset:30720
ds_read_b64_tr_b16 a[116:117], v237 offset:28672
ds_read_b64_tr_b16 a[118:119], v237 offset:30720
ds_read_b64_tr_b16 a[120:121], v238 offset:28672
ds_read_b64_tr_b16 a[122:123], v238 offset:30720
ds_read_b64_tr_b16 a[124:125], v239 offset:28672
ds_read_b64_tr_b16 a[126:127], v239 offset:30720
ds_read_b64_tr_b16 a[128:129], v236 offset:32768
ds_read_b64_tr_b16 a[130:131], v236 offset:34816
ds_read_b64_tr_b16 a[132:133], v237 offset:32768
ds_read_b64_tr_b16 a[134:135], v237 offset:34816
ds_read_b64_tr_b16 a[136:137], v238 offset:32768
ds_read_b64_tr_b16 a[138:139], v238 offset:34816
ds_read_b64_tr_b16 a[140:141], v239 offset:32768
ds_read_b64_tr_b16 a[142:143], v239 offset:34816
s_waitcnt vmcnt(4)
s_mov_b64 exec, 0xffff
buffer_store_dwordx2 v[204:205], v12, s[44:47], s38 offen sc1
s_mov_b64 exec, -1
buffer_load_dwordx4 v61, s[24:27], s3 offen offset:0 lds
ds_read_b64_tr_b16 a[144:145], v236 offset:36864
ds_read_b64_tr_b16 a[146:147], v236 offset:38912
ds_read_b64_tr_b16 a[148:149], v237 offset:36864
ds_read_b64_tr_b16 a[150:151], v237 offset:38912
ds_read_b64_tr_b16 a[152:153], v238 offset:36864
ds_read_b64_tr_b16 a[154:155], v238 offset:38912
ds_read_b64_tr_b16 a[156:157], v239 offset:36864
ds_read_b64_tr_b16 a[158:159], v239 offset:38912
ds_read_b64_tr_b16 a[160:161], v236 offset:40960
ds_read_b64_tr_b16 a[162:163], v236 offset:43008
ds_read_b64_tr_b16 a[164:165], v237 offset:40960
ds_read_b64_tr_b16 a[166:167], v237 offset:43008
ds_read_b64_tr_b16 a[168:169], v238 offset:40960
ds_read_b64_tr_b16 a[170:171], v238 offset:43008
ds_read_b64_tr_b16 a[172:173], v239 offset:40960
ds_read_b64_tr_b16 a[174:175], v239 offset:43008
ds_read_b64_tr_b16 a[176:177], v236 offset:45056
ds_read_b64_tr_b16 a[178:179], v236 offset:47104
s_mov_b32 s58, 2161664
buffer_load_dwordx4 v[200:203], v12, s[44:47], s58 offen sc1
s_cmp_eq_u32 s52, 0
s_cselect_b32 s72, 16384, 0
s_add_u32 s73, s72, 65536
s_sub_u32 s72, 65536, s72
v_add_u32 v56, s73, v236
v_add_u32 v57, s73, v237
v_add_u32 v58, s73, v238
v_add_u32 v59, s73, v239
v_add_u32 v52, s72, v236
v_add_u32 v53, s72, v237
v_add_u32 v54, s72, v238
v_add_u32 v55, s72, v239
ds_read_b64_tr_b16 a[180:181], v237 offset:45056
ds_read_b64_tr_b16 a[182:183], v237 offset:47104
ds_read_b64_tr_b16 a[184:185], v238 offset:45056
ds_read_b64_tr_b16 a[186:187], v238 offset:47104
ds_read_b64_tr_b16 a[188:189], v239 offset:45056
ds_read_b64_tr_b16 a[190:191], v239 offset:47104
ds_read_b64_tr_b16 a[192:193], v236 offset:49152
ds_read_b64_tr_b16 a[194:195], v236 offset:51200
ds_read_b64_tr_b16 a[196:197], v237 offset:49152
ds_read_b64_tr_b16 a[198:199], v237 offset:51200
ds_read_b64_tr_b16 a[200:201], v238 offset:49152
ds_read_b64_tr_b16 a[202:203], v238 offset:51200
ds_read_b64_tr_b16 a[204:205], v239 offset:49152
ds_read_b64_tr_b16 a[206:207], v239 offset:51200
ds_read_b64_tr_b16 a[208:209], v236 offset:53248
ds_read_b64_tr_b16 a[210:211], v236 offset:55296
ds_read_b64_tr_b16 a[212:213], v237 offset:53248
ds_read_b64_tr_b16 a[214:215], v237 offset:55296
ds_read_b64_tr_b16 a[216:217], v238 offset:53248
ds_read_b64_tr_b16 a[218:219], v238 offset:55296
ds_read_b64_tr_b16 a[220:221], v239 offset:53248
ds_read_b64_tr_b16 a[222:223], v239 offset:55296
ds_read_b64_tr_b16 a[224:225], v236 offset:57344
ds_read_b64_tr_b16 a[226:227], v236 offset:59392
s_waitcnt vmcnt(0)
v_xor_b32 v5, v201, v9
v_bitop3_b32 v5, v5, v203, v9 bitop3:0xf6
v_cmp_ne_u32 vcc, 0, v5
s_cbranch_vccz go_34
retry_35:
s_sub_u32 s56, s56, 1
s_cbranch_scc1 L_end
buffer_load_dwordx4 v[200:203], v12, s[44:47], s58 offen sc1
s_waitcnt vmcnt(0)
v_xor_b32 v5, v201, v9
v_bitop3_b32 v5, v5, v203, v9 bitop3:0xf6
v_cmp_ne_u32 vcc, 0, v5
s_cbranch_vccnz retry_35
go_34:
v_add_u32 v7, 2097152, v12
s_add_u32 s59, s62, 2048
s_and_b32 s59, s59, 0x3fff
buffer_load_dwordx4 v[72:75], v7, s[44:47], s59 offen offset:0 sc1
buffer_load_dwordx4 v[76:79], v7, s[44:47], s59 offen offset:1024 sc1
s_add_u32 s59, s59, 2048
s_and_b32 s59, s59, 0x3fff
buffer_load_dwordx4 v[80:83], v7, s[44:47], s59 offen offset:0 sc1
buffer_load_dwordx4 v[84:87], v7, s[44:47], s59 offen offset:1024 sc1
s_add_u32 s59, s59, 2048
s_and_b32 s59, s59, 0x3fff
buffer_load_dwordx4 v[88:91], v7, s[44:47], s59 offen offset:0 sc1
buffer_load_dwordx4 v[92:95], v7, s[44:47], s59 offen offset:1024 sc1
v_mfma_f32_16x16x32_bf16 v[128:131], a[0:3], v[64:67], 0
s_add_u32 s59, s59, 2048
s_and_b32 s59, s59, 0x3fff
buffer_load_dwordx4 v[96:99], v7, s[44:47], s59 offen offset:0 sc1
ds_read_b64_tr_b16 a[228:229], v237 offset:57344
v_mfma_f32_16x16x32_bf16 v[132:135], a[4:7], v[64:67], 0
ds_read_b64_tr_b16 a[230:231], v237 offset:59392
s_lshr_b32 s72, s50, 2
v_mfma_f32_16x16x32_bf16 v[136:139], a[8:11], v[64:67], 0
buffer_load_dwordx4 v[100:103], v7, s[44:47], s59 offen offset:1024 sc1
ds_read_b64_tr_b16 a[232:233], v238 offset:57344
v_mfma_f32_16x16x32_bf16 v[140:143], a[12:15], v[64:67], 0
ds_read_b64_tr_b16 a[234:235], v238 offset:59392
v_mfma_f32_16x16x32_bf16 v[128:131], a[16:19], v[68:71], v[128:131]
s_add_u32 s59, s59, 2048
s_and_b32 s59, s59, 0x3fff
buffer_load_dwordx4 v[104:107], v7, s[44:47], s59 offen offset:0 sc1
ds_read_b64_tr_b16 a[236:237], v239 offset:57344
v_mfma_f32_16x16x32_bf16 v[132:135], a[20:23], v[68:71], v[132:135]
ds_read_b64_tr_b16 a[238:239], v239 offset:59392
s_add_u32 s72, s72, 1
v_mfma_f32_16x16x32_bf16 v[136:139], a[24:27], v[68:71], v[136:139]
buffer_load_dwordx4 v[108:111], v7, s[44:47], s59 offen offset:1024 sc1
ds_read_b64_tr_b16 a[240:241], v240 offset:0
v_mfma_f32_16x16x32_bf16 v[140:143], a[28:31], v[68:71], v[140:143]
s_waitcnt lgkmcnt(7)
s_barrier
s_waitcnt vmcnt(9)
v_mfma_f32_16x16x32_bf16 v[128:131], a[32:35], v[72:75], v[128:131]
s_add_u32 s59, s59, 2048
s_and_b32 s59, s59, 0x3fff
buffer_load_dwordx4 v[112:115], v7, s[44:47], s59 offen offset:0 sc1
ds_read_b64_tr_b16 a[242:243], v240 offset:2048
v_mfma_f32_16x16x32_bf16 v[132:135], a[36:39], v[72:75], v[132:135]
ds_read_b64_tr_b16 a[244:245], v241 offset:0
s_sub_u32 s73, 0, s72
v_mfma_f32_16x16x32_bf16 v[136:139], a[40:43], v[72:75], v[136:139]
ds_read_b64_tr_b16 a[246:247], v241 offset:2048
s_bitcmp1_b32 s50, 1
s_cselect_b32 s72, s73, s72
v_mfma_f32_16x16x32_bf16 v[140:143], a[44:47], v[72:75], v[140:143]
ds_read_b64_tr_b16 a[248:249], v242 offset:0
s_waitcnt vmcnt(9)
v_mfma_f32_16x16x32_bf16 v[128:131], a[48:51], v[76:79], v[128:131]
buffer_load_dwordx4 v[116:119], v7, s[44:47], s59 offen offset:1024 sc1
ds_read_b64_tr_b16 a[250:251], v242 offset:2048
v_mfma_f32_16x16x32_bf16 v[132:135], a[52:55], v[76:79], v[132:135]
ds_read_b64_tr_b16 a[252:253], v243 offset:0
v_add_u32 v5, s72, v4
v_mfma_f32_16x16x32_bf16 v[136:139], a[56:59], v[76:79], v[136:139]
ds_read_b64_tr_b16 a[254:255], v243 offset:2048
v_ashrrev_i32 v5, 4, v5
v_mfma_f32_16x16x32_bf16 v[140:143], a[60:63], v[76:79], v[140:143]
ds_read_b64_tr_b16 a[0:1], v56 offset:0
s_waitcnt vmcnt(9)
v_mfma_f32_16x16x32_bf16 v[128:131], a[64:67], v[80:83], v[128:131]
s_add_u32 s59, s59, 2048
s_and_b32 s59, s59, 0x3fff
buffer_load_dwordx4 v[120:123], v7, s[44:47], s59 offen offset:0 sc1
ds_read_b64_tr_b16 a[2:3], v56 offset:2048
v_mfma_f32_16x16x32_bf16 v[132:135], a[68:71], v[80:83], v[132:135]
ds_read_b64_tr_b16 a[4:5], v57 offset:0
s_lshl_b32 s72, s72, 4
v_mfma_f32_16x16x32_bf16 v[136:139], a[72:75], v[80:83], v[136:139]
ds_read_b64_tr_b16 a[6:7], v57 offset:2048
s_add_u32 s72, s72, 66560
v_mfma_f32_16x16x32_bf16 v[140:143], a[76:79], v[80:83], v[140:143]
ds_read_b64_tr_b16 a[8:9], v58 offset:0
s_waitcnt vmcnt(9)
v_mfma_f32_16x16x32_bf16 v[128:131], a[80:83], v[84:87], v[128:131]
buffer_load_dwordx4 v[124:127], v7, s[44:47], s59 offen offset:1024 sc1
ds_read_b64_tr_b16 a[10:11], v58 offset:2048
v_mfma_f32_16x16x32_bf16 v[132:135], a[84:87], v[84:87], v[132:135]
ds_read_b64_tr_b16 a[12:13], v59 offset:0
v_add_u32 v6, s52, v5
v_mfma_f32_16x16x32_bf16 v[136:139], a[88:91], v[84:87], v[136:139]
ds_read_b64_tr_b16 a[14:15], v59 offset:2048
v_mul_i32_i24 v5, 66304, v5
v_mfma_f32_16x16x32_bf16 v[140:143], a[92:95], v[84:87], v[140:143]
ds_read_b64_tr_b16 a[16:17], v56 offset:4096
s_waitcnt vmcnt(9)
v_mfma_f32_16x16x32_bf16 v[128:131], a[96:99], v[88:91], v[128:131]
s_mul_i32 s60, s0, 5504
s_cmp_eq_u32 s49, 1
s_cselect_b32 exec_lo, -1, 0
s_cselect_b32 exec_hi, 2047, 0
buffer_load_dword v251, v255, s[28:31], s60 offen
s_mov_b64 exec, -1
s_add_u32 m0, s86, 0
s_add_u32 s3, s3, 88064
s_cmp_eq_u32 s3, 1409024
s_cselect_b32 s3, 0, s3
buffer_load_dwordx4 v60, s[24:27], s3 offen offset:0 lds
s_add_u32 m0, m0, 3968
ds_read_b64_tr_b16 a[18:19], v56 offset:6144
v_mfma_f32_16x16x32_bf16 v[132:135], a[100:103], v[88:91], v[132:135]
ds_read_b64_tr_b16 a[20:21], v57 offset:4096
v_and_b32 v6, 4, v6
v_mfma_f32_16x16x32_bf16 v[136:139], a[104:107], v[88:91], v[136:139]
ds_read_b64_tr_b16 a[22:23], v57 offset:6144
v_add3_u32 v228, v12, v5, s72
v_mfma_f32_16x16x32_bf16 v[140:143], a[108:111], v[88:91], v[140:143]
ds_read_b64_tr_b16 a[24:25], v58 offset:4096
s_waitcnt vmcnt(10)
v_mfma_f32_16x16x32_bf16 v[128:131], a[112:115], v[92:95], v[128:131]
buffer_load_dwordx4 v60, s[24:27], s3 offen offset:128 lds
s_add_u32 m0, m0, 4224
ds_read_b64_tr_b16 a[26:27], v58 offset:6144
v_mfma_f32_16x16x32_bf16 v[132:135], a[116:119], v[92:95], v[132:135]
ds_read_b64_tr_b16 a[28:29], v59 offset:4096
v_lshl_or_b32 v228, v6, 29, v228
v_mfma_f32_16x16x32_bf16 v[136:139], a[120:123], v[92:95], v[136:139]
ds_read_b64_tr_b16 a[30:31], v59 offset:6144
v_add_f32 v200, v200, v202
v_mfma_f32_16x16x32_bf16 v[140:143], a[124:127], v[92:95], v[140:143]
ds_read_b64_tr_b16 a[32:33], v56 offset:8192
s_waitcnt vmcnt(10)
v_mfma_f32_16x16x32_bf16 v[128:131], a[128:131], v[96:99], v[128:131]
buffer_load_dwordx4 v61, s[24:27], s3 offen offset:0 lds
ds_read_b64_tr_b16 a[34:35], v56 offset:10240
v_mfma_f32_16x16x32_bf16 v[132:135], a[132:135], v[96:99], v[132:135]
ds_read_b64_tr_b16 a[36:37], v57 offset:8192
v_mov_b32 v202, v200
v_mfma_f32_16x16x32_bf16 v[136:139], a[136:139], v[96:99], v[136:139]
ds_read_b64_tr_b16 a[38:39], v57 offset:10240
v_permlane32_swap_b32 v200, v202
v_mfma_f32_16x16x32_bf16 v[140:143], a[140:143], v[96:99], v[140:143]
ds_read_b64_tr_b16 a[40:41], v58 offset:8192
s_waitcnt vmcnt(10)
v_mfma_f32_16x16x32_bf16 v[128:131], a[144:147], v[100:103], v[128:131]
s_add_u32 m0, s86, 12288
s_add_u32 s3, s3, 88064
buffer_load_dwordx4 v60, s[24:27], s3 offen offset:0 lds
s_add_u32 m0, m0, 3968
ds_read_b64_tr_b16 a[42:43], v58 offset:10240
v_mfma_f32_16x16x32_bf16 v[132:135], a[148:151], v[100:103], v[132:135]
ds_read_b64_tr_b16 a[44:45], v59 offset:8192
v_add_f32 v200, v200, v202
v_mfma_f32_16x16x32_bf16 v[136:139], a[152:155], v[100:103], v[136:139]
ds_read_b64_tr_b16 a[46:47], v59 offset:10240
v_mov_b32 v202, v200
v_mfma_f32_16x16x32_bf16 v[140:143], a[156:159], v[100:103], v[140:143]
ds_read_b64_tr_b16 a[48:49], v56 offset:12288
s_waitcnt vmcnt(10)
v_mfma_f32_16x16x32_bf16 v[128:131], a[160:163], v[104:107], v[128:131]
buffer_load_dwordx4 v60, s[24:27], s3 offen offset:128 lds
s_add_u32 m0, m0, 4224
ds_read_b64_tr_b16 a[50:51], v56 offset:14336
v_mfma_f32_16x16x32_bf16 v[132:135], a[164:167], v[104:107], v[132:135]
ds_read_b64_tr_b16 a[52:53], v57 offset:12288
v_permlane16_swap_b32 v200, v202
v_mfma_f32_16x16x32_bf16 v[136:139], a[168:171], v[104:107], v[136:139]
ds_read_b64_tr_b16 a[54:55], v57 offset:14336
v_add_f32 v200, v200, v202
v_mfma_f32_16x16x32_bf16 v[140:143], a[172:175], v[104:107], v[140:143]
ds_read_b64_tr_b16 a[56:57], v58 offset:12288
s_waitcnt vmcnt(10)
v_mfma_f32_16x16x32_bf16 v[128:131], a[176:179], v[108:111], v[128:131]
buffer_load_dwordx4 v61, s[24:27], s3 offen offset:0 lds
ds_read_b64_tr_b16 a[58:59], v58 offset:14336
v_mfma_f32_16x16x32_bf16 v[132:135], a[180:183], v[108:111], v[132:135]
ds_read_b64_tr_b16 a[60:61], v59 offset:12288
v_mov_b32 v201, 0x3727c5ac
v_mfma_f32_16x16x32_bf16 v[136:139], a[184:187], v[108:111], v[136:139]
ds_read_b64_tr_b16 a[62:63], v59 offset:14336
v_fmac_f32 v201, s91, v200
v_mfma_f32_16x16x32_bf16 v[140:143], a[188:191], v[108:111], v[140:143]
ds_read_b64_tr_b16 a[64:65], v56 offset:32768
s_waitcnt vmcnt(10)
v_mfma_f32_16x16x32_bf16 v[128:131], a[192:195], v[112:115], v[128:131]
s_add_u32 m0, s86, 24576
s_add_u32 s3, s3, 88064
s_cmp_eq_u32 s3, 1409024
s_cselect_b32 s3, 0, s3
buffer_load_dwordx4 v60, s[24:27], s3 offen offset:0 lds
s_add_u32 m0, m0, 3968
ds_read_b64_tr_b16 a[66:67], v56 offset:34816
v_mfma_f32_16x16x32_bf16 v[132:135], a[196:199], v[112:115], v[132:135]
ds_read_b64_tr_b16 a[68:69], v57 offset:32768
v_rsq_f32 v223, v201
v_mfma_f32_16x16x32_bf16 v[136:139], a[200:203], v[112:115], v[136:139]
ds_read_b64_tr_b16 a[70:71], v57 offset:34816
v_mul_f32 v222, v201, v223
v_mfma_f32_16x16x32_bf16 v[140:143], a[204:207], v[112:115], v[140:143]
ds_read_b64_tr_b16 a[72:73], v58 offset:32768
s_waitcnt vmcnt(10)
v_mfma_f32_16x16x32_bf16 v[128:131], a[208:211], v[116:119], v[128:131]
buffer_load_dwordx4 v60, s[24:27], s3 offen offset:128 lds
s_add_u32 m0, m0, 4224
ds_read_b64_tr_b16 a[74:75], v58 offset:34816
v_mfma_f32_16x16x32_bf16 v[132:135], a[212:215], v[116:119], v[132:135]
ds_read_b64_tr_b16 a[76:77], v59 offset:32768
v_mul_f32 v221, 0xc0135761, v223
v_mfma_f32_16x16x32_bf16 v[136:139], a[216:219], v[116:119], v[136:139]
ds_read_b64_tr_b16 a[78:79], v59 offset:34816
v_mul_f32 v220, v223, v223
v_mfma_f32_16x16x32_bf16 v[140:143], a[220:223], v[116:119], v[140:143]
ds_read_b64_tr_b16 a[80:81], v56 offset:36864
s_waitcnt vmcnt(10) lgkmcnt(15)
v_mfma_f32_16x16x32_bf16 v[128:131], a[224:227], v[120:123], v[128:131]
ds_read_b64_tr_b16 a[82:83], v56 offset:38912
v_mfma_f32_16x16x32_bf16 v[132:135], a[228:231], v[120:123], v[132:135]
ds_read_b64_tr_b16 a[84:85], v57 offset:36864
v_mul_f32 v220, v220, v223
v_mfma_f32_16x16x32_bf16 v[136:139], a[232:235], v[120:123], v[136:139]
ds_read_b64_tr_b16 a[86:87], v57 offset:38912
v_mul_f32 v220, 0xbdd2d3e8, v220
v_mfma_f32_16x16x32_bf16 v[140:143], a[236:239], v[120:123], v[140:143]
ds_read_b64_tr_b16 a[88:89], v58 offset:36864
s_waitcnt vmcnt(9)
v_mfma_f32_16x16x32_bf16 v[128:131], a[240:243], v[124:127], v[128:131]
ds_read_b64_tr_b16 a[90:91], v58 offset:38912
v_mfma_f32_16x16x32_bf16 v[132:135], a[244:247], v[124:127], v[132:135]
ds_read_b64_tr_b16 a[92:93], v59 offset:36864
v_mfma_f32_16x16x32_bf16 v[136:139], a[248:251], v[124:127], v[136:139]
ds_read_b64_tr_b16 a[94:95], v59 offset:38912
v_mfma_f32_16x16x32_bf16 v[140:143], a[252:255], v[124:127], v[140:143]
ds_read_b64_tr_b16 a[96:97], v56 offset:40960
s_waitcnt lgkmcnt(0)
s_barrier
v_pk_mul_f32 v[144:145], v[128:129], v[128:129]
v_pk_mul_f32 v[146:147], v[130:131], v[130:131]
v_pk_mul_f32 v[148:149], v[132:133], v[132:133]
v_pk_mul_f32 v[150:151], v[134:135], v[134:135]
v_pk_mul_f32 v[152:153], v[136:137], v[136:137]
v_pk_mul_f32 v[154:155], v[138:139], v[138:139]
v_pk_mul_f32 v[156:157], v[140:141], v[140:141]
v_pk_mul_f32 v[158:159], v[142:143], v[142:143]
v_pk_fma_f32 v[144:145], v[144:145], v[220:221], v[220:221] op_sel:[0,0,1] op_sel_hi:[1,0,1]
v_pk_fma_f32 v[146:147], v[146:147], v[220:221], v[220:221] op_sel:[0,0,1] op_sel_hi:[1,0,1]
v_pk_fma_f32 v[148:149], v[148:149], v[220:221], v[220:221] op_sel:[0,0,1] op_sel_hi:[1,0,1]
v_pk_fma_f32 v[150:151], v[150:151], v[220:221], v[220:221] op_sel:[0,0,1] op_sel_hi:[1,0,1]
v_pk_fma_f32 v[152:153], v[152:153], v[220:221], v[220:221] op_sel:[0,0,1] op_sel_hi:[1,0,1]
v_pk_fma_f32 v[154:155], v[154:155], v[220:221], v[220:221] op_sel:[0,0,1] op_sel_hi:[1,0,1]
v_pk_fma_f32 v[156:157], v[156:157], v[220:221], v[220:221] op_sel:[0,0,1] op_sel_hi:[1,0,1]
v_pk_fma_f32 v[158:159], v[158:159], v[220:221], v[220:221] op_sel:[0,0,1] op_sel_hi:[1,0,1]
v_pk_mul_f32 v[144:145], v[144:145], v[128:129]
v_pk_mul_f32 v[146:147], v[146:147], v[130:131]
v_pk_mul_f32 v[148:149], v[148:149], v[132:133]
v_pk_mul_f32 v[150:151], v[150:151], v[134:135]
buffer_load_dwordx4 v61, s[24:27], s3 offen offset:0 lds
v_pk_mul_f32 v[152:153], v[152:153], v[136:137]
v_pk_mul_f32 v[154:155], v[154:155], v[138:139]
v_pk_mul_f32 v[156:157], v[156:157], v[140:141]
v_pk_mul_f32 v[158:159], v[158:159], v[142:143]
v_exp_f32 v144, v144
v_exp_f32 v145, v145
v_exp_f32 v146, v146
v_exp_f32 v147, v147
v_exp_f32 v148, v148
v_exp_f32 v149, v149
v_exp_f32 v150, v150
v_exp_f32 v151, v151
v_exp_f32 v152, v152
v_exp_f32 v153, v153
v_exp_f32 v154, v154
v_exp_f32 v155, v155
v_exp_f32 v156, v156
v_exp_f32 v157, v157
v_exp_f32 v158, v158
v_exp_f32 v159, v159
s_add_u32 m0, s86, 36864
s_add_u32 s3, s3, 88064
buffer_load_dwordx4 v60, s[24:27], s3 offen offset:0 lds
s_add_u32 m0, m0, 3968
v_pk_fma_f32 v[144:145], v[144:145], v[222:223], v[222:223] op_sel:[0,0,0] op_sel_hi:[1,0,0]
v_pk_fma_f32 v[146:147], v[146:147], v[222:223], v[222:223] op_sel:[0,0,0] op_sel_hi:[1,0,0]
v_pk_fma_f32 v[148:149], v[148:149], v[222:223], v[222:223] op_sel:[0,0,0] op_sel_hi:[1,0,0]
v_pk_fma_f32 v[150:151], v[150:151], v[222:223], v[222:223] op_sel:[0,0,0] op_sel_hi:[1,0,0]
v_pk_fma_f32 v[152:153], v[152:153], v[222:223], v[222:223] op_sel:[0,0,0] op_sel_hi:[1,0,0]
v_pk_fma_f32 v[154:155], v[154:155], v[222:223], v[222:223] op_sel:[0,0,0] op_sel_hi:[1,0,0]
v_pk_fma_f32 v[156:157], v[156:157], v[222:223], v[222:223] op_sel:[0,0,0] op_sel_hi:[1,0,0]
v_pk_fma_f32 v[158:159], v[158:159], v[222:223], v[222:223] op_sel:[0,0,0] op_sel_hi:[1,0,0]
v_rcp_f32 v144, v144
v_rcp_f32 v145, v145
v_rcp_f32 v146, v146
v_rcp_f32 v147, v147
v_rcp_f32 v148, v148
v_rcp_f32 v149, v149
v_rcp_f32 v150, v150
v_rcp_f32 v151, v151
v_rcp_f32 v152, v152
v_rcp_f32 v153, v153
v_rcp_f32 v154, v154
v_rcp_f32 v155, v155
buffer_load_dwordx4 v60, s[24:27], s3 offen offset:128 lds
s_add_u32 m0, m0, 4224
v_rcp_f32 v156, v156
v_rcp_f32 v157, v157
v_rcp_f32 v158, v158
v_rcp_f32 v159, v159
v_pk_mul_f32 v[144:145], v[144:145], v[128:129]
v_pk_mul_f32 v[146:147], v[146:147], v[130:131]
v_pk_mul_f32 v[148:149], v[148:149], v[132:133]
v_pk_mul_f32 v[150:151], v[150:151], v[134:135]
v_pk_mul_f32 v[152:153], v[152:153], v[136:137]
v_pk_mul_f32 v[154:155], v[154:155], v[138:139]
v_pk_mul_f32 v[156:157], v[156:157], v[140:141]
v_pk_mul_f32 v[158:159], v[158:159], v[142:143]
v_cvt_pk_bf16_f32 v192, v144, v145
v_cvt_pk_bf16_f32 v193, v146, v147
v_cvt_pk_bf16_f32 v194, v148, v149
v_cvt_pk_bf16_f32 v195, v150, v151
v_cvt_pk_bf16_f32 v196, v152, v153
v_cvt_pk_bf16_f32 v197, v154, v155
v_cvt_pk_bf16_f32 v198, v156, v157
v_cvt_pk_bf16_f32 v199, v158, v159
buffer_load_dwordx4 v61, s[24:27], s3 offen offset:0 lds
s_add_u32 s57, s62, 2074624
buffer_store_dwordx4 v[192:195], v228, s[44:47], s57 offen sc1
buffer_store_dwordx4 v[196:199], v228, s[44:47], s57 offen offset:1024 sc1
s_add_u32 m0, s86, 49152
s_add_u32 s3, s3, 88064
s_cmp_eq_u32 s3, 1409024
s_cselect_b32 s3, 0, s3
buffer_load_dwordx4 v60, s[24:27], s3 offen offset:0 lds
s_add_u32 m0, m0, 3968
s_nop 0
buffer_load_dwordx4 v60, s[24:27], s3 offen offset:128 lds
s_add_u32 m0, m0, 4224
s_nop 0
buffer_load_dwordx4 v61, s[24:27], s3 offen offset:0 lds
ds_read_b64_tr_b16 a[98:99], v56 offset:43008
ds_read_b64_tr_b16 a[100:101], v57 offset:40960
ds_read_b64_tr_b16 a[102:103], v57 offset:43008
ds_read_b64_tr_b16 a[104:105], v58 offset:40960
ds_read_b64_tr_b16 a[106:107], v58 offset:43008
ds_read_b64_tr_b16 a[108:109], v59 offset:40960
ds_read_b64_tr_b16 a[110:111], v59 offset:43008
ds_read_b64_tr_b16 a[112:113], v56 offset:45056
ds_read_b64_tr_b16 a[114:115], v56 offset:47104
ds_read_b64_tr_b16 a[116:117], v57 offset:45056
ds_read_b64_tr_b16 a[118:119], v57 offset:47104
ds_read_b64_tr_b16 a[120:121], v58 offset:45056
ds_read_b64_tr_b16 a[122:123], v58 offset:47104
ds_read_b64_tr_b16 a[124:125], v59 offset:45056
ds_read_b64_tr_b16 a[126:127], v59 offset:47104
ds_read_b64_tr_b16 a[128:129], v52 offset:16384
ds_read_b64_tr_b16 a[130:131], v52 offset:18432
ds_read_b64_tr_b16 a[132:133], v53 offset:16384
ds_read_b64_tr_b16 a[134:135], v53 offset:18432
ds_read_b64_tr_b16 a[136:137], v54 offset:16384
s_waitcnt vmcnt(3)
s_add_u32 s57, s61, 2229248
s_mov_b64 exec, 1
buffer_store_dwordx2 v[8:9], v10, s[44:47], s57 offen sc1
s_mov_b64 exec, -1
s_cmp_eq_u32 s34, 0
s_cbranch_scc1 nohalo_36
s_mov_b32 exec_lo, s34
s_mov_b32 exec_hi, s34
v_mov_b32 v144, v192
v_mov_b32 v145, v9
v_mov_b32 v146, v193
v_mov_b32 v147, v9
buffer_store_dwordx4 v[144:147], v253, s[44:47], s39 offen offset:0 sc1
v_mov_b32 v148, v194
v_mov_b32 v149, v9
v_mov_b32 v150, v195
v_mov_b32 v151, v9
buffer_store_dwordx4 v[148:151], v253, s[44:47], s39 offen offset:128 sc1
v_mov_b32 v152, v196
v_mov_b32 v153, v9
v_mov_b32 v154, v197
v_mov_b32 v155, v9
buffer_store_dwordx4 v[152:155], v253, s[44:47], s39 offen offset:256 sc1
v_mov_b32 v156, v198
v_mov_b32 v157, v9
v_mov_b32 v158, v199
v_mov_b32 v159, v9
buffer_store_dwordx4 v[156:159], v253, s[44:47], s39 offen offset:384 sc1
s_mov_b64 exec, -1
nohalo_36:
ds_read_b64_tr_b16 a[138:139], v54 offset:18432
ds_read_b64_tr_b16 a[140:141], v55 offset:16384
ds_read_b64_tr_b16 a[142:143], v55 offset:18432
ds_read_b64_tr_b16 a[144:145], v52 offset:20480
ds_read_b64_tr_b16 a[146:147], v52 offset:22528
ds_read_b64_tr_b16 a[148:149], v53 offset:20480
ds_read_b64_tr_b16 a[150:151], v53 offset:22528
ds_read_b64_tr_b16 a[152:153], v54 offset:20480
ds_read_b64_tr_b16 a[154:155], v54 offset:22528
ds_read_b64_tr_b16 a[156:157], v55 offset:20480
ds_read_b64_tr_b16 a[158:159], v55 offset:22528
ds_read_b64_tr_b16 a[160:161], v52 offset:24576
ds_read_b64_tr_b16 a[162:163], v52 offset:26624
ds_read_b64_tr_b16 a[164:165], v53 offset:24576
ds_read_b64_tr_b16 a[166:167], v53 offset:26624
ds_read_b64_tr_b16 a[168:169], v54 offset:24576
ds_read_b64_tr_b16 a[170:171], v54 offset:26624
ds_read_b64_tr_b16 a[172:173], v55 offset:24576
s_mov_b32 s58, 2229248
s_mov_b64 exec, s[98:99]
buffer_load_dwordx2 v[200:201], v11, s[44:47], s58 offen sc1
s_mov_b64 exec, -1
s_cmp_eq_u32 s52, 0
s_cselect_b32 s73, 4096, 0
v_add_u32 v228, s73, v12
s_sub_u32 s73, 4096, s73
v_add_u32 v229, s73, v12
s_and_b32 s72, s52, 1
s_lshl_b32 s72, s72, 10
s_add_u32 s72, s72, 158208
v_add_u32 v233, s72, v253
v_xor_b32 v232, 16, v233
v_and_b32 v5, 7, v1
v_lshlrev_b32 v5, 4, v5
v_lshl_add_u32 v5, v3, 7, v5
v_and_b32 v6, 8, v1
v_add3_u32 v234, v5, v6, s72
ds_read_b64_tr_b16 a[174:175], v55 offset:26624
ds_read_b64_tr_b16 a[176:177], v52 offset:28672
ds_read_b64_tr_b16 a[178:179], v52 offset:30720
ds_read_b64_tr_b16 a[180:181], v53 offset:28672
ds_read_b64_tr_b16 a[182:183], v53 offset:30720
ds_read_b64_tr_b16 a[184:185], v54 offset:28672
ds_read_b64_tr_b16 a[186:187], v54 offset:30720
ds_read_b64_tr_b16 a[188:189], v55 offset:28672
ds_read_b64_tr_b16 a[190:191], v55 offset:30720
ds_read_b64_tr_b16 a[192:193], v52 offset:49152
ds_read_b64_tr_b16 a[194:195], v52 offset:51200
ds_read_b64_tr_b16 a[196:197], v53 offset:49152
ds_read_b64_tr_b16 a[198:199], v53 offset:51200
ds_read_b64_tr_b16 a[200:201], v54 offset:49152
ds_read_b64_tr_b16 a[202:203], v54 offset:51200
ds_read_b64_tr_b16 a[204:205], v55 offset:49152
ds_read_b64_tr_b16 a[206:207], v55 offset:51200
ds_read_b64_tr_b16 a[208:209], v52 offset:53248
ds_read_b64_tr_b16 a[210:211], v52 offset:55296
ds_read_b64_tr_b16 a[212:213], v53 offset:53248
s_mov_b64 exec, s[98:99]
s_waitcnt vmcnt(0)
v_cmp_ne_u32 vcc, v201, v9
s_cbranch_vccz go_37
retry_38:
s_sub_u32 s56, s56, 1
s_cbranch_scc1 L_end
buffer_load_dwordx2 v[200:201], v11, s[44:47], s58 offen sc1
s_waitcnt vmcnt(0)
v_cmp_ne_u32 vcc, v201, v9
s_cbranch_vccnz retry_38
go_37:
s_mov_b64 exec, -1
ds_read_b128 v[160:163], v249 offset:0
ds_read_b128 v[164:167], v249 offset:64
ds_read_b128 v[168:171], v249 offset:128
ds_read_b128 v[172:175], v249 offset:192
ds_read_b128 v[176:179], v249 offset:512
ds_read_b128 v[180:183], v249 offset:576
s_mov_b32 s59, 2141184
buffer_load_dwordx4 v[64:67], v228, s[44:47], s59 offen offset:0 sc1
ds_read_b64_tr_b16 a[214:215], v53 offset:55296
ds_read_b64_tr_b16 a[216:217], v54 offset:53248
buffer_load_dwordx4 v[68:71], v228, s[44:47], s59 offen offset:1024 sc1
ds_read_b64_tr_b16 a[218:219], v54 offset:55296
ds_read_b64_tr_b16 a[220:221], v55 offset:53248
buffer_load_dwordx4 v[72:75], v228, s[44:47], s59 offen offset:2048 sc1
ds_read_b64_tr_b16 a[222:223], v55 offset:55296
ds_read_b64_tr_b16 a[224:225], v52 offset:57344
buffer_load_dwordx4 v[76:79], v228, s[44:47], s59 offen offset:3072 sc1
ds_read_b64_tr_b16 a[226:227], v52 offset:59392
ds_read_b64_tr_b16 a[228:229], v53 offset:57344
s_mov_b32 s59, 2149376
buffer_load_dwordx4 v[80:83], v228, s[44:47], s59 offen offset:0 sc1
ds_read_b64_tr_b16 a[230:231], v53 offset:59392
ds_read_b64_tr_b16 a[232:233], v54 offset:57344
buffer_load_dwordx4 v[84:87], v228, s[44:47], s59 offen offset:1024 sc1
ds_read_b64_tr_b16 a[234:235], v54 offset:59392
ds_read_b64_tr_b16 a[236:237], v55 offset:57344
s_waitcnt vmcnt(5) lgkmcnt(15)
v_mfma_f32_16x16x32_bf16 v[128:131], v[160:163], v[64:67], 0
ds_read_b128 v[184:187], v249 offset:640
v_mfma_f32_16x16x32_bf16 v[32:35], a[0:3], v[64:67], v[32:35]
buffer_load_dwordx4 v[88:91], v228, s[44:47], s59 offen offset:2048 sc1
ds_read_b64_tr_b16 a[238:239], v55 offset:59392
v_mfma_f32_16x16x32_bf16 v[36:39], a[4:7], v[64:67], v[36:39]
ds_read_b64_tr_b16 a[240:241], v52 offset:61440
v_mfma_f32_16x16x32_bf16 v[40:43], a[8:11], v[64:67], v[40:43]
buffer_load_dwordx4 v[92:95], v228, s[44:47], s59 offen offset:3072 sc1
ds_read_b64_tr_b16 a[242:243], v52 offset:63488
v_mfma_f32_16x16x32_bf16 v[44:47], a[12:15], v[64:67], v[44:47]
ds_read_b64_tr_b16 a[244:245], v53 offset:61440
s_waitcnt vmcnt(6)
v_mfma_f32_16x16x32_bf16 v[128:131], v[164:167], v[68:71], v[128:131]
ds_read_b128 v[188:191], v249 offset:704
v_mfma_f32_16x16x32_bf16 v[32:35], a[16:19], v[68:71], v[32:35]
s_mov_b32 s59, 2141184
s_mov_b64 exec, s[68:69]
buffer_load_dwordx4 v[96:99], v229, s[44:47], s59 offen offset:0 sc1
s_mov_b64 exec, -1
ds_read_b64_tr_b16 a[246:247], v53 offset:63488
v_mfma_f32_16x16x32_bf16 v[36:39], a[20:23], v[68:71], v[36:39]
ds_read_b64_tr_b16 a[248:249], v54 offset:61440
v_mfma_f32_16x16x32_bf16 v[40:43], a[24:27], v[68:71], v[40:43]
s_mov_b64 exec, s[68:69]
buffer_load_dwordx4 v[100:103], v229, s[44:47], s59 offen offset:1024 sc1
s_mov_b64 exec, -1
ds_read_b64_tr_b16 a[250:251], v54 offset:63488
v_mfma_f32_16x16x32_bf16 v[44:47], a[28:31], v[68:71], v[44:47]
s_waitcnt lgkmcnt(7)
s_barrier
s_waitcnt vmcnt(7)
v_mfma_f32_16x16x32_bf16 v[128:131], v[168:171], v[72:75], v[128:131]
ds_read_b128 v[160:163], v250 offset:256
v_mfma_f32_16x16x32_bf16 v[32:35], a[32:35], v[72:75], v[32:35]
s_mov_b64 exec, s[68:69]
buffer_load_dwordx4 v[104:107], v229, s[44:47], s59 offen offset:2048 sc1
s_mov_b64 exec, -1
ds_read_b64_tr_b16 a[252:253], v55 offset:61440
v_mfma_f32_16x16x32_bf16 v[36:39], a[36:39], v[72:75], v[36:39]
ds_read_b64_tr_b16 a[254:255], v55 offset:63488
v_mfma_f32_16x16x32_bf16 v[40:43], a[40:43], v[72:75], v[40:43]
ds_read_b64_tr_b16 a[0:1], v244 offset:8192
v_mfma_f32_16x16x32_bf16 v[44:47], a[44:47], v[72:75], v[44:47]
ds_read_b64_tr_b16 a[2:3], v244 offset:10240
s_cmp_eq_u32 s63, 1
s_cselect_b64 exec, -1, 0
buffer_load_dwordx4 v[144:147], v2, s[44:47], s32 offen sc1
buffer_load_dwordx4 v[148:151], v2, s[44:47], s32 offen offset:1024 sc1
s_mov_b64 exec, -1
s_waitcnt vmcnt(9)
v_mfma_f32_16x16x32_bf16 v[128:131], v[172:175], v[76:79], v[128:131]
ds_read_b128 v[164:167], v250 offset:320
v_mfma_f32_16x16x32_bf16 v[32:35], a[48:51], v[76:79], v[32:35]
s_mov_b64 exec, s[68:69]
buffer_load_dwordx4 v[108:111], v229, s[44:47], s59 offen offset:3072 sc1
s_mov_b64 exec, -1
ds_read_b64_tr_b16 a[4:5], v245 offset:8192
v_mfma_f32_16x16x32_bf16 v[36:39], a[52:55], v[76:79], v[36:39]
ds_read_b64_tr_b16 a[6:7], v245 offset:10240
v_mfma_f32_16x16x32_bf16 v[40:43], a[56:59], v[76:79], v[40:43]
ds_read_b64_tr_b16 a[8:9], v246 offset:8192
v_mfma_f32_16x16x32_bf16 v[44:47], a[60:63], v[76:79], v[44:47]
ds_read_b64_tr_b16 a[10:11], v246 offset:10240
s_waitcnt vmcnt(9)
v_mfma_f32_16x16x32_bf16 v[128:131], v[176:179], v[80:83], v[128:131]
ds_read_b128 v[168:171], v250 offset:384
v_mfma_f32_16x16x32_bf16 v[32:35], a[64:67], v[80:83], v[32:35]
s_mov_b32 s59, 2149376
s_mov_b64 exec, s[70:71]
buffer_load_dwordx4 v[112:115], v229, s[44:47], s59 offen offset:0 sc1
s_mov_b64 exec, -1
ds_read_b64_tr_b16 a[12:13], v247 offset:8192
v_mfma_f32_16x16x32_bf16 v[36:39], a[68:71], v[80:83], v[36:39]
ds_read_b64_tr_b16 a[14:15], v247 offset:10240
v_mfma_f32_16x16x32_bf16 v[40:43], a[72:75], v[80:83], v[40:43]
ds_read_b64_tr_b16 a[16:17], v244 offset:12288
v_mfma_f32_16x16x32_bf16 v[44:47], a[76:79], v[80:83], v[44:47]
ds_read_b64_tr_b16 a[18:19], v244 offset:14336
s_waitcnt vmcnt(9)
v_mfma_f32_16x16x32_bf16 v[128:131], v[180:183], v[84:87], v[128:131]
ds_read_b128 v[172:175], v250 offset:448
v_mfma_f32_16x16x32_bf16 v[32:35], a[80:83], v[84:87], v[32:35]
s_mov_b64 exec, s[70:71]
buffer_load_dwordx4 v[116:119], v229, s[44:47], s59 offen offset:1024 sc1
s_mov_b64 exec, -1
ds_read_b64_tr_b16 a[20:21], v245 offset:12288
v_mfma_f32_16x16x32_bf16 v[36:39], a[84:87], v[84:87], v[36:39]
ds_read_b64_tr_b16 a[22:23], v245 offset:14336
v_mfma_f32_16x16x32_bf16 v[40:43], a[88:91], v[84:87], v[40:43]
ds_read_b64_tr_b16 a[24:25], v246 offset:12288
v_mfma_f32_16x16x32_bf16 v[44:47], a[92:95], v[84:87], v[44:47]
ds_read_b64_tr_b16 a[26:27], v246 offset:14336
s_waitcnt vmcnt(9)
v_mfma_f32_16x16x32_bf16 v[128:131], v[184:187], v[88:91], v[128:131]
ds_read_b128 v[176:179], v250 offset:768
v_mfma_f32_16x16x32_bf16 v[32:35], a[96:99], v[88:91], v[32:35]
s_mov_b64 exec, s[70:71]
buffer_load_dwordx4 v[120:123], v229, s[44:47], s59 offen offset:2048 sc1
s_mov_b64 exec, -1
ds_read_b64_tr_b16 a[28:29], v247 offset:12288
v_mfma_f32_16x16x32_bf16 v[36:39], a[100:103], v[88:91], v[36:39]
ds_read_b64_tr_b16 a[30:31], v247 offset:14336
v_mfma_f32_16x16x32_bf16 v[40:43], a[104:107], v[88:91], v[40:43]
ds_read_b64_tr_b16 a[32:33], v244 offset:16384
v_mfma_f32_16x16x32_bf16 v[44:47], a[108:111], v[88:91], v[44:47]
ds_read_b64_tr_b16 a[34:35], v244 offset:18432
s_waitcnt vmcnt(9) lgkmcnt(15)
v_mfma_f32_16x16x32_bf16 v[128:131], v[188:191], v[92:95], v[128:131]
ds_read_b128 v[180:183], v250 offset:832
v_mfma_f32_16x16x32_bf16 v[32:35], a[112:115], v[92:95], v[32:35]
s_mov_b64 exec, s[70:71]
buffer_load_dwordx4 v[124:127], v229, s[44:47], s59 offen offset:3072 sc1
s_mov_b64 exec, -1
ds_read_b64_tr_b16 a[36:37], v245 offset:16384
v_mfma_f32_16x16x32_bf16 v[36:39], a[116:119], v[92:95], v[36:39]
ds_read_b64_tr_b16 a[38:39], v245 offset:18432
v_mfma_f32_16x16x32_bf16 v[40:43], a[120:123], v[92:95], v[40:43]
ds_read_b64_tr_b16 a[40:41], v246 offset:16384
v_mfma_f32_16x16x32_bf16 v[44:47], a[124:127], v[92:95], v[44:47]
ds_read_b64_tr_b16 a[42:43], v246 offset:18432
s_cmp_eq_u32 s63, 0
s_cbranch_scc1 nohf_39
s_cmp_eq_u32 s63, 2
s_cbranch_scc1 hz_40
s_waitcnt vmcnt(5)
v_xor_b32 v5, v145, v9
v_bitop3_b32 v5, v5, v147, v9 bitop3:0xf6
v_bitop3_b32 v5, v5, v149, v9 bitop3:0xf6
v_bitop3_b32 v5, v5, v151, v9 bitop3:0xf6
v_cmp_ne_u32 vcc, 0, v5
s_cbranch_vccz go_42
retry_43:
s_sub_u32 s56, s56, 1
s_cbranch_scc1 L_end
s_sleep 1
buffer_load_dwordx4 v[144:147], v2, s[44:47], s32 offen sc1
buffer_load_dwordx4 v[148:151], v2, s[44:47], s32 offen offset:1024 sc1
s_waitcnt vmcnt(0)
v_xor_b32 v5, v145, v9
v_bitop3_b32 v5, v5, v147, v9 bitop3:0xf6
v_bitop3_b32 v5, v5, v149, v9 bitop3:0xf6
v_bitop3_b32 v5, v5, v151, v9 bitop3:0xf6
v_cmp_ne_u32 vcc, 0, v5
s_cbranch_vccnz retry_43
go_42:
s_branch hw_41
hz_40:
v_mov_b32 v144, 0
v_mov_b32 v146, 0
v_mov_b32 v148, 0
v_mov_b32 v150, 0
hw_41:
ds_write2_b32 v234, v144, v146 offset0:0 offset1:1
ds_write2_b32 v234, v148, v150 offset0:128 offset1:129
s_mov_b64 exec, s[64:65]
ds_read_b128 v[96:99], v232 offset:0
ds_read_b128 v[100:103], v232 offset:128
ds_read_b128 v[104:107], v232 offset:256
ds_read_b128 v[108:111], v232 offset:384
s_mov_b64 exec, s[66:67]
ds_read_b128 v[112:115], v233 offset:512
ds_read_b128 v[116:119], v233 offset:640
ds_read_b128 v[120:123], v233 offset:768
ds_read_b128 v[124:127], v233 offset:896
s_mov_b64 exec, -1
s_waitcnt lgkmcnt(0)
nohf_39:
s_waitcnt vmcnt(9)
v_mfma_f32_16x16x32_bf16 v[128:131], v[160:163], v[96:99], v[128:131]
ds_read_b128 v[184:187], v250 offset:896
v_mfma_f32_16x16x32_bf16 v[32:35], a[128:131], v[96:99], v[32:35]
s_mov_b32 s60, 524288
buffer_load_dword v251, v235, s[28:31], s60 offen offset:384
s_add_u32 m0, s86, 61440
s_add_u32 s3, s3, 88064
buffer_load_dwordx4 v60, s[24:27], s3 offen offset:0 lds
s_add_u32 m0, m0, 3968
ds_read_b64_tr_b16 a[44:45], v244 offset:20480
v_mfma_f32_16x16x32_bf16 v[36:39], a[132:135], v[96:99], v[36:39]
ds_read_b64_tr_b16 a[46:47], v244 offset:22528
v_mfma_f32_16x16x32_bf16 v[40:43], a[136:139], v[96:99], v[40:43]
ds_read_b64_tr_b16 a[48:49], v245 offset:20480
v_mfma_f32_16x16x32_bf16 v[44:47], a[140:143], v[96:99], v[44:47]
ds_read_b64_tr_b16 a[50:51], v245 offset:22528
s_waitcnt vmcnt(10)
v_mfma_f32_16x16x32_bf16 v[128:131], v[164:167], v[100:103], v[128:131]
ds_read_b128 v[188:191], v250 offset:960
v_mfma_f32_16x16x32_bf16 v[32:35], a[144:147], v[100:103], v[32:35]
buffer_load_dwordx4 v60, s[24:27], s3 offen offset:128 lds
s_add_u32 m0, m0, 4224
ds_read_b64_tr_b16 a[52:53], v246 offset:20480
v_mfma_f32_16x16x32_bf16 v[36:39], a[148:151], v[100:103], v[36:39]
ds_read_b64_tr_b16 a[54:55], v246 offset:22528
v_mfma_f32_16x16x32_bf16 v[40:43], a[152:155], v[100:103], v[40:43]
ds_read_b64_tr_b16 a[56:57], v247 offset:20480
v_mfma_f32_16x16x32_bf16 v[44:47], a[156:159], v[100:103], v[44:47]
ds_read_b64_tr_b16 a[58:59], v247 offset:22528
s_waitcnt vmcnt(10) lgkmcnt(15)
v_mfma_f32_16x16x32_bf16 v[128:131], v[168:171], v[104:107], v[128:131]
v_mfma_f32_16x16x32_bf16 v[32:35], a[160:163], v[104:107], v[32:35]
buffer_load_dwordx4 v61, s[24:27], s3 offen offset:0 lds
ds_read_b64_tr_b16 a[60:61], v244 offset:24576
v_mfma_f32_16x16x32_bf16 v[36:39], a[164:167], v[104:107], v[36:39]
ds_read_b64_tr_b16 a[62:63], v244 offset:26624
v_mfma_f32_16x16x32_bf16 v[40:43], a[168:171], v[104:107], v[40:43]
ds_read_b64_tr_b16 a[64:65], v245 offset:24576
v_mfma_f32_16x16x32_bf16 v[44:47], a[172:175], v[104:107], v[44:47]
ds_read_b64_tr_b16 a[66:67], v245 offset:26624
s_waitcnt vmcnt(8)
v_mfma_f32_16x16x32_bf16 v[128:131], v[172:175], v[108:111], v[128:131]
v_mfma_f32_16x16x32_bf16 v[32:35], a[176:179], v[108:111], v[32:35]
s_add_u32 m0, s86, 73728
s_add_u32 s3, s3, 88064
s_cmp_eq_u32 s3, 1409024
s_cselect_b32 s3, 0, s3
buffer_load_dwordx4 v60, s[24:27], s3 offen offset:0 lds
s_add_u32 m0, m0, 3968
ds_read_b64_tr_b16 a[68:69], v246 offset:24576
v_mfma_f32_16x16x32_bf16 v[36:39], a[180:183], v[108:111], v[36:39]
ds_read_b64_tr_b16 a[70:71], v246 offset:26624
v_mfma_f32_16x16x32_bf16 v[40:43], a[184:187], v[108:111], v[40:43]
ds_read_b64_tr_b16 a[72:73], v247 offset:24576
v_mfma_f32_16x16x32_bf16 v[44:47], a[188:191], v[108:111], v[44:47]
ds_read_b64_tr_b16 a[74:75], v247 offset:26624
s_waitcnt vmcnt(8)
v_mfma_f32_16x16x32_bf16 v[128:131], v[176:179], v[112:115], v[128:131]
v_mfma_f32_16x16x32_bf16 v[32:35], a[192:195], v[112:115], v[32:35]
buffer_load_dwordx4 v60, s[24:27], s3 offen offset:128 lds
s_add_u32 m0, m0, 4224
ds_read_b64_tr_b16 a[76:77], v244 offset:28672
v_mfma_f32_16x16x32_bf16 v[36:39], a[196:199], v[112:115], v[36:39]
ds_read_b64_tr_b16 a[78:79], v244 offset:30720
v_mfma_f32_16x16x32_bf16 v[40:43], a[200:203], v[112:115], v[40:43]
ds_read_b64_tr_b16 a[80:81], v245 offset:28672
v_mfma_f32_16x16x32_bf16 v[44:47], a[204:207], v[112:115], v[44:47]
ds_read_b64_tr_b16 a[82:83], v245 offset:30720
s_waitcnt vmcnt(8) lgkmcnt(15)
v_mfma_f32_16x16x32_bf16 v[128:131], v[180:183], v[116:119], v[128:131]
v_mfma_f32_16x16x32_bf16 v[32:35], a[208:211], v[116:119], v[32:35]
buffer_load_dwordx4 v61, s[24:27], s3 offen offset:0 lds
ds_read_b64_tr_b16 a[84:85], v246 offset:28672
v_mfma_f32_16x16x32_bf16 v[36:39], a[212:215], v[116:119], v[36:39]
ds_read_b64_tr_b16 a[86:87], v246 offset:30720
v_mfma_f32_16x16x32_bf16 v[40:43], a[216:219], v[116:119], v[40:43]
ds_read_b64_tr_b16 a[88:89], v236 offset:0
v_mfma_f32_16x16x32_bf16 v[44:47], a[220:223], v[116:119], v[44:47]
ds_read_b64_tr_b16 a[90:91], v236 offset:2048
s_waitcnt vmcnt(8)
v_mfma_f32_16x16x32_bf16 v[128:131], v[184:187], v[120:123], v[128:131]
v_mfma_f32_16x16x32_bf16 v[32:35], a[224:227], v[120:123], v[32:35]
s_add_u32 m0, s86, 86016
s_add_u32 s3, s3, 88064
buffer_load_dwordx4 v60, s[24:27], s3 offen offset:0 lds
s_add_u32 m0, m0, 3968
ds_read_b64_tr_b16 a[92:93], v237 offset:0
v_mfma_f32_16x16x32_bf16 v[36:39], a[228:231], v[120:123], v[36:39]
ds_read_b64_tr_b16 a[94:95], v237 offset:2048
v_mfma_f32_16x16x32_bf16 v[40:43], a[232:235], v[120:123], v[40:43]
ds_read_b64_tr_b16 a[96:97], v238 offset:0
v_mfma_f32_16x16x32_bf16 v[44:47], a[236:239], v[120:123], v[44:47]
ds_read_b64_tr_b16 a[98:99], v238 offset:2048
s_waitcnt vmcnt(8)
v_mfma_f32_16x16x32_bf16 v[128:131], v[188:191], v[124:127], v[128:131]
v_mfma_f32_16x16x32_bf16 v[32:35], a[240:243], v[124:127], v[32:35]
buffer_load_dwordx4 v60, s[24:27], s3 offen offset:128 lds
s_add_u32 m0, m0, 4224
ds_read_b64_tr_b16 a[100:101], v239 offset:0
v_mfma_f32_16x16x32_bf16 v[36:39], a[244:247], v[124:127], v[36:39]
ds_read_b64_tr_b16 a[102:103], v239 offset:2048
v_mfma_f32_16x16x32_bf16 v[40:43], a[248:251], v[124:127], v[40:43]
ds_read_b64_tr_b16 a[104:105], v236 offset:4096
v_mfma_f32_16x16x32_bf16 v[44:47], a[252:255], v[124:127], v[44:47]
ds_read_b64_tr_b16 a[106:107], v236 offset:6144
v_add_f32 v204, v128, v129
v_add_f32 v204, v204, v248
v_pk_add_f32 v[144:145], v[32:33], v[204:205] op_sel:[0,0] op_sel_hi:[1,0] neg_lo:[0,1] neg_hi:[0,1]
v_pk_add_f32 v[146:147], v[34:35], v[204:205] op_sel:[0,0] op_sel_hi:[1,0] neg_lo:[0,1] neg_hi:[0,1]
v_pk_add_f32 v[148:149], v[36:37], v[204:205] op_sel:[0,0] op_sel_hi:[1,0] neg_lo:[0,1] neg_hi:[0,1]
v_pk_add_f32 v[150:151], v[38:39], v[204:205] op_sel:[0,0] op_sel_hi:[1,0] neg_lo:[0,1] neg_hi:[0,1]
v_pk_add_f32 v[152:153], v[40:41], v[204:205] op_sel:[0,0] op_sel_hi:[1,0] neg_lo:[0,1] neg_hi:[0,1]
v_pk_add_f32 v[154:155], v[42:43], v[204:205] op_sel:[0,0] op_sel_hi:[1,0] neg_lo:[0,1] neg_hi:[0,1]
v_pk_add_f32 v[156:157], v[44:45], v[204:205] op_sel:[0,0] op_sel_hi:[1,0] neg_lo:[0,1] neg_hi:[0,1]
v_pk_add_f32 v[158:159], v[46:47], v[204:205] op_sel:[0,0] op_sel_hi:[1,0] neg_lo:[0,1] neg_hi:[0,1]
v_cvt_pk_bf16_f32 v64, v144, v145
v_cvt_pk_bf16_f32 v65, v146, v147
v_cvt_pk_bf16_f32 v66, v148, v149
v_cvt_pk_bf16_f32 v67, v150, v151
v_cvt_pk_bf16_f32 v68, v152, v153
v_cvt_pk_bf16_f32 v69, v154, v155
v_cvt_pk_bf16_f32 v70, v156, v157
v_cvt_pk_bf16_f32 v71, v158, v159
s_add_u32 s57, s62, 2097152
buffer_store_dwordx4 v[64:67], v12, s[44:47], s57 offen sc1
buffer_store_dwordx4 v[68:71], v12, s[44:47], s57 offen offset:1024 sc1
s_waitcnt lgkmcnt(0)
s_barrier
v_pk_mul_f32 v[224:225], v[144:145], v[144:145]
v_pk_fma_f32 v[224:225], v[146:147], v[146:147], v[224:225]
v_pk_fma_f32 v[224:225], v[148:149], v[148:149], v[224:225]
v_pk_fma_f32 v[224:225], v[150:151], v[150:151], v[224:225]
v_pk_fma_f32 v[224:225], v[152:153], v[152:153], v[224:225]
v_pk_fma_f32 v[224:225], v[154:155], v[154:155], v[224:225]
v_pk_fma_f32 v[224:225], v[156:157], v[156:157], v[224:225]
v_pk_fma_f32 v[224:225], v[158:159], v[158:159], v[224:225]
v_add_f32 v204, v224, v225
v_mov_b32 v206, v204
s_nop 1
v_permlane32_swap_b32 v204, v206
v_add_f32 v204, v204, v206
v_mov_b32 v206, v204
s_nop 1
v_permlane16_swap_b32 v204, v206
v_add_f32 v204, v204, v206
v_mov_b32 v205, v9
s_add_u32 s38, s38, -2048
buffer_load_dwordx4 v61, s[24:27], s3 offen offset:0 lds
s_add_u32 m0, s86, 98304
s_add_u32 s3, s3, 88064
s_cmp_eq_u32 s3, 1409024
s_cselect_b32 s3, 0, s3
buffer_load_dwordx4 v60, s[24:27], s3 offen offset:0 lds
s_add_u32 m0, m0, 3968
s_nop 0
buffer_load_dwordx4 v60, s[24:27], s3 offen offset:128 lds
s_add_u32 m0, m0, 4224
s_nop 0
buffer_load_dwordx4 v61, s[24:27], s3 offen offset:0 lds
ds_read_b64_tr_b16 a[108:109], v237 offset:4096
ds_read_b64_tr_b16 a[110:111], v237 offset:6144
ds_read_b64_tr_b16 a[112:113], v238 offset:4096
ds_read_b64_tr_b16 a[114:115], v238 offset:6144
ds_read_b64_tr_b16 a[116:117], v239 offset:4096
ds_read_b64_tr_b16 a[118:119], v239 offset:6144
ds_read_b64_tr_b16 a[120:121], v236 offset:8192
ds_read_b64_tr_b16 a[122:123], v236 offset:10240
ds_read_b64_tr_b16 a[124:125], v237 offset:8192
ds_read_b64_tr_b16 a[126:127], v237 offset:10240
ds_read_b64_tr_b16 a[128:129], v238 offset:8192
ds_read_b64_tr_b16 a[130:131], v238 offset:10240
ds_read_b64_tr_b16 a[132:133], v236 offset:12288
ds_read_b64_tr_b16 a[134:135], v236 offset:14336
ds_read_b64_tr_b16 a[136:137], v237 offset:12288
ds_read_b64_tr_b16 a[138:139], v237 offset:14336
ds_read_b64_tr_b16 a[140:141], v238 offset:12288
ds_read_b64_tr_b16 a[142:143], v238 offset:14336
ds_read_b64_tr_b16 a[144:145], v239 offset:12288
ds_read_b64_tr_b16 a[146:147], v239 offset:14336
s_waitcnt vmcnt(4)
s_mov_b64 exec, 0xffff
buffer_store_dwordx2 v[204:205], v12, s[44:47], s38 offen sc1
s_mov_b64 exec, -1
s_add_u32 m0, s86, 110592
s_add_u32 s3, s3, 88064
buffer_load_dwordx4 v60, s[24:27], s3 offen offset:0 lds
s_add_u32 m0, m0, 3968
s_nop 0
buffer_load_dwordx4 v60, s[24:27], s3 offen offset:128 lds
s_add_u32 m0, m0, 4224
ds_read_b64_tr_b16 a[148:149], v236 offset:16384
ds_read_b64_tr_b16 a[150:151], v236 offset:18432
ds_read_b64_tr_b16 a[152:153], v237 offset:16384
ds_read_b64_tr_b16 a[154:155], v237 offset:18432
ds_read_b64_tr_b16 a[156:157], v238 offset:16384
ds_read_b64_tr_b16 a[158:159], v238 offset:18432
ds_read_b64_tr_b16 a[160:161], v239 offset:16384
ds_read_b64_tr_b16 a[162:163], v239 offset:18432
ds_read_b64_tr_b16 a[164:165], v236 offset:20480
ds_read_b64_tr_b16 a[166:167], v236 offset:22528
ds_read_b64_tr_b16 a[168:169], v237 offset:20480
ds_read_b64_tr_b16 a[170:171], v237 offset:22528
ds_read_b64_tr_b16 a[172:173], v238 offset:20480
ds_read_b64_tr_b16 a[174:175], v238 offset:22528
ds_read_b64_tr_b16 a[176:177], v236 offset:24576
ds_read_b64_tr_b16 a[178:179], v236 offset:26624
ds_read_b64_tr_b16 a[180:181], v237 offset:24576
ds_read_b64_tr_b16 a[182:183], v237 offset:26624
s_mov_b32 s58, 2159616
buffer_load_dwordx4 v[200:203], v12, s[44:47], s58 offen sc1
buffer_load_dwordx4 v61, s[24:27], s3 offen offset:0 lds
s_add_u32 m0, s86, 122880
s_add_u32 s3, s3, 88064
s_cmp_eq_u32 s3, 1409024
s_cselect_b32 s3, 0, s3
buffer_load_dwordx4 v60, s[24:27], s3 offen offset:0 lds
s_add_u32 m0, m0, 3968
s_nop 0
buffer_load_dwordx4 v60, s[24:27], s3 offen offset:128 lds
s_add_u32 m0, m0, 4224
ds_read_b64_tr_b16 a[184:185], v238 offset:24576
ds_read_b64_tr_b16 a[186:187], v238 offset:26624
ds_read_b64_tr_b16 a[188:189], v239 offset:24576
ds_read_b64_tr_b16 a[190:191], v239 offset:26624
ds_read_b64_tr_b16 a[192:193], v236 offset:28672
ds_read_b64_tr_b16 a[194:195], v236 offset:30720
ds_read_b64_tr_b16 a[196:197], v237 offset:28672
ds_read_b64_tr_b16 a[198:199], v237 offset:30720
ds_read_b64_tr_b16 a[200:201], v238 offset:28672
ds_read_b64_tr_b16 a[202:203], v238 offset:30720
ds_read_b64_tr_b16 a[204:205], v239 offset:28672
ds_read_b64_tr_b16 a[206:207], v239 offset:30720
ds_read_b64_tr_b16 a[208:209], v236 offset:32768
ds_read_b64_tr_b16 a[210:211], v236 offset:34816
ds_read_b64_tr_b16 a[212:213], v237 offset:32768
ds_read_b64_tr_b16 a[214:215], v237 offset:34816
ds_read_b64_tr_b16 a[216:217], v238 offset:32768
ds_read_b64_tr_b16 a[218:219], v238 offset:34816
ds_read_b64_tr_b16 a[220:221], v236 offset:36864
ds_read_b64_tr_b16 a[222:223], v236 offset:38912
ds_read_b64_tr_b16 a[224:225], v237 offset:36864
ds_read_b64_tr_b16 a[226:227], v237 offset:38912
ds_read_b64_tr_b16 a[228:229], v238 offset:36864
ds_read_b64_tr_b16 a[230:231], v238 offset:38912
ds_read_b64_tr_b16 a[232:233], v239 offset:36864
ds_read_b64_tr_b16 a[234:235], v239 offset:38912
ds_read_b64_tr_b16 a[236:237], v236 offset:40960
ds_read_b64_tr_b16 a[238:239], v236 offset:43008
ds_read_b64_tr_b16 a[240:241], v237 offset:40960
ds_read_b64_tr_b16 a[242:243], v237 offset:43008
ds_read_b64_tr_b16 a[244:245], v238 offset:40960
ds_read_b64_tr_b16 a[246:247], v238 offset:43008
ds_read_b64_tr_b16 a[248:249], v239 offset:40960
ds_read_b64_tr_b16 a[250:251], v239 offset:43008
ds_read_b64_tr_b16 a[252:253], v236 offset:45056
ds_read_b64_tr_b16 a[254:255], v236 offset:47104
s_waitcnt vmcnt(3)
v_xor_b32 v5, v201, v9
v_bitop3_b32 v5, v5, v203, v9 bitop3:0xf6
v_cmp_ne_u32 vcc, 0, v5
s_cbranch_vccz go_44
retry_45:
s_sub_u32 s56, s56, 1
s_cbranch_scc1 L_end
buffer_load_dwordx4 v[200:203], v12, s[44:47], s58 offen sc1
s_waitcnt vmcnt(0)
v_xor_b32 v5, v201, v9
v_bitop3_b32 v5, v5, v203, v9 bitop3:0xf6
v_cmp_ne_u32 vcc, 0, v5
s_cbranch_vccnz retry_45
go_44:
v_add_u32 v7, 2097152, v12
s_add_u32 s59, s62, 2048
s_and_b32 s59, s59, 0x3fff
buffer_load_dwordx4 v[72:75], v7, s[44:47], s59 offen offset:0 sc1
buffer_load_dwordx4 v[76:79], v7, s[44:47], s59 offen offset:1024 sc1
s_add_u32 s59, s59, 2048
s_and_b32 s59, s59, 0x3fff
buffer_load_dwordx4 v[80:83], v7, s[44:47], s59 offen offset:0 sc1
buffer_load_dwordx4 v[84:87], v7, s[44:47], s59 offen offset:1024 sc1
v_mfma_f32_16x16x32_bf16 v[128:131], a[0:3], v[64:67], 0
s_add_u32 s59, s59, 2048
s_and_b32 s59, s59, 0x3fff
buffer_load_dwordx4 v[88:91], v7, s[44:47], s59 offen offset:0 sc1
ds_read_b64_tr_b16 a[0:1], v237 offset:45056
v_mfma_f32_16x16x32_bf16 v[132:135], a[4:7], v[64:67], 0
ds_read_b64_tr_b16 a[2:3], v237 offset:47104
v_add_f32 v200, v200, v202
v_mfma_f32_16x16x32_bf16 v[136:139], a[8:11], v[64:67], 0
ds_read_b64_tr_b16 a[4:5], v238 offset:45056
ds_read_b64_tr_b16 a[6:7], v238 offset:47104
v_mfma_f32_16x16x32_bf16 v[140:143], a[12:15], v[64:67], 0
buffer_load_dwordx4 v61, s[24:27], s3 offen offset:0 lds
ds_read_b64_tr_b16 a[8:9], v236 offset:49152
v_mfma_f32_16x16x32_bf16 v[144:147], a[16:19], v[64:67], 0
ds_read_b64_tr_b16 a[10:11], v236 offset:51200
v_mov_b32 v202, v200
v_mfma_f32_16x16x32_bf16 v[148:151], a[20:23], v[64:67], 0
ds_read_b64_tr_b16 a[12:13], v237 offset:49152
v_mfma_f32_16x16x32_bf16 v[152:155], a[24:27], v[64:67], 0
ds_read_b64_tr_b16 a[14:15], v237 offset:51200
ds_read_b64_tr_b16 a[16:17], v238 offset:49152
v_mfma_f32_16x16x32_bf16 v[156:159], a[28:31], v[64:67], 0
s_add_u32 m0, s86, 135168
s_add_u32 s3, s3, 88064
buffer_load_dwordx4 v60, s[24:27], s3 offen offset:0 lds
s_add_u32 m0, m0, 3968
ds_read_b64_tr_b16 a[18:19], v238 offset:51200
v_mfma_f32_16x16x32_bf16 v[160:163], a[32:35], v[64:67], 0
ds_read_b64_tr_b16 a[20:21], v239 offset:49152
ds_read_b64_tr_b16 a[22:23], v239 offset:51200
v_mfma_f32_16x16x32_bf16 v[164:167], a[36:39], v[64:67], 0
ds_read_b64_tr_b16 a[24:25], v236 offset:53248
v_permlane32_swap_b32 v200, v202
v_mfma_f32_16x16x32_bf16 v[168:171], a[40:43], v[64:67], 0
s_waitcnt vmcnt(7) lgkmcnt(7)
s_barrier
v_mfma_f32_16x16x32_bf16 v[128:131], a[44:47], v[68:71], v[128:131]
buffer_load_dwordx4 v[92:95], v7, s[44:47], s59 offen offset:1024 sc1
ds_read_b64_tr_b16 a[26:27], v236 offset:55296
v_mfma_f32_16x16x32_bf16 v[132:135], a[48:51], v[68:71], v[132:135]
ds_read_b64_tr_b16 a[28:29], v237 offset:53248
ds_read_b64_tr_b16 a[30:31], v237 offset:55296
v_mfma_f32_16x16x32_bf16 v[136:139], a[52:55], v[68:71], v[136:139]
ds_read_b64_tr_b16 a[32:33], v238 offset:53248
ds_read_b64_tr_b16 a[34:35], v238 offset:55296
v_mfma_f32_16x16x32_bf16 v[140:143], a[56:59], v[68:71], v[140:143]
buffer_load_dwordx4 v60, s[24:27], s3 offen offset:128 lds
s_add_u32 m0, m0, 4224
ds_read_b64_tr_b16 a[36:37], v239 offset:53248
v_mfma_f32_16x16x32_bf16 v[144:147], a[60:63], v[68:71], v[144:147]
ds_read_b64_tr_b16 a[38:39], v239 offset:55296
ds_read_b64_tr_b16 a[40:41], v236 offset:57344
v_mfma_f32_16x16x32_bf16 v[148:151], a[64:67], v[68:71], v[148:151]
ds_read_b64_tr_b16 a[42:43], v236 offset:59392
v_mfma_f32_16x16x32_bf16 v[152:155], a[68:71], v[68:71], v[152:155]
ds_read_b64_tr_b16 a[44:45], v237 offset:57344
v_add_f32 v200, v200, v202
v_mfma_f32_16x16x32_bf16 v[156:159], a[72:75], v[68:71], v[156:159]
buffer_load_dwordx4 v61, s[24:27], s3 offen offset:0 lds
ds_read_b64_tr_b16 a[46:47], v237 offset:59392
v_mfma_f32_16x16x32_bf16 v[160:163], a[76:79], v[68:71], v[160:163]
ds_read_b64_tr_b16 a[48:49], v238 offset:57344
ds_read_b64_tr_b16 a[50:51], v238 offset:59392
v_mfma_f32_16x16x32_bf16 v[164:167], a[80:83], v[68:71], v[164:167]
ds_read_b64_tr_b16 a[52:53], v240 offset:0
ds_read_b64_tr_b16 a[54:55], v240 offset:2048
v_mfma_f32_16x16x32_bf16 v[168:171], a[84:87], v[68:71], v[168:171]
ds_read_b64_tr_b16 a[56:57], v241 offset:0
s_waitcnt vmcnt(9)
v_mfma_f32_16x16x32_bf16 v[128:131], a[88:91], v[72:75], v[128:131]
s_add_u32 s59, s59, 2048
s_and_b32 s59, s59, 0x3fff
buffer_load_dwordx4 v[96:99], v7, s[44:47], s59 offen offset:0 sc1
ds_read_b64_tr_b16 a[58:59], v241 offset:2048
v_mfma_f32_16x16x32_bf16 v[132:135], a[92:95], v[72:75], v[132:135]
ds_read_b64_tr_b16 a[60:61], v242 offset:0
ds_read_b64_tr_b16 a[62:63], v242 offset:2048
v_mfma_f32_16x16x32_bf16 v[136:139], a[96:99], v[72:75], v[136:139]
ds_read_b64_tr_b16 a[64:65], v243 offset:0
v_mov_b32 v202, v200
v_mfma_f32_16x16x32_bf16 v[140:143], a[100:103], v[72:75], v[140:143]
s_add_u32 m0, s86, 0
s_add_u32 s3, s3, 88064
s_cmp_eq_u32 s3, 1409024
s_cselect_b32 s3, 0, s3
buffer_load_dwordx4 v60, s[24:27], s3 offen offset:0 lds
s_add_u32 m0, m0, 3968
ds_read_b64_tr_b16 a[66:67], v243 offset:2048
v_mfma_f32_16x16x32_bf16 v[144:147], a[104:107], v[72:75], v[144:147]
ds_read_b64_tr_b16 a[68:69], v240 offset:4096
ds_read_b64_tr_b16 a[70:71], v240 offset:6144
v_mfma_f32_16x16x32_bf16 v[148:151], a[108:111], v[72:75], v[148:151]
ds_read_b64_tr_b16 a[72:73], v241 offset:4096
v_mfma_f32_16x16x32_bf16 v[152:155], a[112:115], v[72:75], v[152:155]
ds_read_b64_tr_b16 a[74:75], v241 offset:6144
ds_read_b64_tr_b16 a[76:77], v242 offset:4096
v_mfma_f32_16x16x32_bf16 v[156:159], a[116:119], v[72:75], v[156:159]
buffer_load_dwordx4 v60, s[24:27], s3 offen offset:128 lds
s_add_u32 m0, m0, 4224
ds_read_b64_tr_b16 a[78:79], v242 offset:6144
v_mfma_f32_16x16x32_bf16 v[160:163], a[120:123], v[72:75], v[160:163]
ds_read_b64_tr_b16 a[80:81], v243 offset:4096
ds_read_b64_tr_b16 a[82:83], v243 offset:6144
v_mfma_f32_16x16x32_bf16 v[164:167], a[124:127], v[72:75], v[164:167]
ds_read_b64_tr_b16 a[84:85], v240 offset:8192
v_permlane16_swap_b32 v200, v202
v_mfma_f32_16x16x32_bf16 v[168:171], a[128:131], v[72:75], v[168:171]
s_waitcnt lgkmcnt(7)
s_barrier
s_waitcnt vmcnt(11)
v_mfma_f32_16x16x32_bf16 v[128:131], a[132:135], v[76:79], v[128:131]
buffer_load_dwordx4 v[100:103], v7, s[44:47], s59 offen offset:1024 sc1
ds_read_b64_tr_b16 a[86:87], v240 offset:10240
v_mfma_f32_16x16x32_bf16 v[132:135], a[136:139], v[76:79], v[132:135]
ds_read_b64_tr_b16 a[88:89], v241 offset:8192
ds_read_b64_tr_b16 a[90:91], v241 offset:10240
v_mfma_f32_16x16x32_bf16 v[136:139], a[140:143], v[76:79], v[136:139]
ds_read_b64_tr_b16 a[92:93], v242 offset:8192
v_add_f32 v200, v200, v202
v_mfma_f32_16x16x32_bf16 v[140:143], a[144:147], v[76:79], v[140:143]
buffer_load_dwordx4 v61, s[24:27], s3 offen offset:0 lds
ds_read_b64_tr_b16 a[94:95], v242 offset:10240
v_mfma_f32_16x16x32_bf16 v[144:147], a[148:151], v[76:79], v[144:147]
ds_read_b64_tr_b16 a[96:97], v240 offset:12288
ds_read_b64_tr_b16 a[98:99], v240 offset:14336
v_mfma_f32_16x16x32_bf16 v[148:151], a[152:155], v[76:79], v[148:151]
ds_read_b64_tr_b16 a[100:101], v241 offset:12288
v_mfma_f32_16x16x32_bf16 v[152:155], a[156:159], v[76:79], v[152:155]
ds_read_b64_tr_b16 a[102:103], v241 offset:14336
ds_read_b64_tr_b16 a[104:105], v242 offset:12288
v_mfma_f32_16x16x32_bf16 v[156:159], a[160:163], v[76:79], v[156:159]
s_add_u32 m0, s86, 12288
s_add_u32 s3, s3, 88064
buffer_load_dwordx4 v60, s[24:27], s3 offen offset:0 lds
s_add_u32 m0, m0, 3968
ds_read_b64_tr_b16 a[106:107], v242 offset:14336
v_mfma_f32_16x16x32_bf16 v[160:163], a[164:167], v[76:79], v[160:163]
ds_read_b64_tr_b16 a[108:109], v243 offset:12288
ds_read_b64_tr_b16 a[110:111], v243 offset:14336
v_mfma_f32_16x16x32_bf16 v[164:167], a[168:171], v[76:79], v[164:167]
ds_read_b64_tr_b16 a[112:113], v240 offset:16384
v_mov_b32 v201, 0x3727c5ac
v_mfma_f32_16x16x32_bf16 v[168:171], a[172:175], v[76:79], v[168:171]
ds_read_b64_tr_b16 a[114:115], v240 offset:18432
s_waitcnt vmcnt(13)
v_mfma_f32_16x16x32_bf16 v[128:131], a[176:179], v[80:83], v[128:131]
s_mov_b32 s60, 1048576
buffer_load_dword v251, v235, s[28:31], s60 offen offset:384
s_add_u32 s59, s59, 2048
s_and_b32 s59, s59, 0x3fff
buffer_load_dwordx4 v[104:107], v7, s[44:47], s59 offen offset:0 sc1
ds_read_b64_tr_b16 a[116:117], v241 offset:16384
v_mfma_f32_16x16x32_bf16 v[132:135], a[180:183], v[80:83], v[132:135]
ds_read_b64_tr_b16 a[118:119], v241 offset:18432
ds_read_b64_tr_b16 a[120:121], v242 offset:16384
v_mfma_f32_16x16x32_bf16 v[136:139], a[184:187], v[80:83], v[136:139]
ds_read_b64_tr_b16 a[122:123], v242 offset:18432
ds_read_b64_tr_b16 a[124:125], v243 offset:16384
v_mfma_f32_16x16x32_bf16 v[140:143], a[188:191], v[80:83], v[140:143]
buffer_load_dwordx4 v60, s[24:27], s3 offen offset:128 lds
s_add_u32 m0, m0, 4224
ds_read_b64_tr_b16 a[126:127], v243 offset:18432
v_mfma_f32_16x16x32_bf16 v[144:147], a[192:195], v[80:83], v[144:147]
ds_read_b64_tr_b16 a[128:129], v240 offset:20480
ds_read_b64_tr_b16 a[130:131], v240 offset:22528
v_mfma_f32_16x16x32_bf16 v[148:151], a[196:199], v[80:83], v[148:151]
ds_read_b64_tr_b16 a[132:133], v241 offset:20480
v_mfma_f32_16x16x32_bf16 v[152:155], a[200:203], v[80:83], v[152:155]
ds_read_b64_tr_b16 a[134:135], v241 offset:22528
ds_read_b64_tr_b16 a[136:137], v242 offset:20480
v_mfma_f32_16x16x32_bf16 v[156:159], a[204:207], v[80:83], v[156:159]
buffer_load_dwordx4 v61, s[24:27], s3 offen offset:0 lds
v_readlane_b32 s3, v13, 0
ds_read_b64_tr_b16 a[138:139], v242 offset:22528
v_mfma_f32_16x16x32_bf16 v[160:163], a[208:211], v[80:83], v[160:163]
ds_read_b64_tr_b16 a[140:141], v240 offset:24576
v_fmac_f32 v201, s91, v200
v_mfma_f32_16x16x32_bf16 v[164:167], a[212:215], v[80:83], v[164:167]
ds_read_b64_tr_b16 a[142:143], v240 offset:26624
ds_read_b64_tr_b16 a[144:145], v241 offset:24576
v_mfma_f32_16x16x32_bf16 v[168:171], a[216:219], v[80:83], v[168:171]
ds_read_b64_tr_b16 a[146:147], v241 offset:26624
s_waitcnt vmcnt(16)
v_mfma_f32_16x16x32_bf16 v[128:131], a[220:223], v[84:87], v[128:131]
buffer_load_dwordx4 v[108:111], v7, s[44:47], s59 offen offset:1024 sc1
ds_read_b64_tr_b16 a[148:149], v242 offset:24576
v_mfma_f32_16x16x32_bf16 v[132:135], a[224:227], v[84:87], v[132:135]
ds_read_b64_tr_b16 a[150:151], v242 offset:26624
ds_read_b64_tr_b16 a[152:153], v243 offset:24576
v_mfma_f32_16x16x32_bf16 v[136:139], a[228:231], v[84:87], v[136:139]
ds_read_b64_tr_b16 a[154:155], v243 offset:26624
ds_read_b64_tr_b16 a[156:157], v240 offset:28672
v_mfma_f32_16x16x32_bf16 v[140:143], a[232:235], v[84:87], v[140:143]
s_add_u32 m0, s90, 24576
s_nop 0
buffer_load_dwordx4 v48, s[28:31], s3 offen offset:0 lds
ds_read_b64_tr_b16 a[158:159], v240 offset:30720
v_mfma_f32_16x16x32_bf16 v[144:147], a[236:239], v[84:87], v[144:147]
ds_read_b64_tr_b16 a[160:161], v241 offset:28672
v_rsq_f32 v223, v201
v_mfma_f32_16x16x32_bf16 v[148:151], a[240:243], v[84:87], v[148:151]
ds_read_b64_tr_b16 a[162:163], v241 offset:30720
v_mfma_f32_16x16x32_bf16 v[152:155], a[244:247], v[84:87], v[152:155]
ds_read_b64_tr_b16 a[164:165], v242 offset:28672
ds_read_b64_tr_b16 a[166:167], v242 offset:30720
v_mfma_f32_16x16x32_bf16 v[156:159], a[248:251], v[84:87], v[156:159]
buffer_load_dwordx4 v49, s[28:31], s3 offen offset:1024 lds
ds_read_b64_tr_b16 a[168:169], v243 offset:28672
v_mfma_f32_16x16x32_bf16 v[160:163], a[252:255], v[84:87], v[160:163]
ds_read_b64_tr_b16 a[170:171], v243 offset:30720
ds_read_b64_tr_b16 a[172:173], v240 offset:32768
v_mfma_f32_16x16x32_bf16 v[164:167], a[0:3], v[84:87], v[164:167]
ds_read_b64_tr_b16 a[174:175], v240 offset:34816
v_mul_f32 v222, v201, v223
v_mfma_f32_16x16x32_bf16 v[168:171], a[4:7], v[84:87], v[168:171]
s_waitcnt vmcnt(13)
s_waitcnt vmcnt(12) lgkmcnt(7)
s_barrier
v_mfma_f32_16x16x32_bf16 v[128:131], a[8:11], v[88:91], v[128:131]
s_add_u32 s59, s59, 2048
s_and_b32 s59, s59, 0x3fff
buffer_load_dwordx4 v[112:115], v7, s[44:47], s59 offen offset:0 sc1
ds_read_b64_tr_b16 a[176:177], v241 offset:32768
v_mfma_f32_16x16x32_bf16 v[132:135], a[12:15], v[88:91], v[132:135]
ds_read_b64_tr_b16 a[178:179], v241 offset:34816
ds_read_b64_tr_b16 a[180:181], v242 offset:32768
v_mfma_f32_16x16x32_bf16 v[136:139], a[16:19], v[88:91], v[136:139]
ds_read_b64_tr_b16 a[182:183], v242 offset:34816
ds_read_b64_tr_b16 a[184:185], v240 offset:36864
v_mfma_f32_16x16x32_bf16 v[140:143], a[20:23], v[88:91], v[140:143]
buffer_load_dwordx4 v50, s[28:31], s3 offen offset:2048 lds
ds_read_b64_tr_b16 a[186:187], v240 offset:38912
v_mfma_f32_16x16x32_bf16 v[144:147], a[24:27], v[88:91], v[144:147]
ds_read_b64_tr_b16 a[188:189], v241 offset:36864
ds_read_b64_tr_b16 a[190:191], v241 offset:38912
v_mfma_f32_16x16x32_bf16 v[148:151], a[28:31], v[88:91], v[148:151]
ds_read_b64_tr_b16 a[192:193], v242 offset:36864
v_mfma_f32_16x16x32_bf16 v[152:155], a[32:35], v[88:91], v[152:155]
ds_read_b64_tr_b16 a[194:195], v242 offset:38912
ds_read_b64_tr_b16 a[196:197], v243 offset:36864
v_mfma_f32_16x16x32_bf16 v[156:159], a[36:39], v[88:91], v[156:159]
buffer_load_dwordx4 v51, s[28:31], s3 offen offset:3072 lds
v_readlane_b32 s3, v13, 1
ds_read_b64_tr_b16 a[198:199], v243 offset:38912
v_mfma_f32_16x16x32_bf16 v[160:163], a[40:43], v[88:91], v[160:163]
ds_read_b64_tr_b16 a[200:201], v240 offset:40960
v_mul_f32 v221, 0xc0135761, v223
v_mfma_f32_16x16x32_bf16 v[164:167], a[44:47], v[88:91], v[164:167]
ds_read_b64_tr_b16 a[202:203], v240 offset:43008
ds_read_b64_tr_b16 a[204:205], v241 offset:40960
v_mfma_f32_16x16x32_bf16 v[168:171], a[48:51], v[88:91], v[168:171]
ds_read_b64_tr_b16 a[206:207], v241 offset:43008
v_mfma_f32_16x16x32_bf16 v[128:131], a[52:55], v[92:95], v[128:131]
buffer_load_dwordx4 v[116:119], v7, s[44:47], s59 offen offset:1024 sc1
ds_read_b64_tr_b16 a[208:209], v242 offset:40960
v_mfma_f32_16x16x32_bf16 v[132:135], a[56:59], v[92:95], v[132:135]
ds_read_b64_tr_b16 a[210:211], v242 offset:43008
ds_read_b64_tr_b16 a[212:213], v243 offset:40960
v_mfma_f32_16x16x32_bf16 v[136:139], a[60:63], v[92:95], v[136:139]
ds_read_b64_tr_b16 a[214:215], v243 offset:43008
ds_read_b64_tr_b16 a[216:217], v240 offset:45056
v_mfma_f32_16x16x32_bf16 v[140:143], a[64:67], v[92:95], v[140:143]
s_add_u32 m0, s90, 40960
s_nop 0
buffer_load_dwordx4 v48, s[28:31], s3 offen offset:0 lds
ds_read_b64_tr_b16 a[218:219], v240 offset:47104
v_mfma_f32_16x16x32_bf16 v[144:147], a[68:71], v[92:95], v[144:147]
ds_read_b64_tr_b16 a[220:221], v241 offset:45056
v_mul_f32 v220, v223, v223
v_mfma_f32_16x16x32_bf16 v[148:151], a[72:75], v[92:95], v[148:151]
ds_read_b64_tr_b16 a[222:223], v241 offset:47104
v_mfma_f32_16x16x32_bf16 v[152:155], a[76:79], v[92:95], v[152:155]
ds_read_b64_tr_b16 a[224:225], v242 offset:45056
ds_read_b64_tr_b16 a[226:227], v242 offset:47104
v_mfma_f32_16x16x32_bf16 v[156:159], a[80:83], v[92:95], v[156:159]
buffer_load_dwordx4 v49, s[28:31], s3 offen offset:1024 lds
ds_read_b64_tr_b16 a[228:229], v240 offset:49152
v_mfma_f32_16x16x32_bf16 v[160:163], a[84:87], v[92:95], v[160:163]
ds_read_b64_tr_b16 a[230:231], v240 offset:51200
ds_read_b64_tr_b16 a[232:233], v241 offset:49152
v_mfma_f32_16x16x32_bf16 v[164:167], a[88:91], v[92:95], v[164:167]
ds_read_b64_tr_b16 a[234:235], v241 offset:51200
ds_read_b64_tr_b16 a[236:237], v242 offset:49152
v_mfma_f32_16x16x32_bf16 v[168:171], a[92:95], v[92:95], v[168:171]
ds_read_b64_tr_b16 a[238:239], v242 offset:51200
v_mfma_f32_16x16x32_bf16 v[128:131], a[96:99], v[96:99], v[128:131]
s_add_u32 s59, s59, 2048
s_and_b32 s59, s59, 0x3fff
buffer_load_dwordx4 v[120:123], v7, s[44:47], s59 offen offset:0 sc1
ds_read_b64_tr_b16 a[240:241], v243 offset:49152
v_mfma_f32_16x16x32_bf16 v[132:135], a[100:103], v[96:99], v[132:135]
ds_read_b64_tr_b16 a[242:243], v243 offset:51200
ds_read_b64_tr_b16 a[244:245], v240 offset:53248
v_mfma_f32_16x16x32_bf16 v[136:139], a[104:107], v[96:99], v[136:139]
ds_read_b64_tr_b16 a[246:247], v240 offset:55296
v_mul_f32 v220, v220, v223
v_mfma_f32_16x16x32_bf16 v[140:143], a[108:111], v[96:99], v[140:143]
buffer_load_dwordx4 v50, s[28:31], s3 offen offset:2048 lds
ds_read_b64_tr_b16 a[248:249], v241 offset:53248
v_mfma_f32_16x16x32_bf16 v[144:147], a[112:115], v[96:99], v[144:147]
ds_read_b64_tr_b16 a[250:251], v241 offset:55296
ds_read_b64_tr_b16 a[252:253], v242 offset:53248
v_mfma_f32_16x16x32_bf16 v[148:151], a[116:119], v[96:99], v[148:151]
ds_read_b64_tr_b16 a[254:255], v242 offset:55296
v_mfma_f32_16x16x32_bf16 v[152:155], a[120:123], v[96:99], v[152:155]
ds_read_b64_tr_b16 a[0:1], v243 offset:53248
ds_read_b64_tr_b16 a[2:3], v243 offset:55296
v_mfma_f32_16x16x32_bf16 v[156:159], a[124:127], v[96:99], v[156:159]
buffer_load_dwordx4 v51, s[28:31], s3 offen offset:3072 lds
v_readlane_b32 s3, v13, 2
ds_read_b64_tr_b16 a[4:5], v240 offset:57344
v_mfma_f32_16x16x32_bf16 v[160:163], a[128:131], v[96:99], v[160:163]
ds_read_b64_tr_b16 a[6:7], v240 offset:59392
ds_read_b64_tr_b16 a[8:9], v241 offset:57344
v_mfma_f32_16x16x32_bf16 v[164:167], a[132:135], v[96:99], v[164:167]
ds_read_b64_tr_b16 a[10:11], v241 offset:59392
v_mul_f32 v220, 0xbdd2d3e8, v220
v_mfma_f32_16x16x32_bf16 v[168:171], a[136:139], v[96:99], v[168:171]
s_waitcnt vmcnt(12)
s_waitcnt lgkmcnt(7)
s_barrier
v_mfma_f32_16x16x32_bf16 v[128:131], a[140:143], v[100:103], v[128:131]
buffer_load_dword v251, v235, s[28:31], 0 offen offset:384
buffer_load_dwordx4 v[124:127], v7, s[44:47], s59 offen offset:1024 sc1
ds_read_b64_tr_b16 a[12:13], v242 offset:57344
v_mfma_f32_16x16x32_bf16 v[132:135], a[144:147], v[100:103], v[132:135]
ds_read_b64_tr_b16 a[14:15], v242 offset:59392
ds_read_b64_tr_b16 a[16:17], v244 offset:0
v_mfma_f32_16x16x32_bf16 v[136:139], a[148:151], v[100:103], v[136:139]
ds_read_b64_tr_b16 a[18:19], v244 offset:2048
ds_read_b64_tr_b16 a[20:21], v245 offset:0
v_mfma_f32_16x16x32_bf16 v[140:143], a[152:155], v[100:103], v[140:143]
s_add_u32 m0, s90, 57344
s_nop 0
buffer_load_dwordx4 v48, s[28:31], s3 offen offset:0 lds
ds_read_b64_tr_b16 a[22:23], v245 offset:2048
v_mfma_f32_16x16x32_bf16 v[144:147], a[156:159], v[100:103], v[144:147]
ds_read_b64_tr_b16 a[24:25], v246 offset:0
ds_read_b64_tr_b16 a[26:27], v246 offset:2048
v_mfma_f32_16x16x32_bf16 v[148:151], a[160:163], v[100:103], v[148:151]
ds_read_b64_tr_b16 a[28:29], v247 offset:0
v_mfma_f32_16x16x32_bf16 v[152:155], a[164:167], v[100:103], v[152:155]
ds_read_b64_tr_b16 a[30:31], v247 offset:2048
ds_read_b64_tr_b16 a[32:33], v244 offset:4096
v_mfma_f32_16x16x32_bf16 v[156:159], a[168:171], v[100:103], v[156:159]
buffer_load_dwordx4 v49, s[28:31], s3 offen offset:1024 lds
ds_read_b64_tr_b16 a[34:35], v244 offset:6144
v_mfma_f32_16x16x32_bf16 v[160:163], a[172:175], v[100:103], v[160:163]
ds_read_b64_tr_b16 a[36:37], v245 offset:4096
ds_read_b64_tr_b16 a[38:39], v245 offset:6144
v_mfma_f32_16x16x32_bf16 v[164:167], a[176:179], v[100:103], v[164:167]
ds_read_b64_tr_b16 a[40:41], v246 offset:4096
v_mfma_f32_16x16x32_bf16 v[168:171], a[180:183], v[100:103], v[168:171]
ds_read_b64_tr_b16 a[42:43], v246 offset:6144
v_mfma_f32_16x16x32_bf16 v[128:131], a[184:187], v[104:107], v[128:131]
buffer_load_dwordx4 v50, s[28:31], s3 offen offset:2048 lds
ds_read_b64_tr_b16 a[44:45], v247 offset:4096
v_mfma_f32_16x16x32_bf16 v[132:135], a[188:191], v[104:107], v[132:135]
ds_read_b64_tr_b16 a[46:47], v247 offset:6144
ds_read_b64_tr_b16 a[48:49], v244 offset:8192
v_mfma_f32_16x16x32_bf16 v[136:139], a[192:195], v[104:107], v[136:139]
ds_read_b64_tr_b16 a[50:51], v244 offset:10240
ds_read_b64_tr_b16 a[52:53], v245 offset:8192
v_mfma_f32_16x16x32_bf16 v[140:143], a[196:199], v[104:107], v[140:143]
buffer_load_dwordx4 v51, s[28:31], s3 offen offset:3072 lds
v_readlane_b32 s3, v13, 3
ds_read_b64_tr_b16 a[54:55], v245 offset:10240
v_mfma_f32_16x16x32_bf16 v[144:147], a[200:203], v[104:107], v[144:147]
ds_read_b64_tr_b16 a[56:57], v246 offset:8192
ds_read_b64_tr_b16 a[58:59], v246 offset:10240
v_mfma_f32_16x16x32_bf16 v[148:151], a[204:207], v[104:107], v[148:151]
ds_read_b64_tr_b16 a[60:61], v244 offset:12288
v_mfma_f32_16x16x32_bf16 v[152:155], a[208:211], v[104:107], v[152:155]
ds_read_b64_tr_b16 a[62:63], v244 offset:14336
ds_read_b64_tr_b16 a[64:65], v245 offset:12288
v_mfma_f32_16x16x32_bf16 v[156:159], a[212:215], v[104:107], v[156:159]
s_add_u32 m0, s90, 73728
s_nop 0
buffer_load_dwordx4 v48, s[28:31], s3 offen offset:0 lds
ds_read_b64_tr_b16 a[66:67], v245 offset:14336
v_mfma_f32_16x16x32_bf16 v[160:163], a[216:219], v[104:107], v[160:163]
ds_read_b64_tr_b16 a[68:69], v246 offset:12288
ds_read_b64_tr_b16 a[70:71], v246 offset:14336
v_mfma_f32_16x16x32_bf16 v[164:167], a[220:223], v[104:107], v[164:167]
ds_read_b64_tr_b16 a[72:73], v247 offset:12288
v_mfma_f32_16x16x32_bf16 v[168:171], a[224:227], v[104:107], v[168:171]
ds_read_b64_tr_b16 a[74:75], v247 offset:14336
s_waitcnt vmcnt(18)
v_mfma_f32_16x16x32_bf16 v[128:131], a[228:231], v[108:111], v[128:131]
buffer_load_dwordx4 v49, s[28:31], s3 offen offset:1024 lds
ds_read_b64_tr_b16 a[76:77], v244 offset:16384
v_mfma_f32_16x16x32_bf16 v[132:135], a[232:235], v[108:111], v[132:135]
ds_read_b64_tr_b16 a[78:79], v244 offset:18432
ds_read_b64_tr_b16 a[80:81], v245 offset:16384
v_mfma_f32_16x16x32_bf16 v[136:139], a[236:239], v[108:111], v[136:139]
ds_read_b64_tr_b16 a[82:83], v245 offset:18432
ds_read_b64_tr_b16 a[84:85], v246 offset:16384
v_mfma_f32_16x16x32_bf16 v[140:143], a[240:243], v[108:111], v[140:143]
buffer_load_dwordx4 v50, s[28:31], s3 offen offset:2048 lds
ds_read_b64_tr_b16 a[86:87], v246 offset:18432
v_mfma_f32_16x16x32_bf16 v[144:147], a[244:247], v[108:111], v[144:147]
ds_read_b64_tr_b16 a[88:89], v247 offset:16384
ds_read_b64_tr_b16 a[90:91], v247 offset:18432
v_mfma_f32_16x16x32_bf16 v[148:151], a[248:251], v[108:111], v[148:151]
ds_read_b64_tr_b16 a[92:93], v244 offset:20480
s_waitcnt lgkmcnt(15)
v_mfma_f32_16x16x32_bf16 v[152:155], a[252:255], v[108:111], v[152:155]
ds_read_b64_tr_b16 a[94:95], v244 offset:22528
ds_read_b64_tr_b16 a[96:97], v245 offset:20480
v_mfma_f32_16x16x32_bf16 v[156:159], a[0:3], v[108:111], v[156:159]
buffer_load_dwordx4 v51, s[28:31], s3 offen offset:3072 lds
v_readlane_b32 s3, v13, 4
ds_read_b64_tr_b16 a[98:99], v245 offset:22528
v_mfma_f32_16x16x32_bf16 v[160:163], a[4:7], v[108:111], v[160:163]
ds_read_b64_tr_b16 a[100:101], v246 offset:20480
ds_read_b64_tr_b16 a[102:103], v246 offset:22528
v_mfma_f32_16x16x32_bf16 v[164:167], a[8:11], v[108:111], v[164:167]
ds_read_b64_tr_b16 a[104:105], v236 offset:0
v_mfma_f32_16x16x32_bf16 v[168:171], a[12:15], v[108:111], v[168:171]
s_waitcnt vmcnt(12) lgkmcnt(7)
s_barrier
v_mfma_f32_16x16x32_bf16 v[128:131], a[16:19], v[112:115], v[128:131]
s_add_u32 m0, s90, 90112
s_nop 0
buffer_load_dwordx4 v48, s[28:31], s3 offen offset:0 lds
ds_read_b64_tr_b16 a[106:107], v236 offset:2048
v_mfma_f32_16x16x32_bf16 v[132:135], a[20:23], v[112:115], v[132:135]
ds_read_b64_tr_b16 a[108:109], v237 offset:0
ds_read_b64_tr_b16 a[110:111], v237 offset:2048
v_mfma_f32_16x16x32_bf16 v[136:139], a[24:27], v[112:115], v[136:139]
ds_read_b64_tr_b16 a[112:113], v238 offset:0
v_mfma_f32_16x16x32_bf16 v[140:143], a[28:31], v[112:115], v[140:143]
buffer_load_dwordx4 v49, s[28:31], s3 offen offset:1024 lds
ds_read_b64_tr_b16 a[114:115], v238 offset:2048
v_mfma_f32_16x16x32_bf16 v[144:147], a[32:35], v[112:115], v[144:147]
ds_read_b64_tr_b16 a[116:117], v239 offset:0
ds_read_b64_tr_b16 a[118:119], v239 offset:2048
v_mfma_f32_16x16x32_bf16 v[148:151], a[36:39], v[112:115], v[148:151]
ds_read_b64_tr_b16 a[120:121], v236 offset:4096
v_mfma_f32_16x16x32_bf16 v[152:155], a[40:43], v[112:115], v[152:155]
ds_read_b64_tr_b16 a[122:123], v236 offset:6144
ds_read_b64_tr_b16 a[124:125], v237 offset:4096
v_mfma_f32_16x16x32_bf16 v[156:159], a[44:47], v[112:115], v[156:159]
buffer_load_dwordx4 v50, s[28:31], s3 offen offset:2048 lds
ds_read_b64_tr_b16 a[126:127], v237 offset:6144
v_mfma_f32_16x16x32_bf16 v[160:163], a[48:51], v[112:115], v[160:163]
ds_read_b64_tr_b16 a[128:129], v238 offset:4096
ds_read_b64_tr_b16 a[130:131], v238 offset:6144
v_mfma_f32_16x16x32_bf16 v[164:167], a[52:55], v[112:115], v[164:167]
ds_read_b64_tr_b16 a[132:133], v239 offset:4096
ds_read_b64_tr_b16 a[134:135], v239 offset:6144
v_mfma_f32_16x16x32_bf16 v[168:171], a[56:59], v[112:115], v[168:171]
ds_read_b64_tr_b16 a[136:137], v236 offset:8192
v_mfma_f32_16x16x32_bf16 v[128:131], a[60:63], v[116:119], v[128:131]
buffer_load_dwordx4 v51, s[28:31], s3 offen offset:3072 lds
v_readlane_b32 s3, v13, 5
ds_read_b64_tr_b16 a[138:139], v236 offset:10240
v_mfma_f32_16x16x32_bf16 v[132:135], a[64:67], v[116:119], v[132:135]
ds_read_b64_tr_b16 a[140:141], v237 offset:8192
ds_read_b64_tr_b16 a[142:143], v237 offset:10240
v_mfma_f32_16x16x32_bf16 v[136:139], a[68:71], v[116:119], v[136:139]
ds_read_b64_tr_b16 a[144:145], v238 offset:8192
ds_read_b64_tr_b16 a[146:147], v238 offset:10240
v_mfma_f32_16x16x32_bf16 v[140:143], a[72:75], v[116:119], v[140:143]
s_add_u32 m0, s90, 106496
s_nop 0
buffer_load_dwordx4 v48, s[28:31], s3 offen offset:0 lds
ds_read_b64_tr_b16 a[148:149], v236 offset:12288
v_mfma_f32_16x16x32_bf16 v[144:147], a[76:79], v[116:119], v[144:147]
ds_read_b64_tr_b16 a[150:151], v236 offset:14336
ds_read_b64_tr_b16 a[152:153], v237 offset:12288
v_mfma_f32_16x16x32_bf16 v[148:151], a[80:83], v[116:119], v[148:151]
s_waitcnt vmcnt(13)
s_add_u32 s57, s61, 2295808
s_mov_b64 exec, 1
buffer_store_dwordx2 v[8:9], v10, s[44:47], s57 offen sc1
s_mov_b64 exec, -1
ds_read_b64_tr_b16 a[154:155], v237 offset:14336
s_waitcnt lgkmcnt(15)
v_mfma_f32_16x16x32_bf16 v[152:155], a[84:87], v[116:119], v[152:155]
ds_read_b64_tr_b16 a[156:157], v238 offset:12288
ds_read_b64_tr_b16 a[158:159], v238 offset:14336
v_mfma_f32_16x16x32_bf16 v[156:159], a[88:91], v[116:119], v[156:159]
buffer_load_dwordx4 v49, s[28:31], s3 offen offset:1024 lds
ds_read_b64_tr_b16 a[160:161], v239 offset:12288
v_mfma_f32_16x16x32_bf16 v[160:163], a[92:95], v[116:119], v[160:163]
ds_read_b64_tr_b16 a[162:163], v239 offset:14336
ds_read_b64_tr_b16 a[164:165], v236 offset:16384
v_mfma_f32_16x16x32_bf16 v[164:167], a[96:99], v[116:119], v[164:167]
ds_read_b64_tr_b16 a[166:167], v236 offset:18432
ds_read_b64_tr_b16 a[168:169], v237 offset:16384
v_mfma_f32_16x16x32_bf16 v[168:171], a[100:103], v[116:119], v[168:171]
ds_read_b64_tr_b16 a[170:171], v237 offset:18432
s_waitcnt lgkmcnt(15)
v_mfma_f32_16x16x32_bf16 v[128:131], a[104:107], v[120:123], v[128:131]
buffer_load_dwordx4 v50, s[28:31], s3 offen offset:2048 lds
ds_read_b64_tr_b16 a[172:173], v238 offset:16384
v_mfma_f32_16x16x32_bf16 v[132:135], a[108:111], v[120:123], v[132:135]
ds_read_b64_tr_b16 a[174:175], v238 offset:18432
ds_read_b64_tr_b16 a[176:177], v239 offset:16384
v_mfma_f32_16x16x32_bf16 v[136:139], a[112:115], v[120:123], v[136:139]
ds_read_b64_tr_b16 a[178:179], v239 offset:18432
ds_read_b64_tr_b16 a[180:181], v236 offset:20480
v_mfma_f32_16x16x32_bf16 v[140:143], a[116:119], v[120:123], v[140:143]
buffer_load_dwordx4 v51, s[28:31], s3 offen offset:3072 lds
v_readlane_b32 s3, v13, 6
ds_read_b64_tr_b16 a[182:183], v236 offset:22528
v_mfma_f32_16x16x32_bf16 v[144:147], a[120:123], v[120:123], v[144:147]
ds_read_b64_tr_b16 a[184:185], v237 offset:20480
ds_read_b64_tr_b16 a[186:187], v237 offset:22528
v_mfma_f32_16x16x32_bf16 v[148:151], a[124:127], v[120:123], v[148:151]
ds_read_b64_tr_b16 a[188:189], v238 offset:20480
s_waitcnt lgkmcnt(15)
v_mfma_f32_16x16x32_bf16 v[152:155], a[128:131], v[120:123], v[152:155]
ds_read_b64_tr_b16 a[190:191], v238 offset:22528
ds_read_b64_tr_b16 a[192:193], v236 offset:24576
v_mfma_f32_16x16x32_bf16 v[156:159], a[132:135], v[120:123], v[156:159]
ds_read_b64_tr_b16 a[194:195], v236 offset:26624
v_mfma_f32_16x16x32_bf16 v[160:163], a[136:139], v[120:123], v[160:163]
ds_read_b64_tr_b16 a[196:197], v237 offset:24576
v_mfma_f32_16x16x32_bf16 v[164:167], a[140:143], v[120:123], v[164:167]
ds_read_b64_tr_b16 a[198:199], v237 offset:26624
v_mfma_f32_16x16x32_bf16 v[168:171], a[144:147], v[120:123], v[168:171]
s_waitcnt vmcnt(12) lgkmcnt(7)
s_barrier
v_mfma_f32_16x16x32_bf16 v[128:131], a[148:151], v[124:127], v[128:131]
s_add_u32 m0, s90, 122880
s_nop 0
buffer_load_dwordx4 v48, s[28:31], s3 offen offset:0 lds
ds_read_b64_tr_b16 a[200:201], v238 offset:24576
v_mfma_f32_16x16x32_bf16 v[132:135], a[152:155], v[124:127], v[132:135]
ds_read_b64_tr_b16 a[202:203], v238 offset:26624
v_mfma_f32_16x16x32_bf16 v[136:139], a[156:159], v[124:127], v[136:139]
ds_read_b64_tr_b16 a[204:205], v239 offset:24576
v_mfma_f32_16x16x32_bf16 v[140:143], a[160:163], v[124:127], v[140:143]
buffer_load_dwordx4 v49, s[28:31], s3 offen offset:1024 lds
ds_read_b64_tr_b16 a[206:207], v239 offset:26624
v_mfma_f32_16x16x32_bf16 v[144:147], a[164:167], v[124:127], v[144:147]
ds_read_b64_tr_b16 a[208:209], v236 offset:28672
v_mfma_f32_16x16x32_bf16 v[148:151], a[168:171], v[124:127], v[148:151]
ds_read_b64_tr_b16 a[210:211], v236 offset:30720
s_waitcnt lgkmcnt(10)
v_mfma_f32_16x16x32_bf16 v[152:155], a[172:175], v[124:127], v[152:155]
ds_read_b64_tr_b16 a[212:213], v237 offset:28672
v_mfma_f32_16x16x32_bf16 v[156:159], a[176:179], v[124:127], v[156:159]
buffer_load_dwordx4 v50, s[28:31], s3 offen offset:2048 lds
ds_read_b64_tr_b16 a[214:215], v237 offset:30720
v_mfma_f32_16x16x32_bf16 v[160:163], a[180:183], v[124:127], v[160:163]
ds_read_b64_tr_b16 a[216:217], v238 offset:28672
v_mfma_f32_16x16x32_bf16 v[164:167], a[184:187], v[124:127], v[164:167]
ds_read_b64_tr_b16 a[218:219], v238 offset:30720
v_mfma_f32_16x16x32_bf16 v[168:171], a[188:191], v[124:127], v[168:171]
ds_read_b64_tr_b16 a[220:221], v239 offset:28672
s_waitcnt vmcnt(12)
s_waitcnt lgkmcnt(0)
s_barrier
s_mov_b32 s58, 2295808
s_mov_b64 exec, s[100:101]
buffer_load_dwordx2 v[200:201], v11, s[44:47], s58 offen sc1
s_mov_b64 exec, -1
v_pk_mul_f32 v[172:173], v[160:161], v[160:161]
v_pk_mul_f32 v[174:175], v[162:163], v[162:163]
v_pk_mul_f32 v[176:177], v[164:165], v[164:165]
v_pk_mul_f32 v[178:179], v[166:167], v[166:167]
v_pk_fma_f32 v[172:173], v[172:173], v[220:221], v[220:221] op_sel:[0,0,1] op_sel_hi:[1,0,1]
v_pk_fma_f32 v[174:175], v[174:175], v[220:221], v[220:221] op_sel:[0,0,1] op_sel_hi:[1,0,1]
v_pk_fma_f32 v[176:177], v[176:177], v[220:221], v[220:221] op_sel:[0,0,1] op_sel_hi:[1,0,1]
v_pk_fma_f32 v[178:179], v[178:179], v[220:221], v[220:221] op_sel:[0,0,1] op_sel_hi:[1,0,1]
v_pk_mul_f32 v[172:173], v[172:173], v[160:161]
v_pk_mul_f32 v[174:175], v[174:175], v[162:163]
v_pk_mul_f32 v[176:177], v[176:177], v[164:165]
v_pk_mul_f32 v[178:179], v[178:179], v[166:167]
v_exp_f32 v172, v172
v_exp_f32 v173, v173
v_exp_f32 v174, v174
v_exp_f32 v175, v175
v_exp_f32 v176, v176
v_exp_f32 v177, v177
v_exp_f32 v178, v178
v_exp_f32 v179, v179
buffer_load_dwordx4 v51, s[28:31], s3 offen offset:3072 lds
v_readlane_b32 s3, v13, 7
v_pk_fma_f32 v[172:173], v[172:173], v[222:223], v[222:223] op_sel:[0,0,0] op_sel_hi:[1,0,0]
v_pk_fma_f32 v[174:175], v[174:175], v[222:223], v[222:223] op_sel:[0,0,0] op_sel_hi:[1,0,0]
v_pk_fma_f32 v[176:177], v[176:177], v[222:223], v[222:223] op_sel:[0,0,0] op_sel_hi:[1,0,0]
v_pk_fma_f32 v[178:179], v[178:179], v[222:223], v[222:223] op_sel:[0,0,0] op_sel_hi:[1,0,0]
v_rcp_f32 v172, v172
v_rcp_f32 v173, v173
v_rcp_f32 v174, v174
v_rcp_f32 v175, v175
v_rcp_f32 v176, v176
v_rcp_f32 v177, v177
v_rcp_f32 v178, v178
v_rcp_f32 v179, v179
v_pk_mul_f32 v[172:173], v[172:173], v[160:161]
v_pk_mul_f32 v[174:175], v[174:175], v[162:163]
v_pk_mul_f32 v[176:177], v[176:177], v[164:165]
v_pk_mul_f32 v[178:179], v[178:179], v[166:167]
v_cvt_pk_bf16_f32 v80, v172, v173
v_cvt_pk_bf16_f32 v81, v174, v175
v_cvt_pk_bf16_f32 v82, v176, v177
v_cvt_pk_bf16_f32 v83, v178, v179
s_add_u32 m0, s90, 139264
s_nop 0
buffer_load_dwordx4 v48, s[28:31], s3 offen offset:0 lds
buffer_store_dwordx4 v[80:83], v12, s[44:47], s36 offen offset:0 sc1
v_pk_mul_f32 v[180:181], v[128:129], v[128:129]
v_pk_mul_f32 v[182:183], v[130:131], v[130:131]
v_pk_mul_f32 v[184:185], v[132:133], v[132:133]
v_pk_mul_f32 v[186:187], v[134:135], v[134:135]
v_pk_fma_f32 v[180:181], v[180:181], v[220:221], v[220:221] op_sel:[0,0,1] op_sel_hi:[1,0,1]
v_pk_fma_f32 v[182:183], v[182:183], v[220:221], v[220:221] op_sel:[0,0,1] op_sel_hi:[1,0,1]
v_pk_fma_f32 v[184:185], v[184:185], v[220:221], v[220:221] op_sel:[0,0,1] op_sel_hi:[1,0,1]
v_pk_fma_f32 v[186:187], v[186:187], v[220:221], v[220:221] op_sel:[0,0,1] op_sel_hi:[1,0,1]
v_pk_mul_f32 v[180:181], v[180:181], v[128:129]
v_pk_mul_f32 v[182:183], v[182:183], v[130:131]
v_pk_mul_f32 v[184:185], v[184:185], v[132:133]
v_pk_mul_f32 v[186:187], v[186:187], v[134:135]
v_exp_f32 v180, v180
v_exp_f32 v181, v181
v_exp_f32 v182, v182
v_exp_f32 v183, v183
v_exp_f32 v184, v184
v_exp_f32 v185, v185
v_exp_f32 v186, v186
v_exp_f32 v187, v187
buffer_load_dwordx4 v49, s[28:31], s3 offen offset:1024 lds
v_pk_fma_f32 v[180:181], v[180:181], v[222:223], v[222:223] op_sel:[0,0,0] op_sel_hi:[1,0,0]
v_pk_fma_f32 v[182:183], v[182:183], v[222:223], v[222:223] op_sel:[0,0,0] op_sel_hi:[1,0,0]
v_pk_fma_f32 v[184:185], v[184:185], v[222:223], v[222:223] op_sel:[0,0,0] op_sel_hi:[1,0,0]
v_pk_fma_f32 v[186:187], v[186:187], v[222:223], v[222:223] op_sel:[0,0,0] op_sel_hi:[1,0,0]
v_rcp_f32 v180, v180
v_rcp_f32 v181, v181
v_rcp_f32 v182, v182
v_rcp_f32 v183, v183
v_rcp_f32 v184, v184
v_rcp_f32 v185, v185
v_rcp_f32 v186, v186
v_rcp_f32 v187, v187
v_pk_mul_f32 v[180:181], v[180:181], v[128:129]
v_pk_mul_f32 v[182:183], v[182:183], v[130:131]
v_pk_mul_f32 v[184:185], v[184:185], v[132:133]
v_pk_mul_f32 v[186:187], v[186:187], v[134:135]
v_cvt_pk_bf16_f32 v64, v180, v181
v_cvt_pk_bf16_f32 v65, v182, v183
v_cvt_pk_bf16_f32 v66, v184, v185
v_cvt_pk_bf16_f32 v67, v186, v187
buffer_load_dwordx4 v50, s[28:31], s3 offen offset:2048 lds
s_add_u32 s36, s62, 2141184
buffer_store_dwordx4 v[64:67], v12, s[44:47], s36 offen offset:0 sc1
v_pk_mul_f32 v[172:173], v[136:137], v[136:137]
v_pk_mul_f32 v[174:175], v[138:139], v[138:139]
v_pk_mul_f32 v[176:177], v[140:141], v[140:141]
v_pk_mul_f32 v[178:179], v[142:143], v[142:143]
v_pk_fma_f32 v[172:173], v[172:173], v[220:221], v[220:221] op_sel:[0,0,1] op_sel_hi:[1,0,1]
v_pk_fma_f32 v[174:175], v[174:175], v[220:221], v[220:221] op_sel:[0,0,1] op_sel_hi:[1,0,1]
v_pk_fma_f32 v[176:177], v[176:177], v[220:221], v[220:221] op_sel:[0,0,1] op_sel_hi:[1,0,1]
v_pk_fma_f32 v[178:179], v[178:179], v[220:221], v[220:221] op_sel:[0,0,1] op_sel_hi:[1,0,1]
v_pk_mul_f32 v[172:173], v[172:173], v[136:137]
v_pk_mul_f32 v[174:175], v[174:175], v[138:139]
v_pk_mul_f32 v[176:177], v[176:177], v[140:141]
v_pk_mul_f32 v[178:179], v[178:179], v[142:143]
v_exp_f32 v172, v172
v_exp_f32 v173, v173
v_exp_f32 v174, v174
v_exp_f32 v175, v175
v_exp_f32 v176, v176
v_exp_f32 v177, v177
v_exp_f32 v178, v178
v_exp_f32 v179, v179
buffer_load_dwordx4 v51, s[28:31], s3 offen offset:3072 lds
v_readlane_b32 s3, v13, 8
v_pk_fma_f32 v[172:173], v[172:173], v[222:223], v[222:223] op_sel:[0,0,0] op_sel_hi:[1,0,0]
v_pk_fma_f32 v[174:175], v[174:175], v[222:223], v[222:223] op_sel:[0,0,0] op_sel_hi:[1,0,0]
v_pk_fma_f32 v[176:177], v[176:177], v[222:223], v[222:223] op_sel:[0,0,0] op_sel_hi:[1,0,0]
v_pk_fma_f32 v[178:179], v[178:179], v[222:223], v[222:223] op_sel:[0,0,0] op_sel_hi:[1,0,0]
v_rcp_f32 v172, v172
v_rcp_f32 v173, v173
v_rcp_f32 v174, v174
v_rcp_f32 v175, v175
v_rcp_f32 v176, v176
v_rcp_f32 v177, v177
v_rcp_f32 v178, v178
v_rcp_f32 v179, v179
v_pk_mul_f32 v[172:173], v[172:173], v[136:137]
v_pk_mul_f32 v[174:175], v[174:175], v[138:139]
v_pk_mul_f32 v[176:177], v[176:177], v[140:141]
v_pk_mul_f32 v[178:179], v[178:179], v[142:143]
v_cvt_pk_bf16_f32 v68, v172, v173
v_cvt_pk_bf16_f32 v69, v174, v175
v_cvt_pk_bf16_f32 v70, v176, v177
v_cvt_pk_bf16_f32 v71, v178, v179
s_add_u32 m0, s90, 0
s_nop 0
buffer_load_dwordx4 v48, s[28:31], s3 offen offset:0 lds
buffer_store_dwordx4 v[68:71], v12, s[44:47], s36 offen offset:1024 sc1
v_pk_mul_f32 v[180:181], v[144:145], v[144:145]
v_pk_mul_f32 v[182:183], v[146:147], v[146:147]
v_pk_mul_f32 v[184:185], v[148:149], v[148:149]
v_pk_mul_f32 v[186:187], v[150:151], v[150:151]
v_pk_fma_f32 v[180:181], v[180:181], v[220:221], v[220:221] op_sel:[0,0,1] op_sel_hi:[1,0,1]
v_pk_fma_f32 v[182:183], v[182:183], v[220:221], v[220:221] op_sel:[0,0,1] op_sel_hi:[1,0,1]
v_pk_fma_f32 v[184:185], v[184:185], v[220:221], v[220:221] op_sel:[0,0,1] op_sel_hi:[1,0,1]
v_pk_fma_f32 v[186:187], v[186:187], v[220:221], v[220:221] op_sel:[0,0,1] op_sel_hi:[1,0,1]
v_pk_mul_f32 v[180:181], v[180:181], v[144:145]
v_pk_mul_f32 v[182:183], v[182:183], v[146:147]
v_pk_mul_f32 v[184:185], v[184:185], v[148:149]
v_pk_mul_f32 v[186:187], v[186:187], v[150:151]
v_exp_f32 v180, v180
v_exp_f32 v181, v181
v_exp_f32 v182, v182
v_exp_f32 v183, v183
v_exp_f32 v184, v184
v_exp_f32 v185, v185
v_exp_f32 v186, v186
v_exp_f32 v187, v187
buffer_load_dwordx4 v49, s[28:31], s3 offen offset:1024 lds
v_pk_fma_f32 v[180:181], v[180:181], v[222:223], v[222:223] op_sel:[0,0,0] op_sel_hi:[1,0,0]
v_pk_fma_f32 v[182:183], v[182:183], v[222:223], v[222:223] op_sel:[0,0,0] op_sel_hi:[1,0,0]
v_pk_fma_f32 v[184:185], v[184:185], v[222:223], v[222:223] op_sel:[0,0,0] op_sel_hi:[1,0,0]
v_pk_fma_f32 v[186:187], v[186:187], v[222:223], v[222:223] op_sel:[0,0,0] op_sel_hi:[1,0,0]
v_rcp_f32 v180, v180
v_rcp_f32 v181, v181
v_rcp_f32 v182, v182
v_rcp_f32 v183, v183
v_rcp_f32 v184, v184
v_rcp_f32 v185, v185
v_rcp_f32 v186, v186
v_rcp_f32 v187, v187
v_pk_mul_f32 v[180:181], v[180:181], v[144:145]
v_pk_mul_f32 v[182:183], v[182:183], v[146:147]
v_pk_mul_f32 v[184:185], v[184:185], v[148:149]
v_pk_mul_f32 v[186:187], v[186:187], v[150:151]
v_cvt_pk_bf16_f32 v72, v180, v181
v_cvt_pk_bf16_f32 v73, v182, v183
v_cvt_pk_bf16_f32 v74, v184, v185
v_cvt_pk_bf16_f32 v75, v186, v187
buffer_load_dwordx4 v50, s[28:31], s3 offen offset:2048 lds
s_add_u32 s36, s62, 2097152
s_mov_b64 exec, s[100:101]
s_waitcnt vmcnt(11)
v_cmp_ne_u32 vcc, v201, v9
s_cbranch_vccz go_46
retry_47:
s_sub_u32 s56, s56, 1
s_cbranch_scc1 L_end
buffer_load_dwordx2 v[200:201], v11, s[44:47], s58 offen sc1
s_waitcnt vmcnt(0)
v_cmp_ne_u32 vcc, v201, v9
s_cbranch_vccnz retry_47
go_46:
s_mov_b64 exec, -1
buffer_store_dwordx4 v[72:75], v12, s[44:47], s36 offen offset:0 sc1
v_pk_mul_f32 v[172:173], v[152:153], v[152:153]
v_pk_mul_f32 v[174:175], v[154:155], v[154:155]
v_pk_mul_f32 v[176:177], v[156:157], v[156:157]
v_pk_mul_f32 v[178:179], v[158:159], v[158:159]
v_pk_fma_f32 v[172:173], v[172:173], v[220:221], v[220:221] op_sel:[0,0,1] op_sel_hi:[1,0,1]
v_pk_fma_f32 v[174:175], v[174:175], v[220:221], v[220:221] op_sel:[0,0,1] op_sel_hi:[1,0,1]
v_pk_fma_f32 v[176:177], v[176:177], v[220:221], v[220:221] op_sel:[0,0,1] op_sel_hi:[1,0,1]
v_pk_fma_f32 v[178:179], v[178:179], v[220:221], v[220:221] op_sel:[0,0,1] op_sel_hi:[1,0,1]
v_pk_mul_f32 v[172:173], v[172:173], v[152:153]
v_pk_mul_f32 v[174:175], v[174:175], v[154:155]
v_pk_mul_f32 v[176:177], v[176:177], v[156:157]
v_pk_mul_f32 v[178:179], v[178:179], v[158:159]
v_exp_f32 v172, v172
v_exp_f32 v173, v173
v_exp_f32 v174, v174
v_exp_f32 v175, v175
v_exp_f32 v176, v176
v_exp_f32 v177, v177
v_exp_f32 v178, v178
v_exp_f32 v179, v179
buffer_load_dwordx4 v51, s[28:31], s3 offen offset:3072 lds
v_readlane_b32 s3, v13, 9
v_pk_fma_f32 v[172:173], v[172:173], v[222:223], v[222:223] op_sel:[0,0,0] op_sel_hi:[1,0,0]
v_pk_fma_f32 v[174:175], v[174:175], v[222:223], v[222:223] op_sel:[0,0,0] op_sel_hi:[1,0,0]
v_pk_fma_f32 v[176:177], v[176:177], v[222:223], v[222:223] op_sel:[0,0,0] op_sel_hi:[1,0,0]
v_pk_fma_f32 v[178:179], v[178:179], v[222:223], v[222:223] op_sel:[0,0,0] op_sel_hi:[1,0,0]
v_rcp_f32 v172, v172
v_rcp_f32 v173, v173
v_rcp_f32 v174, v174
v_rcp_f32 v175, v175
v_rcp_f32 v176, v176
v_rcp_f32 v177, v177
v_rcp_f32 v178, v178
v_rcp_f32 v179, v179
v_pk_mul_f32 v[172:173], v[172:173], v[152:153]
v_pk_mul_f32 v[174:175], v[174:175], v[154:155]
v_pk_mul_f32 v[176:177], v[176:177], v[156:157]
v_pk_mul_f32 v[178:179], v[178:179], v[158:159]
v_cvt_pk_bf16_f32 v76, v172, v173
v_cvt_pk_bf16_f32 v77, v174, v175
v_cvt_pk_bf16_f32 v78, v176, v177
v_cvt_pk_bf16_f32 v79, v178, v179
buffer_store_dwordx4 v[76:79], v12, s[44:47], s36 offen offset:1024 sc1
v_pk_mul_f32 v[172:173], v[168:169], v[168:169]
v_pk_mul_f32 v[174:175], v[170:171], v[170:171]
v_pk_fma_f32 v[172:173], v[172:173], v[220:221], v[220:221] op_sel:[0,0,1] op_sel_hi:[1,0,1]
v_pk_fma_f32 v[174:175], v[174:175], v[220:221], v[220:221] op_sel:[0,0,1] op_sel_hi:[1,0,1]
v_pk_mul_f32 v[172:173], v[172:173], v[168:169]
v_pk_mul_f32 v[174:175], v[174:175], v[170:171]
v_exp_f32 v172, v172
v_exp_f32 v173, v173
v_exp_f32 v174, v174
v_exp_f32 v175, v175
v_pk_fma_f32 v[172:173], v[172:173], v[222:223], v[222:223] op_sel:[0,0,0] op_sel_hi:[1,0,0]
v_pk_fma_f32 v[174:175], v[174:175], v[222:223], v[222:223] op_sel:[0,0,0] op_sel_hi:[1,0,0]
v_rcp_f32 v172, v172
v_rcp_f32 v173, v173
v_rcp_f32 v174, v174
v_rcp_f32 v175, v175
v_pk_mul_f32 v[172:173], v[172:173], v[168:169]
v_pk_mul_f32 v[174:175], v[174:175], v[170:171]
v_cvt_pk_bf16_f32 v196, v172, v173
v_cvt_pk_bf16_f32 v197, v174, v175
s_cmp_ge_u32 s50, 6
s_cselect_b64 exec, 0, -1
buffer_store_dwordx2 v[196:197], v12, s[44:47], s37 offen sc1
s_mov_b64 exec, -1
ds_read_b64_tr_b16 a[222:223], v239 offset:30720
ds_read_b64_tr_b16 a[224:225], v236 offset:32768
ds_read_b64_tr_b16 a[226:227], v236 offset:34816
ds_read_b64_tr_b16 a[228:229], v237 offset:32768
ds_read_b64_tr_b16 a[230:231], v237 offset:34816
ds_read_b64_tr_b16 a[232:233], v238 offset:32768
ds_read_b64_tr_b16 a[234:235], v238 offset:34816
ds_read_b64_tr_b16 a[236:237], v239 offset:32768
ds_read_b64_tr_b16 a[238:239], v239 offset:34816
ds_read_b64_tr_b16 a[240:241], v236 offset:36864
ds_read_b64_tr_b16 a[242:243], v236 offset:38912
ds_read_b64_tr_b16 a[244:245], v237 offset:36864
ds_read_b64_tr_b16 a[246:247], v237 offset:38912
ds_read_b64_tr_b16 a[248:249], v238 offset:36864
ds_read_b64_tr_b16 a[250:251], v238 offset:38912
ds_read_b64_tr_b16 a[252:253], v239 offset:36864
ds_read_b64_tr_b16 a[254:255], v239 offset:38912
ds_read_b64_tr_b16 a[0:1], v236 offset:40960
ds_read_b64_tr_b16 a[2:3], v236 offset:43008
ds_read_b64_tr_b16 a[4:5], v237 offset:40960
ds_read_b64_tr_b16 a[6:7], v237 offset:43008
ds_read_b64_tr_b16 a[8:9], v238 offset:40960
ds_read_b64_tr_b16 a[10:11], v238 offset:43008
ds_read_b64_tr_b16 a[12:13], v239 offset:40960
ds_read_b64_tr_b16 a[14:15], v239 offset:43008
ds_read_b64_tr_b16 a[16:17], v236 offset:45056
ds_read_b64_tr_b16 a[18:19], v236 offset:47104
ds_read_b64_tr_b16 a[20:21], v237 offset:45056
ds_read_b64_tr_b16 a[22:23], v237 offset:47104
ds_read_b64_tr_b16 a[24:25], v238 offset:45056
ds_read_b64_tr_b16 a[26:27], v238 offset:47104
ds_read_b64_tr_b16 a[28:29], v239 offset:45056
ds_read_b64_tr_b16 a[30:31], v239 offset:47104
ds_read_b64_tr_b16 a[32:33], v236 offset:49152
ds_read_b64_tr_b16 a[34:35], v236 offset:51200
ds_read_b64_tr_b16 a[36:37], v237 offset:49152
ds_read_b64_tr_b16 a[38:39], v237 offset:51200
ds_read_b64_tr_b16 a[40:41], v238 offset:49152
ds_read_b64_tr_b16 a[42:43], v238 offset:51200
ds_read_b64_tr_b16 a[44:45], v239 offset:49152
ds_read_b64_tr_b16 a[46:47], v239 offset:51200
ds_read_b64_tr_b16 a[48:49], v236 offset:53248
ds_read_b64_tr_b16 a[50:51], v236 offset:55296
ds_read_b64_tr_b16 a[52:53], v237 offset:53248
ds_read_b64_tr_b16 a[54:55], v237 offset:55296
ds_read_b64_tr_b16 a[56:57], v238 offset:53248
ds_read_b64_tr_b16 a[58:59], v238 offset:55296
ds_read_b64_tr_b16 a[60:61], v239 offset:53248
ds_read_b64_tr_b16 a[62:63], v239 offset:55296
ds_read_b64_tr_b16 a[64:65], v236 offset:57344
ds_read_b64_tr_b16 a[66:67], v236 offset:59392
ds_read_b64_tr_b16 a[68:69], v237 offset:57344
ds_read_b64_tr_b16 a[70:71], v237 offset:59392
ds_read_b64_tr_b16 a[72:73], v238 offset:57344
ds_read_b64_tr_b16 a[74:75], v238 offset:59392
ds_read_b64_tr_b16 a[76:77], v239 offset:57344
ds_read_b64_tr_b16 a[78:79], v239 offset:59392
ds_read_b64_tr_b16 a[80:81], v240 offset:0
ds_read_b64_tr_b16 a[82:83], v240 offset:2048
ds_read_b64_tr_b16 a[84:85], v241 offset:0
s_waitcnt vmcnt(0)
s_add_u32 s57, s61, 2362368
s_mov_b64 exec, 1
buffer_store_dwordx2 v[8:9], v10, s[44:47], s57 offen sc1
s_mov_b64 exec, -1
s_waitcnt lgkmcnt(0)
s_barrier
s_add_u32 m0, s90, 24576
s_nop 0
buffer_load_dwordx4 v48, s[28:31], s3 offen offset:0 lds
buffer_load_dwordx4 v49, s[28:31], s3 offen offset:1024 lds
ds_read_b64_tr_b16 a[86:87], v241 offset:2048
ds_read_b64_tr_b16 a[88:89], v242 offset:0
ds_read_b64_tr_b16 a[90:91], v242 offset:2048
ds_read_b64_tr_b16 a[92:93], v243 offset:0
ds_read_b64_tr_b16 a[94:95], v243 offset:2048
ds_read_b64_tr_b16 a[96:97], v240 offset:4096
ds_read_b64_tr_b16 a[98:99], v240 offset:6144
ds_read_b64_tr_b16 a[100:101], v241 offset:4096
ds_read_b64_tr_b16 a[102:103], v241 offset:6144
ds_read_b64_tr_b16 a[104:105], v242 offset:4096
ds_read_b64_tr_b16 a[106:107], v242 offset:6144
ds_read_b64_tr_b16 a[108:109], v243 offset:4096
ds_read_b64_tr_b16 a[110:111], v243 offset:6144
ds_read_b64_tr_b16 a[112:113], v240 offset:8192
ds_read_b64_tr_b16 a[114:115], v240 offset:10240
ds_read_b64_tr_b16 a[116:117], v241 offset:8192
ds_read_b64_tr_b16 a[118:119], v241 offset:10240
ds_read_b64_tr_b16 a[120:121], v242 offset:8192
s_mov_b32 s58, 2362368
s_mov_b64 exec, s[100:101]
buffer_load_dwordx2 v[200:201], v11, s[44:47], s58 offen sc1
s_mov_b64 exec, -1
buffer_load_dwordx4 v50, s[28:31], s3 offen offset:2048 lds
buffer_load_dwordx4 v51, s[28:31], s3 offen offset:3072 lds
v_readlane_b32 s3, v13, 10
s_add_u32 m0, s90, 40960
s_nop 3
buffer_load_dwordx4 v48, s[28:31], s3 offen offset:0 lds
ds_read_b64_tr_b16 a[122:123], v242 offset:10240
ds_read_b64_tr_b16 a[124:125], v243 offset:8192
ds_read_b64_tr_b16 a[126:127], v243 offset:10240
ds_read_b64_tr_b16 a[128:129], v240 offset:12288
ds_read_b64_tr_b16 a[130:131], v240 offset:14336
ds_read_b64_tr_b16 a[132:133], v241 offset:12288
ds_read_b64_tr_b16 a[134:135], v241 offset:14336
ds_read_b64_tr_b16 a[136:137], v242 offset:12288
ds_read_b64_tr_b16 a[138:139], v242 offset:14336
ds_read_b64_tr_b16 a[140:141], v243 offset:12288
ds_read_b64_tr_b16 a[142:143], v243 offset:14336
ds_read_b64_tr_b16 a[144:145], v240 offset:16384
ds_read_b64_tr_b16 a[146:147], v240 offset:18432
ds_read_b64_tr_b16 a[148:149], v241 offset:16384
ds_read_b64_tr_b16 a[150:151], v241 offset:18432
ds_read_b64_tr_b16 a[152:153], v242 offset:16384
ds_read_b64_tr_b16 a[154:155], v242 offset:18432
ds_read_b64_tr_b16 a[156:157], v243 offset:16384
ds_read_b64_tr_b16 a[158:159], v243 offset:18432
ds_read_b64_tr_b16 a[160:161], v240 offset:20480
ds_read_b64_tr_b16 a[162:163], v240 offset:22528
ds_read_b64_tr_b16 a[164:165], v241 offset:20480
ds_read_b64_tr_b16 a[166:167], v241 offset:22528
ds_read_b64_tr_b16 a[168:169], v242 offset:20480
ds_read_b64_tr_b16 a[170:171], v242 offset:22528
ds_read_b64_tr_b16 a[172:173], v243 offset:20480
ds_read_b64_tr_b16 a[174:175], v243 offset:22528
ds_read_b64_tr_b16 a[176:177], v240 offset:24576
ds_read_b64_tr_b16 a[178:179], v240 offset:26624
ds_read_b64_tr_b16 a[180:181], v241 offset:24576
ds_read_b64_tr_b16 a[182:183], v241 offset:26624
ds_read_b64_tr_b16 a[184:185], v242 offset:24576
ds_read_b64_tr_b16 a[186:187], v242 offset:26624
ds_read_b64_tr_b16 a[188:189], v243 offset:24576
ds_read_b64_tr_b16 a[190:191], v243 offset:26624
s_mov_b64 exec, s[100:101]
s_waitcnt vmcnt(3)
v_cmp_ne_u32 vcc, v201, v9
s_cbranch_vccz go_48
retry_49:
s_sub_u32 s56, s56, 1
s_cbranch_scc1 L_end
buffer_load_dwordx2 v[200:201], v11, s[44:47], s58 offen sc1
s_waitcnt vmcnt(0)
v_cmp_ne_u32 vcc, v201, v9
s_cbranch_vccnz retry_49
go_48:
s_mov_b64 exec, -1
v_add_u32 v6, 2141184, v12
v_add_u32 v7, 2097152, v12
s_mov_b32 s59, s62
s_add_u32 s59, s59, 2048
s_and_b32 s59, s59, 0x3fff
buffer_load_dwordx4 v[84:87], v6, s[44:47], s59 offen offset:0 sc1
buffer_load_dwordx4 v[88:91], v6, s[44:47], s59 offen offset:1024 sc1
buffer_load_dwordx4 v[92:95], v7, s[44:47], s59 offen offset:0 sc1
buffer_load_dwordx4 v[96:99], v7, s[44:47], s59 offen offset:1024 sc1
s_lshr_b32 s58, s59, 1
s_bitset1_b32 s58, 14
buffer_load_dwordx4 v[100:103], v7, s[44:47], s58 offen offset:0 sc1
s_add_u32 s59, s59, 2048
s_and_b32 s59, s59, 0x3fff
buffer_load_dwordx4 v[104:107], v6, s[44:47], s59 offen offset:0 sc1
v_mfma_f32_16x16x32_bf16 v[32:35], a[192:195], v[64:67], v[32:35]
buffer_load_dwordx4 v[108:111], v6, s[44:47], s59 offen offset:1024 sc1
ds_read_b64_tr_b16 a[192:193], v240 offset:28672
v_mfma_f32_16x16x32_bf16 v[36:39], a[196:199], v[64:67], v[36:39]
ds_read_b64_tr_b16 a[194:195], v240 offset:30720
v_mfma_f32_16x16x32_bf16 v[40:43], a[200:203], v[64:67], v[40:43]
buffer_load_dwordx4 v49, s[28:31], s3 offen offset:1024 lds
ds_read_b64_tr_b16 a[196:197], v241 offset:28672
v_mfma_f32_16x16x32_bf16 v[44:47], a[204:207], v[64:67], v[44:47]
ds_read_b64_tr_b16 a[198:199], v241 offset:30720
v_mfma_f32_16x16x32_bf16 v[32:35], a[208:211], v[68:71], v[32:35]
buffer_load_dwordx4 v[112:115], v7, s[44:47], s59 offen offset:0 sc1
ds_read_b64_tr_b16 a[200:201], v242 offset:28672
v_mfma_f32_16x16x32_bf16 v[36:39], a[212:215], v[68:71], v[36:39]
ds_read_b64_tr_b16 a[202:203], v242 offset:30720
ds_read_b64_tr_b16 a[204:205], v243 offset:28672
v_mfma_f32_16x16x32_bf16 v[40:43], a[216:219], v[68:71], v[40:43]
buffer_load_dwordx4 v50, s[28:31], s3 offen offset:2048 lds
ds_read_b64_tr_b16 a[206:207], v243 offset:30720
v_mfma_f32_16x16x32_bf16 v[44:47], a[220:223], v[68:71], v[44:47]
s_waitcnt vmcnt(10) lgkmcnt(7)
s_barrier
v_mfma_f32_16x16x32_bf16 v[32:35], a[224:227], v[72:75], v[32:35]
ds_read_b64_tr_b16 a[208:209], v240 offset:32768
v_mfma_f32_16x16x32_bf16 v[36:39], a[228:231], v[72:75], v[36:39]
ds_read_b64_tr_b16 a[210:211], v240 offset:34816
ds_read_b64_tr_b16 a[212:213], v241 offset:32768
v_mfma_f32_16x16x32_bf16 v[40:43], a[232:235], v[72:75], v[40:43]
buffer_load_dwordx4 v51, s[28:31], s3 offen offset:3072 lds
ds_read_b64_tr_b16 a[214:215], v241 offset:34816
v_mfma_f32_16x16x32_bf16 v[44:47], a[236:239], v[72:75], v[44:47]
ds_read_b64_tr_b16 a[216:217], v242 offset:32768
ds_read_b64_tr_b16 a[218:219], v242 offset:34816
v_mfma_f32_16x16x32_bf16 v[32:35], a[240:243], v[76:79], v[32:35]
ds_read_b64_tr_b16 a[220:221], v243 offset:32768
v_mfma_f32_16x16x32_bf16 v[36:39], a[244:247], v[76:79], v[36:39]
ds_read_b64_tr_b16 a[222:223], v243 offset:34816
ds_read_b64_tr_b16 a[224:225], v240 offset:36864
v_mfma_f32_16x16x32_bf16 v[40:43], a[248:251], v[76:79], v[40:43]
ds_read_b64_tr_b16 a[226:227], v240 offset:38912
ds_read_b64_tr_b16 a[228:229], v241 offset:36864
v_mfma_f32_16x16x32_bf16 v[44:47], a[252:255], v[76:79], v[44:47]
ds_read_b64_tr_b16 a[230:231], v241 offset:38912
v_mfma_f32_16x16x32_bf16 v[32:35], a[0:3], v[80:83], v[32:35]
ds_read_b64_tr_b16 a[232:233], v242 offset:36864
v_mfma_f32_16x16x32_bf16 v[36:39], a[4:7], v[80:83], v[36:39]
ds_read_b64_tr_b16 a[234:235], v242 offset:38912
ds_read_b64_tr_b16 a[236:237], v243 offset:36864
v_mfma_f32_16x16x32_bf16 v[40:43], a[8:11], v[80:83], v[40:43]
ds_read_b64_tr_b16 a[238:239], v243 offset:38912
ds_read_b64_tr_b16 a[240:241], v240 offset:40960
v_mfma_f32_16x16x32_bf16 v[44:47], a[12:15], v[80:83], v[44:47]
ds_read_b64_tr_b16 a[242:243], v240 offset:43008
s_waitcnt vmcnt(10)
v_mfma_f32_16x16x32_bf16 v[32:35], a[16:19], v[84:87], v[32:35]
buffer_load_dwordx4 v[116:119], v7, s[44:47], s59 offen offset:1024 sc1
ds_read_b64_tr_b16 a[244:245], v241 offset:40960
v_mfma_f32_16x16x32_bf16 v[36:39], a[20:23], v[84:87], v[36:39]
ds_read_b64_tr_b16 a[246:247], v241 offset:43008
ds_read_b64_tr_b16 a[248:249], v242 offset:40960
v_mfma_f32_16x16x32_bf16 v[40:43], a[24:27], v[84:87], v[40:43]
ds_read_b64_tr_b16 a[250:251], v242 offset:43008
v_mfma_f32_16x16x32_bf16 v[44:47], a[28:31], v[84:87], v[44:47]
ds_read_b64_tr_b16 a[252:253], v243 offset:40960
s_waitcnt vmcnt(10)
v_mfma_f32_16x16x32_bf16 v[32:35], a[32:35], v[88:91], v[32:35]
s_lshr_b32 s58, s59, 1
s_bitset1_b32 s58, 14
buffer_load_dwordx4 v[120:123], v7, s[44:47], s58 offen offset:0 sc1
ds_read_b64_tr_b16 a[254:255], v243 offset:43008
v_mfma_f32_16x16x32_bf16 v[36:39], a[36:39], v[88:91], v[36:39]
ds_read_b64_tr_b16 a[0:1], v240 offset:45056
ds_read_b64_tr_b16 a[2:3], v240 offset:47104
v_mfma_f32_16x16x32_bf16 v[40:43], a[40:43], v[88:91], v[40:43]
ds_read_b64_tr_b16 a[4:5], v241 offset:45056
ds_read_b64_tr_b16 a[6:7], v241 offset:47104
v_mfma_f32_16x16x32_bf16 v[44:47], a[44:47], v[88:91], v[44:47]
ds_read_b64_tr_b16 a[8:9], v242 offset:45056
s_waitcnt vmcnt(10)
v_mfma_f32_16x16x32_bf16 v[32:35], a[48:51], v[92:95], v[32:35]
s_add_u32 s59, s59, 2048
s_and_b32 s59, s59, 0x3fff
buffer_load_dwordx4 v[124:127], v6, s[44:47], s59 offen offset:0 sc1
ds_read_b64_tr_b16 a[10:11], v242 offset:47104
v_mfma_f32_16x16x32_bf16 v[36:39], a[52:55], v[92:95], v[36:39]
ds_read_b64_tr_b16 a[12:13], v243 offset:45056
ds_read_b64_tr_b16 a[14:15], v243 offset:47104
v_mfma_f32_16x16x32_bf16 v[40:43], a[56:59], v[92:95], v[40:43]
ds_read_b64_tr_b16 a[16:17], v240 offset:49152
v_mfma_f32_16x16x32_bf16 v[44:47], a[60:63], v[92:95], v[44:47]
ds_read_b64_tr_b16 a[18:19], v240 offset:51200
s_waitcnt vmcnt(10)
v_mfma_f32_16x16x32_bf16 v[32:35], a[64:67], v[96:99], v[32:35]
buffer_load_dwordx4 v[128:131], v6, s[44:47], s59 offen offset:1024 sc1
ds_read_b64_tr_b16 a[20:21], v241 offset:49152
v_mfma_f32_16x16x32_bf16 v[36:39], a[68:71], v[96:99], v[36:39]
ds_read_b64_tr_b16 a[22:23], v241 offset:51200
ds_read_b64_tr_b16 a[24:25], v242 offset:49152
v_mfma_f32_16x16x32_bf16 v[40:43], a[72:75], v[96:99], v[40:43]
ds_read_b64_tr_b16 a[26:27], v242 offset:51200
ds_read_b64_tr_b16 a[28:29], v243 offset:49152
v_mfma_f32_16x16x32_bf16 v[44:47], a[76:79], v[96:99], v[44:47]
ds_read_b64_tr_b16 a[30:31], v243 offset:51200
s_waitcnt vmcnt(10)
v_mfma_f32_16x16x32_bf16 v[32:35], a[80:83], v[100:103], v[32:35]
buffer_load_dwordx4 v[132:135], v7, s[44:47], s59 offen offset:0 sc1
ds_read_b64_tr_b16 a[32:33], v240 offset:53248
v_mfma_f32_16x16x32_bf16 v[36:39], a[84:87], v[100:103], v[36:39]
ds_read_b64_tr_b16 a[34:35], v240 offset:55296
ds_read_b64_tr_b16 a[36:37], v241 offset:53248
v_mfma_f32_16x16x32_bf16 v[40:43], a[88:91], v[100:103], v[40:43]
ds_read_b64_tr_b16 a[38:39], v241 offset:55296
v_mfma_f32_16x16x32_bf16 v[44:47], a[92:95], v[100:103], v[44:47]
ds_read_b64_tr_b16 a[40:41], v242 offset:53248
s_waitcnt vmcnt(10)
v_mfma_f32_16x16x32_bf16 v[32:35], a[96:99], v[104:107], v[32:35]
buffer_load_dwordx4 v[136:139], v7, s[44:47], s59 offen offset:1024 sc1
ds_read_b64_tr_b16 a[42:43], v242 offset:55296
v_mfma_f32_16x16x32_bf16 v[36:39], a[100:103], v[104:107], v[36:39]
ds_read_b64_tr_b16 a[44:45], v243 offset:53248
ds_read_b64_tr_b16 a[46:47], v243 offset:55296
v_mfma_f32_16x16x32_bf16 v[40:43], a[104:107], v[104:107], v[40:43]
ds_read_b64_tr_b16 a[48:49], v240 offset:57344
ds_read_b64_tr_b16 a[50:51], v240 offset:59392
v_mfma_f32_16x16x32_bf16 v[44:47], a[108:111], v[104:107], v[44:47]
s_waitcnt lgkmcnt(7)
s_barrier
s_waitcnt vmcnt(10)
v_mfma_f32_16x16x32_bf16 v[32:35], a[112:115], v[108:111], v[32:35]
s_lshr_b32 s58, s59, 1
s_bitset1_b32 s58, 14
buffer_load_dwordx4 v[140:143], v7, s[44:47], s58 offen offset:0 sc1
ds_read_b64_tr_b16 a[52:53], v241 offset:57344
v_mfma_f32_16x16x32_bf16 v[36:39], a[116:119], v[108:111], v[36:39]
ds_read_b64_tr_b16 a[54:55], v241 offset:59392
ds_read_b64_tr_b16 a[56:57], v242 offset:57344
v_mfma_f32_16x16x32_bf16 v[40:43], a[120:123], v[108:111], v[40:43]
ds_read_b64_tr_b16 a[58:59], v242 offset:59392
v_mfma_f32_16x16x32_bf16 v[44:47], a[124:127], v[108:111], v[44:47]
ds_read_b64_tr_b16 a[60:61], v243 offset:57344
s_waitcnt vmcnt(9)
v_mfma_f32_16x16x32_bf16 v[32:35], a[128:131], v[112:115], v[32:35]
s_add_u32 s59, s59, 2048
s_and_b32 s59, s59, 0x3fff
buffer_load_dwordx4 v[144:147], v6, s[44:47], s59 offen offset:0 sc1
ds_read_b64_tr_b16 a[62:63], v243 offset:59392
v_mfma_f32_16x16x32_bf16 v[36:39], a[132:135], v[112:115], v[36:39]
ds_read_b64_tr_b16 a[64:65], v244 offset:0
ds_read_b64_tr_b16 a[66:67], v244 offset:2048
v_mfma_f32_16x16x32_bf16 v[40:43], a[136:139], v[112:115], v[40:43]
ds_read_b64_tr_b16 a[68:69], v245 offset:0
ds_read_b64_tr_b16 a[70:71], v245 offset:2048
v_mfma_f32_16x16x32_bf16 v[44:47], a[140:143], v[112:115], v[44:47]
ds_read_b64_tr_b16 a[72:73], v246 offset:0
s_waitcnt vmcnt(7)
v_mfma_f32_16x16x32_bf16 v[32:35], a[144:147], v[116:119], v[32:35]
buffer_load_dwordx4 v[148:151], v6, s[44:47], s59 offen offset:1024 sc1
ds_read_b64_tr_b16 a[74:75], v246 offset:2048
v_mfma_f32_16x16x32_bf16 v[36:39], a[148:151], v[116:119], v[36:39]
ds_read_b64_tr_b16 a[76:77], v247 offset:0
ds_read_b64_tr_b16 a[78:79], v247 offset:2048
v_mfma_f32_16x16x32_bf16 v[40:43], a[152:155], v[116:119], v[40:43]
ds_read_b64_tr_b16 a[80:81], v244 offset:4096
v_mfma_f32_16x16x32_bf16 v[44:47], a[156:159], v[116:119], v[44:47]
ds_read_b64_tr_b16 a[82:83], v244 offset:6144
s_waitcnt vmcnt(7)
v_mfma_f32_16x16x32_bf16 v[32:35], a[160:163], v[120:123], v[32:35]
buffer_load_dwordx4 v[152:155], v7, s[44:47], s59 offen offset:0 sc1
ds_read_b64_tr_b16 a[84:85], v245 offset:4096
v_mfma_f32_16x16x32_bf16 v[36:39], a[164:167], v[120:123], v[36:39]
ds_read_b64_tr_b16 a[86:87], v245 offset:6144
ds_read_b64_tr_b16 a[88:89], v246 offset:4096
v_mfma_f32_16x16x32_bf16 v[40:43], a[168:171], v[120:123], v[40:43]
ds_read_b64_tr_b16 a[90:91], v246 offset:6144
ds_read_b64_tr_b16 a[92:93], v247 offset:4096
v_mfma_f32_16x16x32_bf16 v[44:47], a[172:175], v[120:123], v[44:47]
ds_read_b64_tr_b16 a[94:95], v247 offset:6144
s_waitcnt vmcnt(7)
v_mfma_f32_16x16x32_bf16 v[32:35], a[176:179], v[124:127], v[32:35]
buffer_load_dwordx4 v[156:159], v7, s[44:47], s59 offen offset:1024 sc1
ds_read_b64_tr_b16 a[96:97], v244 offset:8192
v_mfma_f32_16x16x32_bf16 v[36:39], a[180:183], v[124:127], v[36:39]
ds_read_b64_tr_b16 a[98:99], v244 offset:10240
ds_read_b64_tr_b16 a[100:101], v245 offset:8192
v_mfma_f32_16x16x32_bf16 v[40:43], a[184:187], v[124:127], v[40:43]
ds_read_b64_tr_b16 a[102:103], v245 offset:10240
ds_read_b64_tr_b16 a[104:105], v246 offset:8192
v_mfma_f32_16x16x32_bf16 v[44:47], a[188:191], v[124:127], v[44:47]
ds_read_b64_tr_b16 a[106:107], v246 offset:10240
s_waitcnt vmcnt(7)
v_mfma_f32_16x16x32_bf16 v[32:35], a[192:195], v[128:131], v[32:35]
s_lshr_b32 s58, s59, 1
s_bitset1_b32 s58, 14
buffer_load_dwordx4 v[160:163], v7, s[44:47], s58 offen offset:0 sc1
ds_read_b64_tr_b16 a[108:109], v247 offset:8192
v_mfma_f32_16x16x32_bf16 v[36:39], a[196:199], v[128:131], v[36:39]
ds_read_b64_tr_b16 a[110:111], v247 offset:10240
ds_read_b64_tr_b16 a[112:113], v244 offset:12288
v_mfma_f32_16x16x32_bf16 v[40:43], a[200:203], v[128:131], v[40:43]
ds_read_b64_tr_b16 a[114:115], v244 offset:14336
v_mfma_f32_16x16x32_bf16 v[44:47], a[204:207], v[128:131], v[44:47]
ds_read_b64_tr_b16 a[116:117], v245 offset:12288
s_waitcnt vmcnt(7)
v_mfma_f32_16x16x32_bf16 v[32:35], a[208:211], v[132:135], v[32:35]
s_add_u32 s59, s59, 2048
s_and_b32 s59, s59, 0x3fff
buffer_load_dwordx4 v[164:167], v6, s[44:47], s59 offen offset:0 sc1
ds_read_b64_tr_b16 a[118:119], v245 offset:14336
v_mfma_f32_16x16x32_bf16 v[36:39], a[212:215], v[132:135], v[36:39]
ds_read_b64_tr_b16 a[120:121], v246 offset:12288
ds_read_b64_tr_b16 a[122:123], v246 offset:14336
v_mfma_f32_16x16x32_bf16 v[40:43], a[216:219], v[132:135], v[40:43]
ds_read_b64_tr_b16 a[124:125], v247 offset:12288
ds_read_b64_tr_b16 a[126:127], v247 offset:14336
v_mfma_f32_16x16x32_bf16 v[44:47], a[220:223], v[132:135], v[44:47]
ds_read_b64_tr_b16 a[128:129], v244 offset:16384
s_waitcnt vmcnt(7)
v_mfma_f32_16x16x32_bf16 v[32:35], a[224:227], v[136:139], v[32:35]
buffer_load_dwordx4 v[168:171], v6, s[44:47], s59 offen offset:1024 sc1
ds_read_b64_tr_b16 a[130:131], v244 offset:18432
v_mfma_f32_16x16x32_bf16 v[36:39], a[228:231], v[136:139], v[36:39]
ds_read_b64_tr_b16 a[132:133], v245 offset:16384
ds_read_b64_tr_b16 a[134:135], v245 offset:18432
v_mfma_f32_16x16x32_bf16 v[40:43], a[232:235], v[136:139], v[40:43]
ds_read_b64_tr_b16 a[136:137], v246 offset:16384
ds_read_b64_tr_b16 a[138:139], v246 offset:18432
v_mfma_f32_16x16x32_bf16 v[44:47], a[236:239], v[136:139], v[44:47]
ds_read_b64_tr_b16 a[140:141], v247 offset:16384
s_waitcnt vmcnt(7)
v_mfma_f32_16x16x32_bf16 v[32:35], a[240:243], v[140:143], v[32:35]
buffer_load_dwordx4 v[172:175], v7, s[44:47], s59 offen offset:0 sc1
ds_read_b64_tr_b16 a[142:143], v247 offset:18432
v_mfma_f32_16x16x32_bf16 v[36:39], a[244:247], v[140:143], v[36:39]
ds_read_b64_tr_b16 a[144:145], v244 offset:20480
ds_read_b64_tr_b16 a[146:147], v244 offset:22528
v_mfma_f32_16x16x32_bf16 v[40:43], a[248:251], v[140:143], v[40:43]
ds_read_b64_tr_b16 a[148:149], v245 offset:20480
v_mfma_f32_16x16x32_bf16 v[44:47], a[252:255], v[140:143], v[44:47]
ds_read_b64_tr_b16 a[150:151], v245 offset:22528
s_waitcnt vmcnt(7)
v_mfma_f32_16x16x32_bf16 v[32:35], a[0:3], v[144:147], v[32:35]
buffer_load_dwordx4 v[176:179], v7, s[44:47], s59 offen offset:1024 sc1
ds_read_b64_tr_b16 a[152:153], v246 offset:20480
v_mfma_f32_16x16x32_bf16 v[36:39], a[4:7], v[144:147], v[36:39]
ds_read_b64_tr_b16 a[154:155], v246 offset:22528
ds_read_b64_tr_b16 a[156:157], v247 offset:20480
v_mfma_f32_16x16x32_bf16 v[40:43], a[8:11], v[144:147], v[40:43]
ds_read_b64_tr_b16 a[158:159], v247 offset:22528
ds_read_b64_tr_b16 a[160:161], v244 offset:24576
v_mfma_f32_16x16x32_bf16 v[44:47], a[12:15], v[144:147], v[44:47]
s_waitcnt lgkmcnt(7)
s_barrier
s_waitcnt vmcnt(7)
v_mfma_f32_16x16x32_bf16 v[32:35], a[16:19], v[148:151], v[32:35]
s_lshr_b32 s58, s59, 1
s_bitset1_b32 s58, 14
buffer_load_dwordx4 v[180:183], v7, s[44:47], s58 offen offset:0 sc1
ds_read_b64_tr_b16 a[162:163], v244 offset:26624
v_mfma_f32_16x16x32_bf16 v[36:39], a[20:23], v[148:151], v[36:39]
ds_read_b64_tr_b16 a[164:165], v245 offset:24576
ds_read_b64_tr_b16 a[166:167], v245 offset:26624
v_mfma_f32_16x16x32_bf16 v[40:43], a[24:27], v[148:151], v[40:43]
ds_read_b64_tr_b16 a[168:169], v246 offset:24576
v_mfma_f32_16x16x32_bf16 v[44:47], a[28:31], v[148:151], v[44:47]
ds_read_b64_tr_b16 a[170:171], v246 offset:26624
s_waitcnt vmcnt(7)
v_mfma_f32_16x16x32_bf16 v[32:35], a[32:35], v[152:155], v[32:35]
s_add_u32 s59, s59, 2048
s_and_b32 s59, s59, 0x3fff
buffer_load_dwordx4 v[184:187], v6, s[44:47], s59 offen offset:0 sc1
ds_read_b64_tr_b16 a[172:173], v247 offset:24576
v_mfma_f32_16x16x32_bf16 v[36:39], a[36:39], v[152:155], v[36:39]
ds_read_b64_tr_b16 a[174:175], v247 offset:26624
ds_read_b64_tr_b16 a[176:177], v244 offset:28672
v_mfma_f32_16x16x32_bf16 v[40:43], a[40:43], v[152:155], v[40:43]
ds_read_b64_tr_b16 a[178:179], v244 offset:30720
ds_read_b64_tr_b16 a[180:181], v245 offset:28672
v_mfma_f32_16x16x32_bf16 v[44:47], a[44:47], v[152:155], v[44:47]
ds_read_b64_tr_b16 a[182:183], v245 offset:30720
s_waitcnt vmcnt(7)
v_mfma_f32_16x16x32_bf16 v[32:35], a[48:51], v[156:159], v[32:35]
buffer_load_dwordx4 v[188:191], v6, s[44:47], s59 offen offset:1024 sc1
ds_read_b64_tr_b16 a[184:185], v246 offset:28672
v_mfma_f32_16x16x32_bf16 v[36:39], a[52:55], v[156:159], v[36:39]
ds_read_b64_tr_b16 a[186:187], v246 offset:30720
ds_read_b64_tr_b16 a[188:189], v247 offset:28672
v_mfma_f32_16x16x32_bf16 v[40:43], a[56:59], v[156:159], v[40:43]
ds_read_b64_tr_b16 a[190:191], v247 offset:30720
ds_read_b64_tr_b16 a[192:193], v236 offset:0
v_mfma_f32_16x16x32_bf16 v[44:47], a[60:63], v[156:159], v[44:47]
ds_read_b64_tr_b16 a[194:195], v236 offset:2048
s_waitcnt vmcnt(7)
v_mfma_f32_16x16x32_bf16 v[32:35], a[64:67], v[160:163], v[32:35]
buffer_load_dwordx4 v[64:67], v7, s[44:47], s59 offen offset:0 sc1
ds_read_b64_tr_b16 a[196:197], v237 offset:0
v_mfma_f32_16x16x32_bf16 v[36:39], a[68:71], v[160:163], v[36:39]
ds_read_b64_tr_b16 a[198:199], v237 offset:2048
ds_read_b64_tr_b16 a[200:201], v238 offset:0
v_mfma_f32_16x16x32_bf16 v[40:43], a[72:75], v[160:163], v[40:43]
ds_read_b64_tr_b16 a[202:203], v238 offset:2048
v_mfma_f32_16x16x32_bf16 v[44:47], a[76:79], v[160:163], v[44:47]
ds_read_b64_tr_b16 a[204:205], v239 offset:0
s_waitcnt vmcnt(7)
v_mfma_f32_16x16x32_bf16 v[32:35], a[80:83], v[164:167], v[32:35]
buffer_load_dwordx4 v[68:71], v7, s[44:47], s59 offen offset:1024 sc1
ds_read_b64_tr_b16 a[206:207], v239 offset:2048
v_mfma_f32_16x16x32_bf16 v[36:39], a[84:87], v[164:167], v[36:39]
ds_read_b64_tr_b16 a[208:209], v236 offset:4096
ds_read_b64_tr_b16 a[210:211], v236 offset:6144
v_mfma_f32_16x16x32_bf16 v[40:43], a[88:91], v[164:167], v[40:43]
ds_read_b64_tr_b16 a[212:213], v237 offset:4096
ds_read_b64_tr_b16 a[214:215], v237 offset:6144
v_mfma_f32_16x16x32_bf16 v[44:47], a[92:95], v[164:167], v[44:47]
ds_read_b64_tr_b16 a[216:217], v238 offset:4096
s_waitcnt vmcnt(7)
v_mfma_f32_16x16x32_bf16 v[32:35], a[96:99], v[168:171], v[32:35]
s_lshr_b32 s58, s59, 1
s_bitset1_b32 s58, 14
buffer_load_dwordx4 v[72:75], v7, s[44:47], s58 offen offset:0 sc1
ds_read_b64_tr_b16 a[218:219], v238 offset:6144
v_mfma_f32_16x16x32_bf16 v[36:39], a[100:103], v[168:171], v[36:39]
ds_read_b64_tr_b16 a[220:221], v239 offset:4096
ds_read_b64_tr_b16 a[222:223], v239 offset:6144
v_mfma_f32_16x16x32_bf16 v[40:43], a[104:107], v[168:171], v[40:43]
ds_read_b64_tr_b16 a[224:225], v236 offset:8192
ds_read_b64_tr_b16 a[226:227], v236 offset:10240
v_mfma_f32_16x16x32_bf16 v[44:47], a[108:111], v[168:171], v[44:47]
ds_read_b64_tr_b16 a[228:229], v237 offset:8192
s_waitcnt vmcnt(7)
v_mfma_f32_16x16x32_bf16 v[32:35], a[112:115], v[172:175], v[32:35]
s_add_u32 s59, s59, 2048
s_and_b32 s59, s59, 0x3fff
buffer_load_dwordx4 v[76:79], v6, s[44:47], s59 offen offset:0 sc1
ds_read_b64_tr_b16 a[230:231], v237 offset:10240
v_mfma_f32_16x16x32_bf16 v[36:39], a[116:119], v[172:175], v[36:39]
ds_read_b64_tr_b16 a[232:233], v238 offset:8192
ds_read_b64_tr_b16 a[234:235], v238 offset:10240
v_mfma_f32_16x16x32_bf16 v[40:43], a[120:123], v[172:175], v[40:43]
ds_read_b64_tr_b16 a[236:237], v239 offset:8192
v_mfma_f32_16x16x32_bf16 v[44:47], a[124:127], v[172:175], v[44:47]
ds_read_b64_tr_b16 a[238:239], v239 offset:10240
s_waitcnt vmcnt(7)
v_mfma_f32_16x16x32_bf16 v[32:35], a[128:131], v[176:179], v[32:35]
buffer_load_dwordx4 v[80:83], v6, s[44:47], s59 offen offset:1024 sc1
ds_read_b64_tr_b16 a[240:241], v236 offset:12288
v_mfma_f32_16x16x32_bf16 v[36:39], a[132:135], v[176:179], v[36:39]
ds_read_b64_tr_b16 a[242:243], v236 offset:14336
ds_read_b64_tr_b16 a[244:245], v237 offset:12288
v_mfma_f32_16x16x32_bf16 v[40:43], a[136:139], v[176:179], v[40:43]
ds_read_b64_tr_b16 a[246:247], v237 offset:14336
ds_read_b64_tr_b16 a[248:249], v238 offset:12288
v_mfma_f32_16x16x32_bf16 v[44:47], a[140:143], v[176:179], v[44:47]
ds_read_b64_tr_b16 a[250:251], v238 offset:14336
s_waitcnt vmcnt(7) lgkmcnt(15)
v_mfma_f32_16x16x32_bf16 v[32:35], a[144:147], v[180:183], v[32:35]
buffer_load_dwordx4 v[84:87], v7, s[44:47], s59 offen offset:0 sc1
ds_read_b64_tr_b16 a[252:253], v239 offset:12288
v_mfma_f32_16x16x32_bf16 v[36:39], a[148:151], v[180:183], v[36:39]
ds_read_b64_tr_b16 a[254:255], v239 offset:14336
ds_read_b64_tr_b16 a[0:1], v236 offset:24576
v_mfma_f32_16x16x32_bf16 v[40:43], a[152:155], v[180:183], v[40:43]
ds_read_b64_tr_b16 a[2:3], v236 offset:26624
ds_read_b64_tr_b16 a[4:5], v237 offset:24576
v_mfma_f32_16x16x32_bf16 v[44:47], a[156:159], v[180:183], v[44:47]
ds_read_b64_tr_b16 a[6:7], v237 offset:26624
s_waitcnt vmcnt(7)
v_mfma_f32_16x16x32_bf16 v[32:35], a[160:163], v[184:187], v[32:35]
buffer_load_dwordx4 v[88:91], v7, s[44:47], s59 offen offset:1024 sc1
ds_read_b64_tr_b16 a[8:9], v238 offset:24576
v_mfma_f32_16x16x32_bf16 v[36:39], a[164:167], v[184:187], v[36:39]
ds_read_b64_tr_b16 a[10:11], v238 offset:26624
ds_read_b64_tr_b16 a[12:13], v239 offset:24576
v_mfma_f32_16x16x32_bf16 v[40:43], a[168:171], v[184:187], v[40:43]
ds_read_b64_tr_b16 a[14:15], v239 offset:26624
v_mfma_f32_16x16x32_bf16 v[44:47], a[172:175], v[184:187], v[44:47]
ds_read_b64_tr_b16 a[16:17], v236 offset:28672
s_waitcnt vmcnt(7)
v_mfma_f32_16x16x32_bf16 v[32:35], a[176:179], v[188:191], v[32:35]
s_lshr_b32 s58, s59, 1
s_bitset1_b32 s58, 14
buffer_load_dwordx4 v[92:95], v7, s[44:47], s58 offen offset:0 sc1
ds_read_b64_tr_b16 a[18:19], v236 offset:30720
v_mfma_f32_16x16x32_bf16 v[36:39], a[180:183], v[188:191], v[36:39]
ds_read_b64_tr_b16 a[20:21], v237 offset:28672
ds_read_b64_tr_b16 a[22:23], v237 offset:30720
v_mfma_f32_16x16x32_bf16 v[40:43], a[184:187], v[188:191], v[40:43]
ds_read_b64_tr_b16 a[24:25], v238 offset:28672
ds_read_b64_tr_b16 a[26:27], v238 offset:30720
v_mfma_f32_16x16x32_bf16 v[44:47], a[188:191], v[188:191], v[44:47]
ds_read_b64_tr_b16 a[28:29], v239 offset:28672
s_waitcnt vmcnt(7)
v_mfma_f32_16x16x32_bf16 v[32:35], a[192:195], v[64:67], v[32:35]
s_mov_b32 s58, 40960
buffer_load_dwordx4 v[96:99], v7, s[44:47], s58 offen offset:0 sc1
ds_read_b64_tr_b16 a[30:31], v239 offset:30720
v_mfma_f32_16x16x32_bf16 v[36:39], a[196:199], v[64:67], v[36:39]
ds_read_b64_tr_b16 a[32:33], v236 offset:32768
ds_read_b64_tr_b16 a[34:35], v236 offset:34816
v_mfma_f32_16x16x32_bf16 v[40:43], a[200:203], v[64:67], v[40:43]
ds_read_b64_tr_b16 a[36:37], v237 offset:32768
ds_read_b64_tr_b16 a[38:39], v237 offset:34816
v_mfma_f32_16x16x32_bf16 v[44:47], a[204:207], v[64:67], v[44:47]
ds_read_b64_tr_b16 a[40:41], v238 offset:32768
s_waitcnt vmcnt(7) lgkmcnt(15)
v_mfma_f32_16x16x32_bf16 v[32:35], a[208:211], v[68:71], v[32:35]
buffer_load_dwordx4 v[100:103], v7, s[44:47], s58 offen offset:1024 sc1
ds_read_b64_tr_b16 a[42:43], v238 offset:34816
v_mfma_f32_16x16x32_bf16 v[36:39], a[212:215], v[68:71], v[36:39]
ds_read_b64_tr_b16 a[44:45], v239 offset:32768
ds_read_b64_tr_b16 a[46:47], v239 offset:34816
v_mfma_f32_16x16x32_bf16 v[40:43], a[216:219], v[68:71], v[40:43]
ds_read_b64_tr_b16 a[48:49], v236 offset:36864
v_mfma_f32_16x16x32_bf16 v[44:47], a[220:223], v[68:71], v[44:47]
ds_read_b64_tr_b16 a[50:51], v236 offset:38912
s_waitcnt vmcnt(7)
v_mfma_f32_16x16x32_bf16 v[32:35], a[224:227], v[72:75], v[32:35]
buffer_load_dwordx4 v[104:107], v7, s[44:47], s58 offen offset:2048 sc1
ds_read_b64_tr_b16 a[52:53], v237 offset:36864
v_mfma_f32_16x16x32_bf16 v[36:39], a[228:231], v[72:75], v[36:39]
ds_read_b64_tr_b16 a[54:55], v237 offset:38912
ds_read_b64_tr_b16 a[56:57], v238 offset:36864
v_mfma_f32_16x16x32_bf16 v[40:43], a[232:235], v[72:75], v[40:43]
ds_read_b64_tr_b16 a[58:59], v238 offset:38912
ds_read_b64_tr_b16 a[60:61], v239 offset:36864
v_mfma_f32_16x16x32_bf16 v[44:47], a[236:239], v[72:75], v[44:47]
ds_read_b64_tr_b16 a[62:63], v239 offset:38912
s_waitcnt vmcnt(7)
v_mfma_f32_16x16x32_bf16 v[32:35], a[240:243], v[76:79], v[32:35]
ds_read_b64_tr_b16 a[64:65], v236 offset:40960
v_mfma_f32_16x16x32_bf16 v[36:39], a[244:247], v[76:79], v[36:39]
ds_read_b64_tr_b16 a[66:67], v236 offset:43008
ds_read_b64_tr_b16 a[68:69], v237 offset:40960
v_mfma_f32_16x16x32_bf16 v[40:43], a[248:251], v[76:79], v[40:43]
ds_read_b64_tr_b16 a[70:71], v237 offset:43008
ds_read_b64_tr_b16 a[72:73], v238 offset:40960
v_mfma_f32_16x16x32_bf16 v[44:47], a[252:255], v[76:79], v[44:47]
ds_read_b64_tr_b16 a[74:75], v238 offset:43008
s_waitcnt vmcnt(6) lgkmcnt(15)
v_mfma_f32_16x16x32_bf16 v[32:35], a[0:3], v[80:83], v[32:35]
ds_read_b64_tr_b16 a[76:77], v239 offset:40960
v_mfma_f32_16x16x32_bf16 v[36:39], a[4:7], v[80:83], v[36:39]
ds_read_b64_tr_b16 a[78:79], v239 offset:43008
ds_read_b64_tr_b16 a[80:81], v236 offset:45056
v_mfma_f32_16x16x32_bf16 v[40:43], a[8:11], v[80:83], v[40:43]
ds_read_b64_tr_b16 a[82:83], v236 offset:47104
ds_read_b64_tr_b16 a[84:85], v237 offset:45056
v_mfma_f32_16x16x32_bf16 v[44:47], a[12:15], v[80:83], v[44:47]
ds_read_b64_tr_b16 a[86:87], v237 offset:47104
s_waitcnt vmcnt(5)
v_mfma_f32_16x16x32_bf16 v[32:35], a[16:19], v[84:87], v[32:35]
ds_read_b64_tr_b16 a[88:89], v238 offset:45056
v_mfma_f32_16x16x32_bf16 v[36:39], a[20:23], v[84:87], v[36:39]
ds_read_b64_tr_b16 a[90:91], v238 offset:47104
ds_read_b64_tr_b16 a[92:93], v239 offset:45056
v_mfma_f32_16x16x32_bf16 v[40:43], a[24:27], v[84:87], v[40:43]
ds_read_b64_tr_b16 a[94:95], v239 offset:47104
ds_read_b64_tr_b16 a[96:97], v236 offset:49152
v_mfma_f32_16x16x32_bf16 v[44:47], a[28:31], v[84:87], v[44:47]
ds_read_b64_tr_b16 a[98:99], v236 offset:51200
s_waitcnt vmcnt(4) lgkmcnt(15)
v_mfma_f32_16x16x32_bf16 v[32:35], a[32:35], v[88:91], v[32:35]
ds_read_b64_tr_b16 a[100:101], v237 offset:49152
v_mfma_f32_16x16x32_bf16 v[36:39], a[36:39], v[88:91], v[36:39]
ds_read_b64_tr_b16 a[102:103], v237 offset:51200
ds_read_b64_tr_b16 a[104:105], v238 offset:49152
v_mfma_f32_16x16x32_bf16 v[40:43], a[40:43], v[88:91], v[40:43]
ds_read_b64_tr_b16 a[106:107], v238 offset:51200
v_mfma_f32_16x16x32_bf16 v[44:47], a[44:47], v[88:91], v[44:47]
ds_read_b64_tr_b16 a[108:109], v239 offset:49152
s_waitcnt vmcnt(3)
v_mfma_f32_16x16x32_bf16 v[32:35], a[48:51], v[92:95], v[32:35]
ds_read_b64_tr_b16 a[110:111], v239 offset:51200
v_mfma_f32_16x16x32_bf16 v[36:39], a[52:55], v[92:95], v[36:39]
v_mfma_f32_16x16x32_bf16 v[40:43], a[56:59], v[92:95], v[40:43]
v_mfma_f32_16x16x32_bf16 v[44:47], a[60:63], v[92:95], v[44:47]
ds_read_b128 v[200:203], v14 offset:768
ds_read_b128 v[204:207], v14 offset:832
ds_read_b128 v[208:211], v14 offset:896
ds_read_b128 v[212:215], v14 offset:960
s_waitcnt vmcnt(2) lgkmcnt(15)
v_mfma_f32_16x16x32_bf16 v[32:35], a[64:67], v[96:99], v[32:35]
v_mfma_f32_16x16x32_bf16 v[36:39], a[68:71], v[96:99], v[36:39]
v_mfma_f32_16x16x32_bf16 v[40:43], a[72:75], v[96:99], v[40:43]
v_mfma_f32_16x16x32_bf16 v[44:47], a[76:79], v[96:99], v[44:47]
s_waitcnt vmcnt(1) lgkmcnt(12)
v_mfma_f32_16x16x32_bf16 v[32:35], a[80:83], v[100:103], v[32:35]
s_mul_i32 s57, s52, 2304
s_add_u32 s57, s57, 65536
v_mfma_f32_16x16x32_bf16 v[36:39], a[84:87], v[100:103], v[36:39]
v_mul_u32_u24 v5, 144, v4
v_lshl_add_u32 v5, v3, 3, v5
v_mfma_f32_16x16x32_bf16 v[40:43], a[88:91], v[100:103], v[40:43]
v_add_u32 v5, s57, v5
v_lshrrev_b32 v252, 3, v1
v_mfma_f32_16x16x32_bf16 v[44:47], a[92:95], v[100:103], v[44:47]
v_mul_u32_u24 v8, 144, v252
v_and_b32 v6, 7, v1
s_waitcnt vmcnt(0) lgkmcnt(4)
v_mfma_f32_16x16x32_bf16 v[32:35], a[96:99], v[104:107], v[32:35]
v_lshlrev_b32 v6, 4, v6
v_add3_u32 v8, v8, v6, s57
v_mfma_f32_16x16x32_bf16 v[36:39], a[100:103], v[104:107], v[36:39]
v_lshl_add_u32 v252, v252, 10, v6
v_mfma_f32_16x16x32_bf16 v[40:43], a[104:107], v[104:107], v[40:43]
v_mfma_f32_16x16x32_bf16 v[44:47], a[108:111], v[104:107], v[44:47]
s_waitcnt lgkmcnt(0)
s_nop 0
v_pk_fma_f32 v[16:17], v[32:33], v[200:201], v[16:17]
v_pk_fma_f32 v[18:19], v[34:35], v[202:203], v[18:19]
s_nop 0
v_pk_fma_f32 v[20:21], v[36:37], v[204:205], v[20:21]
v_pk_fma_f32 v[22:23], v[38:39], v[206:207], v[22:23]
v_pk_fma_f32 v[24:25], v[40:41], v[208:209], v[24:25]
v_pk_fma_f32 v[26:27], v[42:43], v[210:211], v[26:27]
v_pk_fma_f32 v[28:29], v[44:45], v[212:213], v[28:29]
v_pk_fma_f32 v[30:31], v[46:47], v[214:215], v[30:31]
v_cvt_pk_bf16_f32 v192, v16, v17
v_cvt_pk_bf16_f32 v193, v18, v19
v_cvt_pk_bf16_f32 v194, v20, v21
v_cvt_pk_bf16_f32 v195, v22, v23
v_cvt_pk_bf16_f32 v196, v24, v25
v_cvt_pk_bf16_f32 v197, v26, v27
v_cvt_pk_bf16_f32 v198, v28, v29
v_cvt_pk_bf16_f32 v199, v30, v31
ds_write2_b64 v5, v[192:193], v[194:195] offset0:0 offset1:4
ds_write2_b64 v5, v[196:197], v[198:199] offset0:8 offset1:12
ds_read_b128 v[64:67], v8
ds_read_b128 v[68:71], v8 offset:1152
s_add_u32 s57, s33, 8192
s_waitcnt lgkmcnt(1)
buffer_store_dwordx4 v[64:67], v252, s[40:43], s33 offen nt
s_waitcnt lgkmcnt(0)
buffer_store_dwordx4 v[68:71], v252, s[40:43], s57 offen nt
s_endpgm
L_end:
s_endpgm

.section .rodata,"a"
.p2align 6
.amdhsa_kernel adaLN_cond__sliding_local_dilated__mixer_s_mlp__prompt_kernel
  .amdhsa_next_free_vgpr 512
  .amdhsa_next_free_sgpr 102
  .amdhsa_accum_offset 256
  .amdhsa_group_segment_fixed_size 0
  .amdhsa_kernarg_size 104
  .amdhsa_user_sgpr_count 2
  .amdhsa_user_sgpr_kernarg_segment_ptr 1
  .amdhsa_system_sgpr_workgroup_id_x 1
  .amdhsa_float_denorm_mode_32 3
  .amdhsa_float_denorm_mode_16_64 3
.end_amdhsa_kernel
```
